```python
import torch

def _softmax(x, axis=-1):
    return torch.softmax(x, dim=axis)
def _gelu(x):
    return torch.nn.functional.gelu(x, approximate="tanh")
def _silu(x):
    return torch.nn.functional.silu(x)
def _sigmoid(x):
    return torch.sigmoid(x)
def _layernorm(x, axis=-1, eps=1e-5):
    m = x.mean(dim=axis, keepdim=True)
    v = x.var(dim=axis, keepdim=True, unbiased=False)
    return (x - m) / torch.sqrt(v + eps)
def _scatter_add(tgt, idx, src, axis=0):
    return tgt.clone().index_add_(axis, idx, src)
def _segment_sum(src, seg, n):
    out = torch.zeros((n,) + src.shape[1:], dtype=src.dtype)
    return out.index_add_(0, seg, src)
def _pad(x, pw):
    flat = tuple(v for pair in reversed(pw) for v in pair)
    return torch.nn.functional.pad(x, flat)

kernel_name = 'interleave_layers__ssm_conv_h3__glu_gated_glu__prompt'

def setup_inputs():

    _w = (lambda a: (lambda t: t.to(torch.bfloat16) if t.is_floating_point() else t)(torch.as_tensor(a)))
    def _A_setup():
        B, S, D = 1, 2048, 640
        ks = 4
        return {
            "q": _w((lambda *s: torch.randn(*s, dtype=torch.bfloat16) * 0.05)(B, S, D)),
            "k": _w((lambda *s: torch.randn(*s, dtype=torch.bfloat16) * 0.4)(B, S, D)),
            "v": _w((lambda *s: torch.randn(*s, dtype=torch.bfloat16) * 0.4)(B, S, D)),
            "shift_k": _w((lambda *s: torch.randn(*s, dtype=torch.bfloat16) * 0.4)(D, ks) * 0.5),
            "ssm_k": _w((lambda *s: torch.randn(*s, dtype=torch.bfloat16) * 0.4)(D, S) * (1.0 / S ** 0.5)),
            "ssm_D": _w((lambda *s: torch.randn(*s, dtype=torch.bfloat16) * 0.4)(D)),
        }
    _A_in = _A_setup()

    def _B_setup():
        B, S, D, F = 1, 2048, 640, 1728
        return {
            "x": _w((lambda *s: torch.randn(*s, dtype=torch.bfloat16) * 0.05)(B, S, D)),
            "w_gate": _w((lambda *s: torch.randn(*s, dtype=torch.bfloat16) * 0.05)(D, F)),
            "w_up": _w((lambda *s: torch.randn(*s, dtype=torch.bfloat16) * 0.05)(D, F)),
            "w_down": _w((lambda *s: torch.randn(*s, dtype=torch.bfloat16) * 0.05)(F, D)),
        }
    _B_in = _B_setup()

    return {
        "A_q": _A_in["q"],
        "A_k": _A_in["k"],
        "A_v": _A_in["v"],
        "A_shift_k": _A_in["shift_k"],
        "A_ssm_k": _A_in["ssm_k"],
        "A_ssm_D": _A_in["ssm_D"],
        "B_x": _B_in["x"],
        "B_w_gate": _B_in["w_gate"],
        "B_w_up": _B_in["w_up"],
        "B_w_down": _B_in["w_down"],
    }

def reference(A_q, A_k, A_v, A_shift_k, A_ssm_k, A_ssm_D, B_x, B_w_gate, B_w_up, B_w_down):
    def _A_ref(q, k, v, shift_k, ssm_k, ssm_D):
        B, S, D = q.shape
        ks = shift_k.shape[-1]
        k_pad = _pad(k, ((0, 0), (ks - 1, 0), (0, 0)))
        k_shift = torch.zeros_like(k)
        for t in range(ks):
            k_shift = k_shift + k_pad[:, t:t + S, :] * shift_k[:, ks - 1 - t][None, None, :]
        kv = k_shift * v
        L = 2 * S
        kv_pad = _pad(kv, ((0, 0), (0, S), (0, 0)))
        kf_pad = _pad(ssm_k, ((0, 0), (0, S)))
        kv_f = (lambda x, axes=(-2,-1): torch.fft.rfft2(x.float(), dim=axes))(kv_pad[:, None, :, :], axes=(1, 2))
        kf_f = (lambda x, axes=(-2,-1): torch.fft.rfft2(x.float(), dim=axes))(kf_pad[:, None, :], axes=(1, 2))
        kf_f = (lambda x, *d: x.permute(*d))(kf_f, 1, 2, 0)
        y_f = kv_f * kf_f[None, :, :, :]
        y = (lambda x, s, axes=(-2,-1): torch.fft.irfft2(x, s=s, dim=axes).to(torch.bfloat16))(y_f, (1, L), axes=(1, 2))[:, 0, :S, :]
        y = y + kv * ssm_D[None, None, :]
        return q * y

    def _B_ref(x, w_gate, w_up, w_down):
        g = torch.einsum("bsd,df->bsf", x, w_gate)
        u = torch.einsum("bsd,df->bsf", x, w_up)
        h = _sigmoid(g) * u
        return torch.einsum("bsf,fd->bsd", h, w_down)

    x = A_q
    x = x + _A_ref(_layernorm(x, axis=-1), A_k, A_v, A_shift_k, A_ssm_k, A_ssm_D)
    x = x + _B_ref(_layernorm(x, axis=-1), B_w_gate, B_w_up, B_w_down)
    x = x + _A_ref(_layernorm(x, axis=-1), A_k, A_v, A_shift_k, A_ssm_k, A_ssm_D)
    x = x + _B_ref(_layernorm(x, axis=-1), B_w_gate, B_w_up, B_w_down)
    return x
```

```asm
; @launch kernel=kvt_kernel grid=(320,1,1) block=(256,1,1) lds=8704
; @launch kernel=conv_kernel grid=(160,1,1) block=(256,1,1) lds=124928
; @launch kernel=lna_kernel grid=(128,1,1) block=(1024,1,1) lds=20608
; @launch kernel=g1_kernel grid=(432,1,1) block=(256,1,1) lds=65536
; @launch kernel=g2a_kernel grid=(160,1,1) block=(256,1,1) lds=73728
; @launch kernel=lnb_kernel grid=(128,1,1) block=(1024,1,1) lds=20608
; @launch kernel=g1_kernel grid=(432,1,1) block=(256,1,1) lds=65536
; @launch kernel=g2b_kernel grid=(160,1,1) block=(256,1,1) lds=73728
.amdgcn_target "amdgcn-amd-amdhsa--gfx950"
.text
.globl kvt_kernel
.p2align 8
.type kvt_kernel,@function
kvt_kernel:
    s_cmp_ge_u32 s2, 320
    s_cbranch_scc1 KVT_END
    s_load_dwordx4 s[4:7], s[0:1], 8
    s_load_dwordx2 s[8:9], s[0:1], 24
    s_load_dwordx2 s[14:15], s[0:1], 96
    s_and_b32 s60, s2, 31
    s_lshr_b32 s61, s2, 5
    s_waitcnt lgkmcnt(0)
    s_mov_b32 s16, s4
    s_mov_b32 s17, s5
    s_mov_b32 s18, 2621440
    s_mov_b32 s19, 0x00020000
    s_mov_b32 s20, s6
    s_mov_b32 s21, s7
    s_mov_b32 s22, 2621440
    s_mov_b32 s23, 0x00020000
    s_mov_b32 s24, s8
    s_mov_b32 s25, s9
    s_mov_b32 s26, 5120
    s_mov_b32 s27, 0x00020000
    s_add_u32 s56, s14, 17563648
    s_addc_u32 s57, s15, 0
    s_mov_b32 s58, 2621440
    s_mov_b32 s59, 0x00020000
    v_lshrrev_b32 v1, 4, v0
    v_and_b32 v2, 15, v0
    s_lshl_b32 s62, s60, 6
    v_lshl_add_u32 v3, v1, 2, s62
    s_movk_i32 s63, 1280
    v_mul_lo_u32 v3, v3, s63
    s_lshl_b32 s62, s61, 7
    v_add_u32 v3, s62, v3
    v_lshl_add_u32 v3, v2, 3, v3
    v_add_u32 v4, 4294963456, v3
    buffer_load_dwordx2 v[10:11], v4, s[16:19], 0 offen
    v_add_u32 v4, 4294964736, v3
    buffer_load_dwordx2 v[12:13], v4, s[16:19], 0 offen
    v_add_u32 v4, 4294966016, v3
    buffer_load_dwordx2 v[14:15], v4, s[16:19], 0 offen
    v_add_u32 v4, 0, v3
    buffer_load_dwordx2 v[16:17], v4, s[16:19], 0 offen
    v_add_u32 v4, 1280, v3
    buffer_load_dwordx2 v[18:19], v4, s[16:19], 0 offen
    v_add_u32 v4, 2560, v3
    buffer_load_dwordx2 v[20:21], v4, s[16:19], 0 offen
    v_add_u32 v4, 3840, v3
    buffer_load_dwordx2 v[22:23], v4, s[16:19], 0 offen
    v_add_u32 v4, 0, v3
    buffer_load_dwordx2 v[24:25], v4, s[20:23], 0 offen
    v_add_u32 v4, 1280, v3
    buffer_load_dwordx2 v[26:27], v4, s[20:23], 0 offen
    v_add_u32 v4, 2560, v3
    buffer_load_dwordx2 v[28:29], v4, s[20:23], 0 offen
    v_add_u32 v4, 3840, v3
    buffer_load_dwordx2 v[30:31], v4, s[20:23], 0 offen
    s_lshl_b32 s62, s61, 9
    v_lshlrev_b32 v4, 5, v2
    v_add_u32 v4, s62, v4
    buffer_load_dwordx4 v[32:35], v4, s[24:27], 0 offen
    buffer_load_dwordx4 v[36:39], v4, s[24:27], 0 offen offset:16
    s_waitcnt vmcnt(0)
    v_and_b32 v5, 1, v1
    v_xor_b32 v5, 1, v5
    v_lshlrev_b32 v5, 3, v5
    v_lshrrev_b32 v6, 1, v1
    v_lshl_add_u32 v5, v6, 4, v5
    v_mul_u32_u24 v6, 544, v2
    v_add_u32 v5, v5, v6
    v_lshlrev_b32 v40, 16, v10
    v_lshlrev_b32 v41, 16, v12
    v_lshlrev_b32 v42, 16, v14
    v_lshlrev_b32 v43, 16, v16
    v_lshlrev_b32 v44, 16, v18
    v_lshlrev_b32 v45, 16, v20
    v_lshlrev_b32 v46, 16, v22
    v_lshlrev_b32 v47, 16, v24
    v_lshlrev_b32 v48, 16, v26
    v_lshlrev_b32 v49, 16, v28
    v_lshlrev_b32 v50, 16, v30
    v_lshlrev_b32 v51, 16, v32
    v_and_b32 v52, 0xffff0000, v32
    v_lshlrev_b32 v53, 16, v33
    v_and_b32 v54, 0xffff0000, v33
    v_mul_f32 v60, v54, v40
    v_mul_f32 v61, v54, v41
    v_cvt_pk_bf16_f32 v7, v60, v61
    v_lshlrev_b32 v60, 16, v7
    v_and_b32 v61, 0xffff0000, v7
    v_mul_f32 v8, v53, v41
    v_mul_f32 v9, v53, v42
    v_cvt_pk_bf16_f32 v7, v8, v9
    v_lshlrev_b32 v8, 16, v7
    v_and_b32 v9, 0xffff0000, v7
    v_add_f32 v60, v60, v8
    v_add_f32 v61, v61, v9
    v_cvt_pk_bf16_f32 v7, v60, v61
    v_lshlrev_b32 v60, 16, v7
    v_and_b32 v61, 0xffff0000, v7
    v_mul_f32 v8, v52, v42
    v_mul_f32 v9, v52, v43
    v_cvt_pk_bf16_f32 v7, v8, v9
    v_lshlrev_b32 v8, 16, v7
    v_and_b32 v9, 0xffff0000, v7
    v_add_f32 v60, v60, v8
    v_add_f32 v61, v61, v9
    v_cvt_pk_bf16_f32 v7, v60, v61
    v_lshlrev_b32 v60, 16, v7
    v_and_b32 v61, 0xffff0000, v7
    v_mul_f32 v8, v51, v43
    v_mul_f32 v9, v51, v44
    v_cvt_pk_bf16_f32 v7, v8, v9
    v_lshlrev_b32 v8, 16, v7
    v_and_b32 v9, 0xffff0000, v7
    v_add_f32 v60, v60, v8
    v_add_f32 v61, v61, v9
    v_cvt_pk_bf16_f32 v7, v60, v61
    v_lshlrev_b32 v60, 16, v7
    v_and_b32 v61, 0xffff0000, v7
    v_mul_f32 v60, v60, v47
    v_mul_f32 v61, v61, v48
    v_mul_f32 v62, v54, v42
    v_mul_f32 v63, v54, v43
    v_cvt_pk_bf16_f32 v7, v62, v63
    v_lshlrev_b32 v62, 16, v7
    v_and_b32 v63, 0xffff0000, v7
    v_mul_f32 v8, v53, v43
    v_mul_f32 v9, v53, v44
    v_cvt_pk_bf16_f32 v7, v8, v9
    v_lshlrev_b32 v8, 16, v7
    v_and_b32 v9, 0xffff0000, v7
    v_add_f32 v62, v62, v8
    v_add_f32 v63, v63, v9
    v_cvt_pk_bf16_f32 v7, v62, v63
    v_lshlrev_b32 v62, 16, v7
    v_and_b32 v63, 0xffff0000, v7
    v_mul_f32 v8, v52, v44
    v_mul_f32 v9, v52, v45
    v_cvt_pk_bf16_f32 v7, v8, v9
    v_lshlrev_b32 v8, 16, v7
    v_and_b32 v9, 0xffff0000, v7
    v_add_f32 v62, v62, v8
    v_add_f32 v63, v63, v9
    v_cvt_pk_bf16_f32 v7, v62, v63
    v_lshlrev_b32 v62, 16, v7
    v_and_b32 v63, 0xffff0000, v7
    v_mul_f32 v8, v51, v45
    v_mul_f32 v9, v51, v46
    v_cvt_pk_bf16_f32 v7, v8, v9
    v_lshlrev_b32 v8, 16, v7
    v_and_b32 v9, 0xffff0000, v7
    v_add_f32 v62, v62, v8
    v_add_f32 v63, v63, v9
    v_cvt_pk_bf16_f32 v7, v62, v63
    v_lshlrev_b32 v62, 16, v7
    v_and_b32 v63, 0xffff0000, v7
    v_mul_f32 v62, v62, v49
    v_mul_f32 v63, v63, v50
    v_cvt_pk_bf16_f32 v64, v63, v62
    v_cvt_pk_bf16_f32 v65, v61, v60
    ds_write_b64 v5, v[64:65] offset:0
    v_and_b32 v40, 0xffff0000, v10
    v_and_b32 v41, 0xffff0000, v12
    v_and_b32 v42, 0xffff0000, v14
    v_and_b32 v43, 0xffff0000, v16
    v_and_b32 v44, 0xffff0000, v18
    v_and_b32 v45, 0xffff0000, v20
    v_and_b32 v46, 0xffff0000, v22
    v_and_b32 v47, 0xffff0000, v24
    v_and_b32 v48, 0xffff0000, v26
    v_and_b32 v49, 0xffff0000, v28
    v_and_b32 v50, 0xffff0000, v30
    v_lshlrev_b32 v51, 16, v34
    v_and_b32 v52, 0xffff0000, v34
    v_lshlrev_b32 v53, 16, v35
    v_and_b32 v54, 0xffff0000, v35
    v_mul_f32 v60, v54, v40
    v_mul_f32 v61, v54, v41
    v_cvt_pk_bf16_f32 v7, v60, v61
    v_lshlrev_b32 v60, 16, v7
    v_and_b32 v61, 0xffff0000, v7
    v_mul_f32 v8, v53, v41
    v_mul_f32 v9, v53, v42
    v_cvt_pk_bf16_f32 v7, v8, v9
    v_lshlrev_b32 v8, 16, v7
    v_and_b32 v9, 0xffff0000, v7
    v_add_f32 v60, v60, v8
    v_add_f32 v61, v61, v9
    v_cvt_pk_bf16_f32 v7, v60, v61
    v_lshlrev_b32 v60, 16, v7
    v_and_b32 v61, 0xffff0000, v7
    v_mul_f32 v8, v52, v42
    v_mul_f32 v9, v52, v43
    v_cvt_pk_bf16_f32 v7, v8, v9
    v_lshlrev_b32 v8, 16, v7
    v_and_b32 v9, 0xffff0000, v7
    v_add_f32 v60, v60, v8
    v_add_f32 v61, v61, v9
    v_cvt_pk_bf16_f32 v7, v60, v61
    v_lshlrev_b32 v60, 16, v7
    v_and_b32 v61, 0xffff0000, v7
    v_mul_f32 v8, v51, v43
    v_mul_f32 v9, v51, v44
    v_cvt_pk_bf16_f32 v7, v8, v9
    v_lshlrev_b32 v8, 16, v7
    v_and_b32 v9, 0xffff0000, v7
    v_add_f32 v60, v60, v8
    v_add_f32 v61, v61, v9
    v_cvt_pk_bf16_f32 v7, v60, v61
    v_lshlrev_b32 v60, 16, v7
    v_and_b32 v61, 0xffff0000, v7
    v_mul_f32 v60, v60, v47
    v_mul_f32 v61, v61, v48
    v_mul_f32 v62, v54, v42
    v_mul_f32 v63, v54, v43
    v_cvt_pk_bf16_f32 v7, v62, v63
    v_lshlrev_b32 v62, 16, v7
    v_and_b32 v63, 0xffff0000, v7
    v_mul_f32 v8, v53, v43
    v_mul_f32 v9, v53, v44
    v_cvt_pk_bf16_f32 v7, v8, v9
    v_lshlrev_b32 v8, 16, v7
    v_and_b32 v9, 0xffff0000, v7
    v_add_f32 v62, v62, v8
    v_add_f32 v63, v63, v9
    v_cvt_pk_bf16_f32 v7, v62, v63
    v_lshlrev_b32 v62, 16, v7
    v_and_b32 v63, 0xffff0000, v7
    v_mul_f32 v8, v52, v44
    v_mul_f32 v9, v52, v45
    v_cvt_pk_bf16_f32 v7, v8, v9
    v_lshlrev_b32 v8, 16, v7
    v_and_b32 v9, 0xffff0000, v7
    v_add_f32 v62, v62, v8
    v_add_f32 v63, v63, v9
    v_cvt_pk_bf16_f32 v7, v62, v63
    v_lshlrev_b32 v62, 16, v7
    v_and_b32 v63, 0xffff0000, v7
    v_mul_f32 v8, v51, v45
    v_mul_f32 v9, v51, v46
    v_cvt_pk_bf16_f32 v7, v8, v9
    v_lshlrev_b32 v8, 16, v7
    v_and_b32 v9, 0xffff0000, v7
    v_add_f32 v62, v62, v8
    v_add_f32 v63, v63, v9
    v_cvt_pk_bf16_f32 v7, v62, v63
    v_lshlrev_b32 v62, 16, v7
    v_and_b32 v63, 0xffff0000, v7
    v_mul_f32 v62, v62, v49
    v_mul_f32 v63, v63, v50
    v_cvt_pk_bf16_f32 v64, v63, v62
    v_cvt_pk_bf16_f32 v65, v61, v60
    ds_write_b64 v5, v[64:65] offset:136
    v_lshlrev_b32 v40, 16, v11
    v_lshlrev_b32 v41, 16, v13
    v_lshlrev_b32 v42, 16, v15
    v_lshlrev_b32 v43, 16, v17
    v_lshlrev_b32 v44, 16, v19
    v_lshlrev_b32 v45, 16, v21
    v_lshlrev_b32 v46, 16, v23
    v_lshlrev_b32 v47, 16, v25
    v_lshlrev_b32 v48, 16, v27
    v_lshlrev_b32 v49, 16, v29
    v_lshlrev_b32 v50, 16, v31
    v_lshlrev_b32 v51, 16, v36
    v_and_b32 v52, 0xffff0000, v36
    v_lshlrev_b32 v53, 16, v37
    v_and_b32 v54, 0xffff0000, v37
    v_mul_f32 v60, v54, v40
    v_mul_f32 v61, v54, v41
    v_cvt_pk_bf16_f32 v7, v60, v61
    v_lshlrev_b32 v60, 16, v7
    v_and_b32 v61, 0xffff0000, v7
    v_mul_f32 v8, v53, v41
    v_mul_f32 v9, v53, v42
    v_cvt_pk_bf16_f32 v7, v8, v9
    v_lshlrev_b32 v8, 16, v7
    v_and_b32 v9, 0xffff0000, v7
    v_add_f32 v60, v60, v8
    v_add_f32 v61, v61, v9
    v_cvt_pk_bf16_f32 v7, v60, v61
    v_lshlrev_b32 v60, 16, v7
    v_and_b32 v61, 0xffff0000, v7
    v_mul_f32 v8, v52, v42
    v_mul_f32 v9, v52, v43
    v_cvt_pk_bf16_f32 v7, v8, v9
    v_lshlrev_b32 v8, 16, v7
    v_and_b32 v9, 0xffff0000, v7
    v_add_f32 v60, v60, v8
    v_add_f32 v61, v61, v9
    v_cvt_pk_bf16_f32 v7, v60, v61
    v_lshlrev_b32 v60, 16, v7
    v_and_b32 v61, 0xffff0000, v7
    v_mul_f32 v8, v51, v43
    v_mul_f32 v9, v51, v44
    v_cvt_pk_bf16_f32 v7, v8, v9
    v_lshlrev_b32 v8, 16, v7
    v_and_b32 v9, 0xffff0000, v7
    v_add_f32 v60, v60, v8
    v_add_f32 v61, v61, v9
    v_cvt_pk_bf16_f32 v7, v60, v61
    v_lshlrev_b32 v60, 16, v7
    v_and_b32 v61, 0xffff0000, v7
    v_mul_f32 v60, v60, v47
    v_mul_f32 v61, v61, v48
    v_mul_f32 v62, v54, v42
    v_mul_f32 v63, v54, v43
    v_cvt_pk_bf16_f32 v7, v62, v63
    v_lshlrev_b32 v62, 16, v7
    v_and_b32 v63, 0xffff0000, v7
    v_mul_f32 v8, v53, v43
    v_mul_f32 v9, v53, v44
    v_cvt_pk_bf16_f32 v7, v8, v9
    v_lshlrev_b32 v8, 16, v7
    v_and_b32 v9, 0xffff0000, v7
    v_add_f32 v62, v62, v8
    v_add_f32 v63, v63, v9
    v_cvt_pk_bf16_f32 v7, v62, v63
    v_lshlrev_b32 v62, 16, v7
    v_and_b32 v63, 0xffff0000, v7
    v_mul_f32 v8, v52, v44
    v_mul_f32 v9, v52, v45
    v_cvt_pk_bf16_f32 v7, v8, v9
    v_lshlrev_b32 v8, 16, v7
    v_and_b32 v9, 0xffff0000, v7
    v_add_f32 v62, v62, v8
    v_add_f32 v63, v63, v9
    v_cvt_pk_bf16_f32 v7, v62, v63
    v_lshlrev_b32 v62, 16, v7
    v_and_b32 v63, 0xffff0000, v7
    v_mul_f32 v8, v51, v45
    v_mul_f32 v9, v51, v46
    v_cvt_pk_bf16_f32 v7, v8, v9
    v_lshlrev_b32 v8, 16, v7
    v_and_b32 v9, 0xffff0000, v7
    v_add_f32 v62, v62, v8
    v_add_f32 v63, v63, v9
    v_cvt_pk_bf16_f32 v7, v62, v63
    v_lshlrev_b32 v62, 16, v7
    v_and_b32 v63, 0xffff0000, v7
    v_mul_f32 v62, v62, v49
    v_mul_f32 v63, v63, v50
    v_cvt_pk_bf16_f32 v64, v63, v62
    v_cvt_pk_bf16_f32 v65, v61, v60
    ds_write_b64 v5, v[64:65] offset:272
    v_and_b32 v40, 0xffff0000, v11
    v_and_b32 v41, 0xffff0000, v13
    v_and_b32 v42, 0xffff0000, v15
    v_and_b32 v43, 0xffff0000, v17
    v_and_b32 v44, 0xffff0000, v19
    v_and_b32 v45, 0xffff0000, v21
    v_and_b32 v46, 0xffff0000, v23
    v_and_b32 v47, 0xffff0000, v25
    v_and_b32 v48, 0xffff0000, v27
    v_and_b32 v49, 0xffff0000, v29
    v_and_b32 v50, 0xffff0000, v31
    v_lshlrev_b32 v51, 16, v38
    v_and_b32 v52, 0xffff0000, v38
    v_lshlrev_b32 v53, 16, v39
    v_and_b32 v54, 0xffff0000, v39
    v_mul_f32 v60, v54, v40
    v_mul_f32 v61, v54, v41
    v_cvt_pk_bf16_f32 v7, v60, v61
    v_lshlrev_b32 v60, 16, v7
    v_and_b32 v61, 0xffff0000, v7
    v_mul_f32 v8, v53, v41
    v_mul_f32 v9, v53, v42
    v_cvt_pk_bf16_f32 v7, v8, v9
    v_lshlrev_b32 v8, 16, v7
    v_and_b32 v9, 0xffff0000, v7
    v_add_f32 v60, v60, v8
    v_add_f32 v61, v61, v9
    v_cvt_pk_bf16_f32 v7, v60, v61
    v_lshlrev_b32 v60, 16, v7
    v_and_b32 v61, 0xffff0000, v7
    v_mul_f32 v8, v52, v42
    v_mul_f32 v9, v52, v43
    v_cvt_pk_bf16_f32 v7, v8, v9
    v_lshlrev_b32 v8, 16, v7
    v_and_b32 v9, 0xffff0000, v7
    v_add_f32 v60, v60, v8
    v_add_f32 v61, v61, v9
    v_cvt_pk_bf16_f32 v7, v60, v61
    v_lshlrev_b32 v60, 16, v7
    v_and_b32 v61, 0xffff0000, v7
    v_mul_f32 v8, v51, v43
    v_mul_f32 v9, v51, v44
    v_cvt_pk_bf16_f32 v7, v8, v9
    v_lshlrev_b32 v8, 16, v7
    v_and_b32 v9, 0xffff0000, v7
    v_add_f32 v60, v60, v8
    v_add_f32 v61, v61, v9
    v_cvt_pk_bf16_f32 v7, v60, v61
    v_lshlrev_b32 v60, 16, v7
    v_and_b32 v61, 0xffff0000, v7
    v_mul_f32 v60, v60, v47
    v_mul_f32 v61, v61, v48
    v_mul_f32 v62, v54, v42
    v_mul_f32 v63, v54, v43
    v_cvt_pk_bf16_f32 v7, v62, v63
    v_lshlrev_b32 v62, 16, v7
    v_and_b32 v63, 0xffff0000, v7
    v_mul_f32 v8, v53, v43
    v_mul_f32 v9, v53, v44
    v_cvt_pk_bf16_f32 v7, v8, v9
    v_lshlrev_b32 v8, 16, v7
    v_and_b32 v9, 0xffff0000, v7
    v_add_f32 v62, v62, v8
    v_add_f32 v63, v63, v9
    v_cvt_pk_bf16_f32 v7, v62, v63
    v_lshlrev_b32 v62, 16, v7
    v_and_b32 v63, 0xffff0000, v7
    v_mul_f32 v8, v52, v44
    v_mul_f32 v9, v52, v45
    v_cvt_pk_bf16_f32 v7, v8, v9
    v_lshlrev_b32 v8, 16, v7
    v_and_b32 v9, 0xffff0000, v7
    v_add_f32 v62, v62, v8
    v_add_f32 v63, v63, v9
    v_cvt_pk_bf16_f32 v7, v62, v63
    v_lshlrev_b32 v62, 16, v7
    v_and_b32 v63, 0xffff0000, v7
    v_mul_f32 v8, v51, v45
    v_mul_f32 v9, v51, v46
    v_cvt_pk_bf16_f32 v7, v8, v9
    v_lshlrev_b32 v8, 16, v7
    v_and_b32 v9, 0xffff0000, v7
    v_add_f32 v62, v62, v8
    v_add_f32 v63, v63, v9
    v_cvt_pk_bf16_f32 v7, v62, v63
    v_lshlrev_b32 v62, 16, v7
    v_and_b32 v63, 0xffff0000, v7
    v_mul_f32 v62, v62, v49
    v_mul_f32 v63, v63, v50
    v_cvt_pk_bf16_f32 v64, v63, v62
    v_cvt_pk_bf16_f32 v65, v61, v60
    ds_write_b64 v5, v[64:65] offset:408
    s_waitcnt lgkmcnt(0)
    s_barrier
    v_lshrrev_b32 v1, 3, v0
    v_and_b32 v2, 7, v0
    v_mul_u32_u24 v5, 136, v1
    v_lshl_add_u32 v5, v2, 4, v5
    s_lshl_b32 s62, s61, 6
    v_add_u32 v3, s62, v1
    v_lshlrev_b32 v3, 12, v3
    s_lshl_b32 s62, s60, 7
    v_add_u32 v3, s62, v3
    v_lshl_add_u32 v3, v2, 4, v3
    ds_read_b64 v[8:9], v5 offset:0
    ds_read_b64 v[10:11], v5 offset:8
    s_waitcnt lgkmcnt(0)
    s_mov_b32 s62, 0
    buffer_store_dwordx4 v[8:11], v3, s[56:59], s62 offen
    s_nop 1
    ds_read_b64 v[8:9], v5 offset:4352
    ds_read_b64 v[10:11], v5 offset:4360
    s_waitcnt lgkmcnt(0)
    s_mov_b32 s62, 131072
    buffer_store_dwordx4 v[8:11], v3, s[56:59], s62 offen
    s_nop 1
KVT_END:
    s_endpgm
.globl conv_kernel
.p2align 8
.type conv_kernel,@function
conv_kernel:
    s_cmp_ge_u32 s2, 160
    s_cbranch_scc1 CONV_END
    s_load_dwordx4 s[4:7], s[0:1], 8
    s_load_dwordx4 s[8:11], s[0:1], 24
    s_load_dwordx2 s[12:13], s[0:1], 40
    s_load_dwordx2 s[14:15], s[0:1], 96
    s_lshl_b32 s3, s2, 2
    s_waitcnt lgkmcnt(0)
    s_lshl_b32 s60, s3, 3
    s_add_u32 s8, s8, s60
    s_addc_u32 s9, s9, 0
    s_lshl_b32 s60, s3, 1
    s_add_u32 s12, s12, s60
    s_addc_u32 s13, s13, 0
    s_load_dwordx8 s[32:39], s[8:9], 0
    s_load_dwordx2 s[30:31], s[12:13], 0
    s_add_u32 s16, s14, 17563648
    s_addc_u32 s17, s15, 0
    s_mov_b32 s18, 2621440
    s_mov_b32 s19, 0x00020000
    s_mov_b32 s24, s10
    s_mov_b32 s25, s11
    s_mov_b32 s26, 2621440
    s_mov_b32 s27, 0x00020000
    s_mov_b32 s56, s14
    s_mov_b32 s57, s15
    s_mov_b32 s58, 2621440
    s_mov_b32 s59, 0x00020000
    v_lshlrev_b32 v3, 4, v0
    s_lshl_b32 s60, s3, 12
    buffer_load_dwordx4 v[48:51], v3, s[24:27], s60 offen
    buffer_load_dwordx4 v[32:35], v3, s[16:19], s60 offen
    s_add_u32 s60, s60, 4096
    buffer_load_dwordx4 v[52:55], v3, s[24:27], s60 offen
    buffer_load_dwordx4 v[36:39], v3, s[16:19], s60 offen
    s_add_u32 s60, s60, 4096
    buffer_load_dwordx4 v[56:59], v3, s[24:27], s60 offen
    buffer_load_dwordx4 v[40:43], v3, s[16:19], s60 offen
    s_add_u32 s60, s60, 4096
    buffer_load_dwordx4 v[60:63], v3, s[24:27], s60 offen
    buffer_load_dwordx4 v[44:47], v3, s[16:19], s60 offen
    s_add_u32 s60, s60, 4096
    v_mov_b32 v64, 0
    v_mov_b32 v65, 0
    v_mov_b32 v66, 0
    v_mov_b32 v67, 0
    v_add_u32 v7, 67584, v3
    ds_write_b128 v7, v[64:67]
    ds_write_b128 v7, v[64:67] offset:1024
    v_add_u32 v7, 77824, v3
    ds_write_b128 v7, v[64:67]
    ds_write_b128 v7, v[64:67] offset:1024
    v_add_u32 v7, 88064, v3
    ds_write_b128 v7, v[64:67]
    ds_write_b128 v7, v[64:67] offset:1024
    v_add_u32 v7, 98304, v3
    ds_write_b128 v7, v[64:67]
    ds_write_b128 v7, v[64:67] offset:1024
    v_and_b32 v4, 3, v0
    v_lshlrev_b32 v4, 4, v4
    ds_write_b128 v4, v[64:67] offset:0
    ds_write_b128 v4, v[64:67] offset:4224
    ds_write_b128 v4, v[64:67] offset:8448
    ds_write_b128 v4, v[64:67] offset:12672
    ds_write_b128 v4, v[64:67] offset:16896
    ds_write_b128 v4, v[64:67] offset:21120
    ds_write_b128 v4, v[64:67] offset:25344
    ds_write_b128 v4, v[64:67] offset:29568
    ds_write_b128 v4, v[64:67] offset:33792
    ds_write_b128 v4, v[64:67] offset:38016
    ds_write_b128 v4, v[64:67] offset:42240
    ds_write_b128 v4, v[64:67] offset:46464
    ds_write_b128 v4, v[64:67] offset:50688
    ds_write_b128 v4, v[64:67] offset:54912
    ds_write_b128 v4, v[64:67] offset:59136
    ds_write_b128 v4, v[64:67] offset:63360
    s_waitcnt lgkmcnt(0)
    s_barrier
    s_lshl_b32 s64, s30, 16
    s_and_b32 s65, s30, 0xffff0000
    s_lshl_b32 s66, s31, 16
    s_and_b32 s67, s31, 0xffff0000
    v_lshrrev_b32 v31, 2, v0
    v_mul_u32_u24 v31, 80, v31
    v_and_b32 v30, 3, v0
    v_lshl_add_u32 v31, v30, 4, v31
    s_waitcnt vmcnt(0)
    ds_write_b128 v3, v[48:51] offset:64
    ds_write_b128 v3, v[48:51] offset:4286
    ds_write_b128 v3, v[48:51] offset:8508
    ds_write_b128 v3, v[48:51] offset:12730
    v_add_u32 v7, 72704, v31
    ds_write_b128 v7, v[32:35]
    ds_write_b128 v3, v[52:55] offset:16960
    ds_write_b128 v3, v[52:55] offset:21182
    ds_write_b128 v3, v[52:55] offset:25404
    ds_write_b128 v3, v[52:55] offset:29626
    v_add_u32 v7, 82944, v31
    ds_write_b128 v7, v[36:39]
    ds_write_b128 v3, v[56:59] offset:33856
    ds_write_b128 v3, v[56:59] offset:38078
    ds_write_b128 v3, v[56:59] offset:42300
    ds_write_b128 v3, v[56:59] offset:46522
    v_add_u32 v7, 93184, v31
    ds_write_b128 v7, v[40:43]
    ds_write_b128 v3, v[60:63] offset:50752
    ds_write_b128 v3, v[60:63] offset:54974
    ds_write_b128 v3, v[60:63] offset:59196
    ds_write_b128 v3, v[60:63] offset:63418
    v_add_u32 v7, 103424, v31
    ds_write_b128 v7, v[44:47]
    v_lshrrev_b32 v1, 6, v0
    v_and_b32 v2, 31, v0
    v_bfe_u32 v3, v0, 5, 1
    v_mul_u32_u24 v4, 16896, v1
    v_lshlrev_b32 v5, 1, v2
    v_add_u32 v4, v4, v5
    v_lshlrev_b32 v5, 4, v3
    v_sub_u32 v4, v4, v5
    v_add_u32 v4, 18, v4
    v_add_u32 v7, 1, v2
    v_and_b32 v7, 3, v7
    v_mul_u32_u24 v7, 4222, v7
    v_add_u32 v4, v4, v7
    v_mul_u32_u24 v5, 10240, v1
    v_mul_u32_u24 v6, 80, v2
    v_add_u32 v5, v5, v6
    v_lshlrev_b32 v6, 4, v3
    v_add_u32 v5, v5, v6
    v_add_u32 v5, 67664, v5
    v_lshlrev_b32 v6, 1, v1
    v_lshlrev_b32 v7, 8, v2
    v_add_u32 v6, v6, v7
    v_lshlrev_b32 v7, 5, v3
    v_add_u32 v6, v6, v7
    v_add_u32 v6, 108544, v6
    v_mov_b32 v64, 0
    v_mov_b32 v65, 0
    v_mov_b32 v66, 0
    v_mov_b32 v67, 0
    v_mov_b32 v68, 0
    v_mov_b32 v69, 0
    v_mov_b32 v70, 0
    v_mov_b32 v71, 0
    v_mov_b32 v72, 0
    v_mov_b32 v73, 0
    v_mov_b32 v74, 0
    v_mov_b32 v75, 0
    v_mov_b32 v76, 0
    v_mov_b32 v77, 0
    v_mov_b32 v78, 0
    v_mov_b32 v79, 0
    v_mov_b32 v80, 0
    v_mov_b32 v81, 0
    v_mov_b32 v82, 0
    v_mov_b32 v83, 0
    v_mov_b32 v84, 0
    v_mov_b32 v85, 0
    v_mov_b32 v86, 0
    v_mov_b32 v87, 0
    v_mov_b32 v88, 0
    v_mov_b32 v89, 0
    v_mov_b32 v90, 0
    v_mov_b32 v91, 0
    v_mov_b32 v92, 0
    v_mov_b32 v93, 0
    v_mov_b32 v94, 0
    v_mov_b32 v95, 0
    s_waitcnt lgkmcnt(0)
    s_barrier
    ds_read_b64 v[8:9], v4 offset:32
    ds_read_b64 v[10:11], v4 offset:40
    ds_read_b64 v[12:13], v4 offset:0
    ds_read_b64 v[14:15], v4 offset:8
    ds_read_b128 v[16:19], v5 offset:5040
    ds_read_b128 v[20:23], v5 offset:5072
    ds_read_b128 v[24:27], v5 offset:7600
    ds_read_b128 v[28:31], v5 offset:7632
    ds_read_b64 v[32:33], v4 offset:96
    ds_read_b64 v[34:35], v4 offset:104
    ds_read_b64 v[36:37], v4 offset:64
    ds_read_b64 v[38:39], v4 offset:72
    ds_read_b128 v[40:43], v5 offset:4960
    ds_read_b128 v[44:47], v5 offset:4992
    ds_read_b128 v[48:51], v5 offset:7520
    ds_read_b128 v[52:55], v5 offset:7552
    s_waitcnt lgkmcnt(8)
    v_mfma_f32_32x32x16_bf16 v[64:79], v[8:11], v[16:19], v[64:79]
    v_mfma_f32_32x32x16_bf16 v[80:95], v[8:11], v[24:27], v[80:95]
    v_mfma_f32_32x32x16_bf16 v[64:79], v[12:15], v[20:23], v[64:79]
    v_mfma_f32_32x32x16_bf16 v[80:95], v[12:15], v[28:31], v[80:95]
    ds_read_b64 v[8:9], v4 offset:160
    ds_read_b64 v[10:11], v4 offset:168
    ds_read_b64 v[12:13], v4 offset:128
    ds_read_b64 v[14:15], v4 offset:136
    ds_read_b128 v[16:19], v5 offset:4880
    ds_read_b128 v[20:23], v5 offset:4912
    ds_read_b128 v[24:27], v5 offset:7440
    ds_read_b128 v[28:31], v5 offset:7472
    s_waitcnt lgkmcnt(8)
    v_mfma_f32_32x32x16_bf16 v[64:79], v[32:35], v[40:43], v[64:79]
    v_mfma_f32_32x32x16_bf16 v[80:95], v[32:35], v[48:51], v[80:95]
    v_mfma_f32_32x32x16_bf16 v[64:79], v[36:39], v[44:47], v[64:79]
    v_mfma_f32_32x32x16_bf16 v[80:95], v[36:39], v[52:55], v[80:95]
    ds_read_b64 v[32:33], v4 offset:224
    ds_read_b64 v[34:35], v4 offset:232
    ds_read_b64 v[36:37], v4 offset:192
    ds_read_b64 v[38:39], v4 offset:200
    ds_read_b128 v[40:43], v5 offset:4800
    ds_read_b128 v[44:47], v5 offset:4832
    ds_read_b128 v[48:51], v5 offset:7360
    ds_read_b128 v[52:55], v5 offset:7392
    s_waitcnt lgkmcnt(8)
    v_mfma_f32_32x32x16_bf16 v[64:79], v[8:11], v[16:19], v[64:79]
    v_mfma_f32_32x32x16_bf16 v[80:95], v[8:11], v[24:27], v[80:95]
    v_mfma_f32_32x32x16_bf16 v[64:79], v[12:15], v[20:23], v[64:79]
    v_mfma_f32_32x32x16_bf16 v[80:95], v[12:15], v[28:31], v[80:95]
    ds_read_b64 v[8:9], v4 offset:288
    ds_read_b64 v[10:11], v4 offset:296
    ds_read_b64 v[12:13], v4 offset:256
    ds_read_b64 v[14:15], v4 offset:264
    ds_read_b128 v[16:19], v5 offset:4720
    ds_read_b128 v[20:23], v5 offset:4752
    ds_read_b128 v[24:27], v5 offset:7280
    ds_read_b128 v[28:31], v5 offset:7312
    s_waitcnt lgkmcnt(8)
    v_mfma_f32_32x32x16_bf16 v[64:79], v[32:35], v[40:43], v[64:79]
    v_mfma_f32_32x32x16_bf16 v[80:95], v[32:35], v[48:51], v[80:95]
    v_mfma_f32_32x32x16_bf16 v[64:79], v[36:39], v[44:47], v[64:79]
    v_mfma_f32_32x32x16_bf16 v[80:95], v[36:39], v[52:55], v[80:95]
    ds_read_b64 v[32:33], v4 offset:352
    ds_read_b64 v[34:35], v4 offset:360
    ds_read_b64 v[36:37], v4 offset:320
    ds_read_b64 v[38:39], v4 offset:328
    ds_read_b128 v[40:43], v5 offset:4640
    ds_read_b128 v[44:47], v5 offset:4672
    ds_read_b128 v[48:51], v5 offset:7200
    ds_read_b128 v[52:55], v5 offset:7232
    s_waitcnt lgkmcnt(8)
    v_mfma_f32_32x32x16_bf16 v[64:79], v[8:11], v[16:19], v[64:79]
    v_mfma_f32_32x32x16_bf16 v[80:95], v[8:11], v[24:27], v[80:95]
    v_mfma_f32_32x32x16_bf16 v[64:79], v[12:15], v[20:23], v[64:79]
    v_mfma_f32_32x32x16_bf16 v[80:95], v[12:15], v[28:31], v[80:95]
    ds_read_b64 v[8:9], v4 offset:416
    ds_read_b64 v[10:11], v4 offset:424
    ds_read_b64 v[12:13], v4 offset:384
    ds_read_b64 v[14:15], v4 offset:392
    ds_read_b128 v[16:19], v5 offset:4560
    ds_read_b128 v[20:23], v5 offset:4592
    ds_read_b128 v[24:27], v5 offset:7120
    ds_read_b128 v[28:31], v5 offset:7152
    s_waitcnt lgkmcnt(8)
    v_mfma_f32_32x32x16_bf16 v[64:79], v[32:35], v[40:43], v[64:79]
    v_mfma_f32_32x32x16_bf16 v[80:95], v[32:35], v[48:51], v[80:95]
    v_mfma_f32_32x32x16_bf16 v[64:79], v[36:39], v[44:47], v[64:79]
    v_mfma_f32_32x32x16_bf16 v[80:95], v[36:39], v[52:55], v[80:95]
    ds_read_b64 v[32:33], v4 offset:480
    ds_read_b64 v[34:35], v4 offset:488
    ds_read_b64 v[36:37], v4 offset:448
    ds_read_b64 v[38:39], v4 offset:456
    ds_read_b128 v[40:43], v5 offset:4480
    ds_read_b128 v[44:47], v5 offset:4512
    ds_read_b128 v[48:51], v5 offset:7040
    ds_read_b128 v[52:55], v5 offset:7072
    s_waitcnt lgkmcnt(8)
    v_mfma_f32_32x32x16_bf16 v[64:79], v[8:11], v[16:19], v[64:79]
    v_mfma_f32_32x32x16_bf16 v[80:95], v[8:11], v[24:27], v[80:95]
    v_mfma_f32_32x32x16_bf16 v[64:79], v[12:15], v[20:23], v[64:79]
    v_mfma_f32_32x32x16_bf16 v[80:95], v[12:15], v[28:31], v[80:95]
    ds_read_b64 v[8:9], v4 offset:544
    ds_read_b64 v[10:11], v4 offset:552
    ds_read_b64 v[12:13], v4 offset:512
    ds_read_b64 v[14:15], v4 offset:520
    ds_read_b128 v[16:19], v5 offset:4400
    ds_read_b128 v[20:23], v5 offset:4432
    ds_read_b128 v[24:27], v5 offset:6960
    ds_read_b128 v[28:31], v5 offset:6992
    s_waitcnt lgkmcnt(8)
    v_mfma_f32_32x32x16_bf16 v[64:79], v[32:35], v[40:43], v[64:79]
    v_mfma_f32_32x32x16_bf16 v[80:95], v[32:35], v[48:51], v[80:95]
    v_mfma_f32_32x32x16_bf16 v[64:79], v[36:39], v[44:47], v[64:79]
    v_mfma_f32_32x32x16_bf16 v[80:95], v[36:39], v[52:55], v[80:95]
    ds_read_b64 v[32:33], v4 offset:608
    ds_read_b64 v[34:35], v4 offset:616
    ds_read_b64 v[36:37], v4 offset:576
    ds_read_b64 v[38:39], v4 offset:584
    ds_read_b128 v[40:43], v5 offset:4320
    ds_read_b128 v[44:47], v5 offset:4352
    ds_read_b128 v[48:51], v5 offset:6880
    ds_read_b128 v[52:55], v5 offset:6912
    s_waitcnt lgkmcnt(8)
    v_mfma_f32_32x32x16_bf16 v[64:79], v[8:11], v[16:19], v[64:79]
    v_mfma_f32_32x32x16_bf16 v[80:95], v[8:11], v[24:27], v[80:95]
    v_mfma_f32_32x32x16_bf16 v[64:79], v[12:15], v[20:23], v[64:79]
    v_mfma_f32_32x32x16_bf16 v[80:95], v[12:15], v[28:31], v[80:95]
    ds_read_b64 v[8:9], v4 offset:672
    ds_read_b64 v[10:11], v4 offset:680
    ds_read_b64 v[12:13], v4 offset:640
    ds_read_b64 v[14:15], v4 offset:648
    ds_read_b128 v[16:19], v5 offset:4240
    ds_read_b128 v[20:23], v5 offset:4272
    ds_read_b128 v[24:27], v5 offset:6800
    ds_read_b128 v[28:31], v5 offset:6832
    s_waitcnt lgkmcnt(8)
    v_mfma_f32_32x32x16_bf16 v[64:79], v[32:35], v[40:43], v[64:79]
    v_mfma_f32_32x32x16_bf16 v[80:95], v[32:35], v[48:51], v[80:95]
    v_mfma_f32_32x32x16_bf16 v[64:79], v[36:39], v[44:47], v[64:79]
    v_mfma_f32_32x32x16_bf16 v[80:95], v[36:39], v[52:55], v[80:95]
    ds_read_b64 v[32:33], v4 offset:736
    ds_read_b64 v[34:35], v4 offset:744
    ds_read_b64 v[36:37], v4 offset:704
    ds_read_b64 v[38:39], v4 offset:712
    ds_read_b128 v[40:43], v5 offset:4160
    ds_read_b128 v[44:47], v5 offset:4192
    ds_read_b128 v[48:51], v5 offset:6720
    ds_read_b128 v[52:55], v5 offset:6752
    s_waitcnt lgkmcnt(8)
    v_mfma_f32_32x32x16_bf16 v[64:79], v[8:11], v[16:19], v[64:79]
    v_mfma_f32_32x32x16_bf16 v[80:95], v[8:11], v[24:27], v[80:95]
    v_mfma_f32_32x32x16_bf16 v[64:79], v[12:15], v[20:23], v[64:79]
    v_mfma_f32_32x32x16_bf16 v[80:95], v[12:15], v[28:31], v[80:95]
    ds_read_b64 v[8:9], v4 offset:800
    ds_read_b64 v[10:11], v4 offset:808
    ds_read_b64 v[12:13], v4 offset:768
    ds_read_b64 v[14:15], v4 offset:776
    ds_read_b128 v[16:19], v5 offset:4080
    ds_read_b128 v[20:23], v5 offset:4112
    ds_read_b128 v[24:27], v5 offset:6640
    ds_read_b128 v[28:31], v5 offset:6672
    s_waitcnt lgkmcnt(8)
    v_mfma_f32_32x32x16_bf16 v[64:79], v[32:35], v[40:43], v[64:79]
    v_mfma_f32_32x32x16_bf16 v[80:95], v[32:35], v[48:51], v[80:95]
    v_mfma_f32_32x32x16_bf16 v[64:79], v[36:39], v[44:47], v[64:79]
    v_mfma_f32_32x32x16_bf16 v[80:95], v[36:39], v[52:55], v[80:95]
    ds_read_b64 v[32:33], v4 offset:864
    ds_read_b64 v[34:35], v4 offset:872
    ds_read_b64 v[36:37], v4 offset:832
    ds_read_b64 v[38:39], v4 offset:840
    ds_read_b128 v[40:43], v5 offset:4000
    ds_read_b128 v[44:47], v5 offset:4032
    ds_read_b128 v[48:51], v5 offset:6560
    ds_read_b128 v[52:55], v5 offset:6592
    s_waitcnt lgkmcnt(8)
    v_mfma_f32_32x32x16_bf16 v[64:79], v[8:11], v[16:19], v[64:79]
    v_mfma_f32_32x32x16_bf16 v[80:95], v[8:11], v[24:27], v[80:95]
    v_mfma_f32_32x32x16_bf16 v[64:79], v[12:15], v[20:23], v[64:79]
    v_mfma_f32_32x32x16_bf16 v[80:95], v[12:15], v[28:31], v[80:95]
    ds_read_b64 v[8:9], v4 offset:928
    ds_read_b64 v[10:11], v4 offset:936
    ds_read_b64 v[12:13], v4 offset:896
    ds_read_b64 v[14:15], v4 offset:904
    ds_read_b128 v[16:19], v5 offset:3920
    ds_read_b128 v[20:23], v5 offset:3952
    ds_read_b128 v[24:27], v5 offset:6480
    ds_read_b128 v[28:31], v5 offset:6512
    s_waitcnt lgkmcnt(8)
    v_mfma_f32_32x32x16_bf16 v[64:79], v[32:35], v[40:43], v[64:79]
    v_mfma_f32_32x32x16_bf16 v[80:95], v[32:35], v[48:51], v[80:95]
    v_mfma_f32_32x32x16_bf16 v[64:79], v[36:39], v[44:47], v[64:79]
    v_mfma_f32_32x32x16_bf16 v[80:95], v[36:39], v[52:55], v[80:95]
    ds_read_b64 v[32:33], v4 offset:992
    ds_read_b64 v[34:35], v4 offset:1000
    ds_read_b64 v[36:37], v4 offset:960
    ds_read_b64 v[38:39], v4 offset:968
    ds_read_b128 v[40:43], v5 offset:3840
    ds_read_b128 v[44:47], v5 offset:3872
    ds_read_b128 v[48:51], v5 offset:6400
    ds_read_b128 v[52:55], v5 offset:6432
    s_waitcnt lgkmcnt(8)
    v_mfma_f32_32x32x16_bf16 v[64:79], v[8:11], v[16:19], v[64:79]
    v_mfma_f32_32x32x16_bf16 v[80:95], v[8:11], v[24:27], v[80:95]
    v_mfma_f32_32x32x16_bf16 v[64:79], v[12:15], v[20:23], v[64:79]
    v_mfma_f32_32x32x16_bf16 v[80:95], v[12:15], v[28:31], v[80:95]
    ds_read_b64 v[8:9], v4 offset:1056
    ds_read_b64 v[10:11], v4 offset:1064
    ds_read_b64 v[12:13], v4 offset:1024
    ds_read_b64 v[14:15], v4 offset:1032
    ds_read_b128 v[16:19], v5 offset:3760
    ds_read_b128 v[20:23], v5 offset:3792
    ds_read_b128 v[24:27], v5 offset:6320
    ds_read_b128 v[28:31], v5 offset:6352
    s_waitcnt lgkmcnt(8)
    v_mfma_f32_32x32x16_bf16 v[64:79], v[32:35], v[40:43], v[64:79]
    v_mfma_f32_32x32x16_bf16 v[80:95], v[32:35], v[48:51], v[80:95]
    v_mfma_f32_32x32x16_bf16 v[64:79], v[36:39], v[44:47], v[64:79]
    v_mfma_f32_32x32x16_bf16 v[80:95], v[36:39], v[52:55], v[80:95]
    ds_read_b64 v[32:33], v4 offset:1120
    ds_read_b64 v[34:35], v4 offset:1128
    ds_read_b64 v[36:37], v4 offset:1088
    ds_read_b64 v[38:39], v4 offset:1096
    ds_read_b128 v[40:43], v5 offset:3680
    ds_read_b128 v[44:47], v5 offset:3712
    ds_read_b128 v[48:51], v5 offset:6240
    ds_read_b128 v[52:55], v5 offset:6272
    s_waitcnt lgkmcnt(8)
    v_mfma_f32_32x32x16_bf16 v[64:79], v[8:11], v[16:19], v[64:79]
    v_mfma_f32_32x32x16_bf16 v[80:95], v[8:11], v[24:27], v[80:95]
    v_mfma_f32_32x32x16_bf16 v[64:79], v[12:15], v[20:23], v[64:79]
    v_mfma_f32_32x32x16_bf16 v[80:95], v[12:15], v[28:31], v[80:95]
    ds_read_b64 v[8:9], v4 offset:1184
    ds_read_b64 v[10:11], v4 offset:1192
    ds_read_b64 v[12:13], v4 offset:1152
    ds_read_b64 v[14:15], v4 offset:1160
    ds_read_b128 v[16:19], v5 offset:3600
    ds_read_b128 v[20:23], v5 offset:3632
    ds_read_b128 v[24:27], v5 offset:6160
    ds_read_b128 v[28:31], v5 offset:6192
    s_waitcnt lgkmcnt(8)
    v_mfma_f32_32x32x16_bf16 v[64:79], v[32:35], v[40:43], v[64:79]
    v_mfma_f32_32x32x16_bf16 v[80:95], v[32:35], v[48:51], v[80:95]
    v_mfma_f32_32x32x16_bf16 v[64:79], v[36:39], v[44:47], v[64:79]
    v_mfma_f32_32x32x16_bf16 v[80:95], v[36:39], v[52:55], v[80:95]
    ds_read_b64 v[32:33], v4 offset:1248
    ds_read_b64 v[34:35], v4 offset:1256
    ds_read_b64 v[36:37], v4 offset:1216
    ds_read_b64 v[38:39], v4 offset:1224
    ds_read_b128 v[40:43], v5 offset:3520
    ds_read_b128 v[44:47], v5 offset:3552
    ds_read_b128 v[48:51], v5 offset:6080
    ds_read_b128 v[52:55], v5 offset:6112
    s_waitcnt lgkmcnt(8)
    v_mfma_f32_32x32x16_bf16 v[64:79], v[8:11], v[16:19], v[64:79]
    v_mfma_f32_32x32x16_bf16 v[80:95], v[8:11], v[24:27], v[80:95]
    v_mfma_f32_32x32x16_bf16 v[64:79], v[12:15], v[20:23], v[64:79]
    v_mfma_f32_32x32x16_bf16 v[80:95], v[12:15], v[28:31], v[80:95]
    ds_read_b64 v[8:9], v4 offset:1312
    ds_read_b64 v[10:11], v4 offset:1320
    ds_read_b64 v[12:13], v4 offset:1280
    ds_read_b64 v[14:15], v4 offset:1288
    ds_read_b128 v[16:19], v5 offset:3440
    ds_read_b128 v[20:23], v5 offset:3472
    ds_read_b128 v[24:27], v5 offset:6000
    ds_read_b128 v[28:31], v5 offset:6032
    s_waitcnt lgkmcnt(8)
    v_mfma_f32_32x32x16_bf16 v[64:79], v[32:35], v[40:43], v[64:79]
    v_mfma_f32_32x32x16_bf16 v[80:95], v[32:35], v[48:51], v[80:95]
    v_mfma_f32_32x32x16_bf16 v[64:79], v[36:39], v[44:47], v[64:79]
    v_mfma_f32_32x32x16_bf16 v[80:95], v[36:39], v[52:55], v[80:95]
    ds_read_b64 v[32:33], v4 offset:1376
    ds_read_b64 v[34:35], v4 offset:1384
    ds_read_b64 v[36:37], v4 offset:1344
    ds_read_b64 v[38:39], v4 offset:1352
    ds_read_b128 v[40:43], v5 offset:3360
    ds_read_b128 v[44:47], v5 offset:3392
    ds_read_b128 v[48:51], v5 offset:5920
    ds_read_b128 v[52:55], v5 offset:5952
    s_waitcnt lgkmcnt(8)
    v_mfma_f32_32x32x16_bf16 v[64:79], v[8:11], v[16:19], v[64:79]
    v_mfma_f32_32x32x16_bf16 v[80:95], v[8:11], v[24:27], v[80:95]
    v_mfma_f32_32x32x16_bf16 v[64:79], v[12:15], v[20:23], v[64:79]
    v_mfma_f32_32x32x16_bf16 v[80:95], v[12:15], v[28:31], v[80:95]
    ds_read_b64 v[8:9], v4 offset:1440
    ds_read_b64 v[10:11], v4 offset:1448
    ds_read_b64 v[12:13], v4 offset:1408
    ds_read_b64 v[14:15], v4 offset:1416
    ds_read_b128 v[16:19], v5 offset:3280
    ds_read_b128 v[20:23], v5 offset:3312
    ds_read_b128 v[24:27], v5 offset:5840
    ds_read_b128 v[28:31], v5 offset:5872
    s_waitcnt lgkmcnt(8)
    v_mfma_f32_32x32x16_bf16 v[64:79], v[32:35], v[40:43], v[64:79]
    v_mfma_f32_32x32x16_bf16 v[80:95], v[32:35], v[48:51], v[80:95]
    v_mfma_f32_32x32x16_bf16 v[64:79], v[36:39], v[44:47], v[64:79]
    v_mfma_f32_32x32x16_bf16 v[80:95], v[36:39], v[52:55], v[80:95]
    ds_read_b64 v[32:33], v4 offset:1504
    ds_read_b64 v[34:35], v4 offset:1512
    ds_read_b64 v[36:37], v4 offset:1472
    ds_read_b64 v[38:39], v4 offset:1480
    ds_read_b128 v[40:43], v5 offset:3200
    ds_read_b128 v[44:47], v5 offset:3232
    ds_read_b128 v[48:51], v5 offset:5760
    ds_read_b128 v[52:55], v5 offset:5792
    s_waitcnt lgkmcnt(8)
    v_mfma_f32_32x32x16_bf16 v[64:79], v[8:11], v[16:19], v[64:79]
    v_mfma_f32_32x32x16_bf16 v[80:95], v[8:11], v[24:27], v[80:95]
    v_mfma_f32_32x32x16_bf16 v[64:79], v[12:15], v[20:23], v[64:79]
    v_mfma_f32_32x32x16_bf16 v[80:95], v[12:15], v[28:31], v[80:95]
    ds_read_b64 v[8:9], v4 offset:1568
    ds_read_b64 v[10:11], v4 offset:1576
    ds_read_b64 v[12:13], v4 offset:1536
    ds_read_b64 v[14:15], v4 offset:1544
    ds_read_b128 v[16:19], v5 offset:3120
    ds_read_b128 v[20:23], v5 offset:3152
    ds_read_b128 v[24:27], v5 offset:5680
    ds_read_b128 v[28:31], v5 offset:5712
    s_waitcnt lgkmcnt(8)
    v_mfma_f32_32x32x16_bf16 v[64:79], v[32:35], v[40:43], v[64:79]
    v_mfma_f32_32x32x16_bf16 v[80:95], v[32:35], v[48:51], v[80:95]
    v_mfma_f32_32x32x16_bf16 v[64:79], v[36:39], v[44:47], v[64:79]
    v_mfma_f32_32x32x16_bf16 v[80:95], v[36:39], v[52:55], v[80:95]
    ds_read_b64 v[32:33], v4 offset:1632
    ds_read_b64 v[34:35], v4 offset:1640
    ds_read_b64 v[36:37], v4 offset:1600
    ds_read_b64 v[38:39], v4 offset:1608
    ds_read_b128 v[40:43], v5 offset:3040
    ds_read_b128 v[44:47], v5 offset:3072
    ds_read_b128 v[48:51], v5 offset:5600
    ds_read_b128 v[52:55], v5 offset:5632
    s_waitcnt lgkmcnt(8)
    v_mfma_f32_32x32x16_bf16 v[64:79], v[8:11], v[16:19], v[64:79]
    v_mfma_f32_32x32x16_bf16 v[80:95], v[8:11], v[24:27], v[80:95]
    v_mfma_f32_32x32x16_bf16 v[64:79], v[12:15], v[20:23], v[64:79]
    v_mfma_f32_32x32x16_bf16 v[80:95], v[12:15], v[28:31], v[80:95]
    ds_read_b64 v[8:9], v4 offset:1696
    ds_read_b64 v[10:11], v4 offset:1704
    ds_read_b64 v[12:13], v4 offset:1664
    ds_read_b64 v[14:15], v4 offset:1672
    ds_read_b128 v[16:19], v5 offset:2960
    ds_read_b128 v[20:23], v5 offset:2992
    ds_read_b128 v[24:27], v5 offset:5520
    ds_read_b128 v[28:31], v5 offset:5552
    s_waitcnt lgkmcnt(8)
    v_mfma_f32_32x32x16_bf16 v[64:79], v[32:35], v[40:43], v[64:79]
    v_mfma_f32_32x32x16_bf16 v[80:95], v[32:35], v[48:51], v[80:95]
    v_mfma_f32_32x32x16_bf16 v[64:79], v[36:39], v[44:47], v[64:79]
    v_mfma_f32_32x32x16_bf16 v[80:95], v[36:39], v[52:55], v[80:95]
    ds_read_b64 v[32:33], v4 offset:1760
    ds_read_b64 v[34:35], v4 offset:1768
    ds_read_b64 v[36:37], v4 offset:1728
    ds_read_b64 v[38:39], v4 offset:1736
    ds_read_b128 v[40:43], v5 offset:2880
    ds_read_b128 v[44:47], v5 offset:2912
    ds_read_b128 v[48:51], v5 offset:5440
    ds_read_b128 v[52:55], v5 offset:5472
    s_waitcnt lgkmcnt(8)
    v_mfma_f32_32x32x16_bf16 v[64:79], v[8:11], v[16:19], v[64:79]
    v_mfma_f32_32x32x16_bf16 v[80:95], v[8:11], v[24:27], v[80:95]
    v_mfma_f32_32x32x16_bf16 v[64:79], v[12:15], v[20:23], v[64:79]
    v_mfma_f32_32x32x16_bf16 v[80:95], v[12:15], v[28:31], v[80:95]
    ds_read_b64 v[8:9], v4 offset:1824
    ds_read_b64 v[10:11], v4 offset:1832
    ds_read_b64 v[12:13], v4 offset:1792
    ds_read_b64 v[14:15], v4 offset:1800
    ds_read_b128 v[16:19], v5 offset:2800
    ds_read_b128 v[20:23], v5 offset:2832
    ds_read_b128 v[24:27], v5 offset:5360
    ds_read_b128 v[28:31], v5 offset:5392
    s_waitcnt lgkmcnt(8)
    v_mfma_f32_32x32x16_bf16 v[64:79], v[32:35], v[40:43], v[64:79]
    v_mfma_f32_32x32x16_bf16 v[80:95], v[32:35], v[48:51], v[80:95]
    v_mfma_f32_32x32x16_bf16 v[64:79], v[36:39], v[44:47], v[64:79]
    v_mfma_f32_32x32x16_bf16 v[80:95], v[36:39], v[52:55], v[80:95]
    ds_read_b64 v[32:33], v4 offset:1888
    ds_read_b64 v[34:35], v4 offset:1896
    ds_read_b64 v[36:37], v4 offset:1856
    ds_read_b64 v[38:39], v4 offset:1864
    ds_read_b128 v[40:43], v5 offset:2720
    ds_read_b128 v[44:47], v5 offset:2752
    ds_read_b128 v[48:51], v5 offset:5280
    ds_read_b128 v[52:55], v5 offset:5312
    s_waitcnt lgkmcnt(8)
    v_mfma_f32_32x32x16_bf16 v[64:79], v[8:11], v[16:19], v[64:79]
    v_mfma_f32_32x32x16_bf16 v[80:95], v[8:11], v[24:27], v[80:95]
    v_mfma_f32_32x32x16_bf16 v[64:79], v[12:15], v[20:23], v[64:79]
    v_mfma_f32_32x32x16_bf16 v[80:95], v[12:15], v[28:31], v[80:95]
    ds_read_b64 v[8:9], v4 offset:1952
    ds_read_b64 v[10:11], v4 offset:1960
    ds_read_b64 v[12:13], v4 offset:1920
    ds_read_b64 v[14:15], v4 offset:1928
    ds_read_b128 v[16:19], v5 offset:2640
    ds_read_b128 v[20:23], v5 offset:2672
    ds_read_b128 v[24:27], v5 offset:5200
    ds_read_b128 v[28:31], v5 offset:5232
    s_waitcnt lgkmcnt(8)
    v_mfma_f32_32x32x16_bf16 v[64:79], v[32:35], v[40:43], v[64:79]
    v_mfma_f32_32x32x16_bf16 v[80:95], v[32:35], v[48:51], v[80:95]
    v_mfma_f32_32x32x16_bf16 v[64:79], v[36:39], v[44:47], v[64:79]
    v_mfma_f32_32x32x16_bf16 v[80:95], v[36:39], v[52:55], v[80:95]
    ds_read_b64 v[32:33], v4 offset:2016
    ds_read_b64 v[34:35], v4 offset:2024
    ds_read_b64 v[36:37], v4 offset:1984
    ds_read_b64 v[38:39], v4 offset:1992
    ds_read_b128 v[40:43], v5 offset:2560
    ds_read_b128 v[44:47], v5 offset:2592
    ds_read_b128 v[48:51], v5 offset:5120
    ds_read_b128 v[52:55], v5 offset:5152
    s_waitcnt lgkmcnt(8)
    v_mfma_f32_32x32x16_bf16 v[64:79], v[8:11], v[16:19], v[64:79]
    v_mfma_f32_32x32x16_bf16 v[80:95], v[8:11], v[24:27], v[80:95]
    v_mfma_f32_32x32x16_bf16 v[64:79], v[12:15], v[20:23], v[64:79]
    v_mfma_f32_32x32x16_bf16 v[80:95], v[12:15], v[28:31], v[80:95]
    ds_read_b64 v[8:9], v4 offset:2080
    ds_read_b64 v[10:11], v4 offset:2088
    ds_read_b64 v[12:13], v4 offset:2048
    ds_read_b64 v[14:15], v4 offset:2056
    ds_read_b128 v[24:27], v5 offset:5040
    ds_read_b128 v[28:31], v5 offset:5072
    s_waitcnt lgkmcnt(6)
    v_mfma_f32_32x32x16_bf16 v[64:79], v[32:35], v[40:43], v[64:79]
    v_mfma_f32_32x32x16_bf16 v[80:95], v[32:35], v[48:51], v[80:95]
    v_mfma_f32_32x32x16_bf16 v[64:79], v[36:39], v[44:47], v[64:79]
    v_mfma_f32_32x32x16_bf16 v[80:95], v[36:39], v[52:55], v[80:95]
    ds_read_b64 v[32:33], v4 offset:2144
    ds_read_b64 v[34:35], v4 offset:2152
    ds_read_b64 v[36:37], v4 offset:2112
    ds_read_b64 v[38:39], v4 offset:2120
    ds_read_b128 v[48:51], v5 offset:4960
    ds_read_b128 v[52:55], v5 offset:4992
    s_waitcnt lgkmcnt(6)
    v_mfma_f32_32x32x16_bf16 v[80:95], v[8:11], v[24:27], v[80:95]
    v_mfma_f32_32x32x16_bf16 v[80:95], v[12:15], v[28:31], v[80:95]
    ds_read_b64 v[8:9], v4 offset:2208
    ds_read_b64 v[10:11], v4 offset:2216
    ds_read_b64 v[12:13], v4 offset:2176
    ds_read_b64 v[14:15], v4 offset:2184
    ds_read_b128 v[24:27], v5 offset:4880
    ds_read_b128 v[28:31], v5 offset:4912
    s_waitcnt lgkmcnt(6)
    v_mfma_f32_32x32x16_bf16 v[80:95], v[32:35], v[48:51], v[80:95]
    v_mfma_f32_32x32x16_bf16 v[80:95], v[36:39], v[52:55], v[80:95]
    ds_read_b64 v[32:33], v4 offset:2272
    ds_read_b64 v[34:35], v4 offset:2280
    ds_read_b64 v[36:37], v4 offset:2240
    ds_read_b64 v[38:39], v4 offset:2248
    ds_read_b128 v[48:51], v5 offset:4800
    ds_read_b128 v[52:55], v5 offset:4832
    s_waitcnt lgkmcnt(6)
    v_mfma_f32_32x32x16_bf16 v[80:95], v[8:11], v[24:27], v[80:95]
    v_mfma_f32_32x32x16_bf16 v[80:95], v[12:15], v[28:31], v[80:95]
    ds_read_b64 v[8:9], v4 offset:2336
    ds_read_b64 v[10:11], v4 offset:2344
    ds_read_b64 v[12:13], v4 offset:2304
    ds_read_b64 v[14:15], v4 offset:2312
    ds_read_b128 v[24:27], v5 offset:4720
    ds_read_b128 v[28:31], v5 offset:4752
    s_waitcnt lgkmcnt(6)
    v_mfma_f32_32x32x16_bf16 v[80:95], v[32:35], v[48:51], v[80:95]
    v_mfma_f32_32x32x16_bf16 v[80:95], v[36:39], v[52:55], v[80:95]
    ds_read_b64 v[32:33], v4 offset:2400
    ds_read_b64 v[34:35], v4 offset:2408
    ds_read_b64 v[36:37], v4 offset:2368
    ds_read_b64 v[38:39], v4 offset:2376
    ds_read_b128 v[48:51], v5 offset:4640
    ds_read_b128 v[52:55], v5 offset:4672
    s_waitcnt lgkmcnt(6)
    v_mfma_f32_32x32x16_bf16 v[80:95], v[8:11], v[24:27], v[80:95]
    v_mfma_f32_32x32x16_bf16 v[80:95], v[12:15], v[28:31], v[80:95]
    ds_read_b64 v[8:9], v4 offset:2464
    ds_read_b64 v[10:11], v4 offset:2472
    ds_read_b64 v[12:13], v4 offset:2432
    ds_read_b64 v[14:15], v4 offset:2440
    ds_read_b128 v[24:27], v5 offset:4560
    ds_read_b128 v[28:31], v5 offset:4592
    s_waitcnt lgkmcnt(6)
    v_mfma_f32_32x32x16_bf16 v[80:95], v[32:35], v[48:51], v[80:95]
    v_mfma_f32_32x32x16_bf16 v[80:95], v[36:39], v[52:55], v[80:95]
    ds_read_b64 v[32:33], v4 offset:2528
    ds_read_b64 v[34:35], v4 offset:2536
    ds_read_b64 v[36:37], v4 offset:2496
    ds_read_b64 v[38:39], v4 offset:2504
    ds_read_b128 v[48:51], v5 offset:4480
    ds_read_b128 v[52:55], v5 offset:4512
    s_waitcnt lgkmcnt(6)
    v_mfma_f32_32x32x16_bf16 v[80:95], v[8:11], v[24:27], v[80:95]
    v_mfma_f32_32x32x16_bf16 v[80:95], v[12:15], v[28:31], v[80:95]
    ds_read_b64 v[8:9], v4 offset:2592
    ds_read_b64 v[10:11], v4 offset:2600
    ds_read_b64 v[12:13], v4 offset:2560
    ds_read_b64 v[14:15], v4 offset:2568
    ds_read_b128 v[24:27], v5 offset:4400
    ds_read_b128 v[28:31], v5 offset:4432
    s_waitcnt lgkmcnt(6)
    v_mfma_f32_32x32x16_bf16 v[80:95], v[32:35], v[48:51], v[80:95]
    v_mfma_f32_32x32x16_bf16 v[80:95], v[36:39], v[52:55], v[80:95]
    ds_read_b64 v[32:33], v4 offset:2656
    ds_read_b64 v[34:35], v4 offset:2664
    ds_read_b64 v[36:37], v4 offset:2624
    ds_read_b64 v[38:39], v4 offset:2632
    ds_read_b128 v[48:51], v5 offset:4320
    ds_read_b128 v[52:55], v5 offset:4352
    s_waitcnt lgkmcnt(6)
    v_mfma_f32_32x32x16_bf16 v[80:95], v[8:11], v[24:27], v[80:95]
    v_mfma_f32_32x32x16_bf16 v[80:95], v[12:15], v[28:31], v[80:95]
    ds_read_b64 v[8:9], v4 offset:2720
    ds_read_b64 v[10:11], v4 offset:2728
    ds_read_b64 v[12:13], v4 offset:2688
    ds_read_b64 v[14:15], v4 offset:2696
    ds_read_b128 v[24:27], v5 offset:4240
    ds_read_b128 v[28:31], v5 offset:4272
    s_waitcnt lgkmcnt(6)
    v_mfma_f32_32x32x16_bf16 v[80:95], v[32:35], v[48:51], v[80:95]
    v_mfma_f32_32x32x16_bf16 v[80:95], v[36:39], v[52:55], v[80:95]
    ds_read_b64 v[32:33], v4 offset:2784
    ds_read_b64 v[34:35], v4 offset:2792
    ds_read_b64 v[36:37], v4 offset:2752
    ds_read_b64 v[38:39], v4 offset:2760
    ds_read_b128 v[48:51], v5 offset:4160
    ds_read_b128 v[52:55], v5 offset:4192
    s_waitcnt lgkmcnt(6)
    v_mfma_f32_32x32x16_bf16 v[80:95], v[8:11], v[24:27], v[80:95]
    v_mfma_f32_32x32x16_bf16 v[80:95], v[12:15], v[28:31], v[80:95]
    ds_read_b64 v[8:9], v4 offset:2848
    ds_read_b64 v[10:11], v4 offset:2856
    ds_read_b64 v[12:13], v4 offset:2816
    ds_read_b64 v[14:15], v4 offset:2824
    ds_read_b128 v[24:27], v5 offset:4080
    ds_read_b128 v[28:31], v5 offset:4112
    s_waitcnt lgkmcnt(6)
    v_mfma_f32_32x32x16_bf16 v[80:95], v[32:35], v[48:51], v[80:95]
    v_mfma_f32_32x32x16_bf16 v[80:95], v[36:39], v[52:55], v[80:95]
    ds_read_b64 v[32:33], v4 offset:2912
    ds_read_b64 v[34:35], v4 offset:2920
    ds_read_b64 v[36:37], v4 offset:2880
    ds_read_b64 v[38:39], v4 offset:2888
    ds_read_b128 v[48:51], v5 offset:4000
    ds_read_b128 v[52:55], v5 offset:4032
    s_waitcnt lgkmcnt(6)
    v_mfma_f32_32x32x16_bf16 v[80:95], v[8:11], v[24:27], v[80:95]
    v_mfma_f32_32x32x16_bf16 v[80:95], v[12:15], v[28:31], v[80:95]
    ds_read_b64 v[8:9], v4 offset:2976
    ds_read_b64 v[10:11], v4 offset:2984
    ds_read_b64 v[12:13], v4 offset:2944
    ds_read_b64 v[14:15], v4 offset:2952
    ds_read_b128 v[24:27], v5 offset:3920
    ds_read_b128 v[28:31], v5 offset:3952
    s_waitcnt lgkmcnt(6)
    v_mfma_f32_32x32x16_bf16 v[80:95], v[32:35], v[48:51], v[80:95]
    v_mfma_f32_32x32x16_bf16 v[80:95], v[36:39], v[52:55], v[80:95]
    ds_read_b64 v[32:33], v4 offset:3040
    ds_read_b64 v[34:35], v4 offset:3048
    ds_read_b64 v[36:37], v4 offset:3008
    ds_read_b64 v[38:39], v4 offset:3016
    ds_read_b128 v[48:51], v5 offset:3840
    ds_read_b128 v[52:55], v5 offset:3872
    s_waitcnt lgkmcnt(6)
    v_mfma_f32_32x32x16_bf16 v[80:95], v[8:11], v[24:27], v[80:95]
    v_mfma_f32_32x32x16_bf16 v[80:95], v[12:15], v[28:31], v[80:95]
    ds_read_b64 v[8:9], v4 offset:3104
    ds_read_b64 v[10:11], v4 offset:3112
    ds_read_b64 v[12:13], v4 offset:3072
    ds_read_b64 v[14:15], v4 offset:3080
    ds_read_b128 v[24:27], v5 offset:3760
    ds_read_b128 v[28:31], v5 offset:3792
    s_waitcnt lgkmcnt(6)
    v_mfma_f32_32x32x16_bf16 v[80:95], v[32:35], v[48:51], v[80:95]
    v_mfma_f32_32x32x16_bf16 v[80:95], v[36:39], v[52:55], v[80:95]
    ds_read_b64 v[32:33], v4 offset:3168
    ds_read_b64 v[34:35], v4 offset:3176
    ds_read_b64 v[36:37], v4 offset:3136
    ds_read_b64 v[38:39], v4 offset:3144
    ds_read_b128 v[48:51], v5 offset:3680
    ds_read_b128 v[52:55], v5 offset:3712
    s_waitcnt lgkmcnt(6)
    v_mfma_f32_32x32x16_bf16 v[80:95], v[8:11], v[24:27], v[80:95]
    v_mfma_f32_32x32x16_bf16 v[80:95], v[12:15], v[28:31], v[80:95]
    ds_read_b64 v[8:9], v4 offset:3232
    ds_read_b64 v[10:11], v4 offset:3240
    ds_read_b64 v[12:13], v4 offset:3200
    ds_read_b64 v[14:15], v4 offset:3208
    ds_read_b128 v[24:27], v5 offset:3600
    ds_read_b128 v[28:31], v5 offset:3632
    s_waitcnt lgkmcnt(6)
    v_mfma_f32_32x32x16_bf16 v[80:95], v[32:35], v[48:51], v[80:95]
    v_mfma_f32_32x32x16_bf16 v[80:95], v[36:39], v[52:55], v[80:95]
    ds_read_b64 v[32:33], v4 offset:3296
    ds_read_b64 v[34:35], v4 offset:3304
    ds_read_b64 v[36:37], v4 offset:3264
    ds_read_b64 v[38:39], v4 offset:3272
    ds_read_b128 v[48:51], v5 offset:3520
    ds_read_b128 v[52:55], v5 offset:3552
    s_waitcnt lgkmcnt(6)
    v_mfma_f32_32x32x16_bf16 v[80:95], v[8:11], v[24:27], v[80:95]
    v_mfma_f32_32x32x16_bf16 v[80:95], v[12:15], v[28:31], v[80:95]
    ds_read_b64 v[8:9], v4 offset:3360
    ds_read_b64 v[10:11], v4 offset:3368
    ds_read_b64 v[12:13], v4 offset:3328
    ds_read_b64 v[14:15], v4 offset:3336
    ds_read_b128 v[24:27], v5 offset:3440
    ds_read_b128 v[28:31], v5 offset:3472
    s_waitcnt lgkmcnt(6)
    v_mfma_f32_32x32x16_bf16 v[80:95], v[32:35], v[48:51], v[80:95]
    v_mfma_f32_32x32x16_bf16 v[80:95], v[36:39], v[52:55], v[80:95]
    ds_read_b64 v[32:33], v4 offset:3424
    ds_read_b64 v[34:35], v4 offset:3432
    ds_read_b64 v[36:37], v4 offset:3392
    ds_read_b64 v[38:39], v4 offset:3400
    ds_read_b128 v[48:51], v5 offset:3360
    ds_read_b128 v[52:55], v5 offset:3392
    s_waitcnt lgkmcnt(6)
    v_mfma_f32_32x32x16_bf16 v[80:95], v[8:11], v[24:27], v[80:95]
    v_mfma_f32_32x32x16_bf16 v[80:95], v[12:15], v[28:31], v[80:95]
    ds_read_b64 v[8:9], v4 offset:3488
    ds_read_b64 v[10:11], v4 offset:3496
    ds_read_b64 v[12:13], v4 offset:3456
    ds_read_b64 v[14:15], v4 offset:3464
    ds_read_b128 v[24:27], v5 offset:3280
    ds_read_b128 v[28:31], v5 offset:3312
    s_waitcnt lgkmcnt(6)
    v_mfma_f32_32x32x16_bf16 v[80:95], v[32:35], v[48:51], v[80:95]
    v_mfma_f32_32x32x16_bf16 v[80:95], v[36:39], v[52:55], v[80:95]
    ds_read_b64 v[32:33], v4 offset:3552
    ds_read_b64 v[34:35], v4 offset:3560
    ds_read_b64 v[36:37], v4 offset:3520
    ds_read_b64 v[38:39], v4 offset:3528
    ds_read_b128 v[48:51], v5 offset:3200
    ds_read_b128 v[52:55], v5 offset:3232
    s_waitcnt lgkmcnt(6)
    v_mfma_f32_32x32x16_bf16 v[80:95], v[8:11], v[24:27], v[80:95]
    v_mfma_f32_32x32x16_bf16 v[80:95], v[12:15], v[28:31], v[80:95]
    ds_read_b64 v[8:9], v4 offset:3616
    ds_read_b64 v[10:11], v4 offset:3624
    ds_read_b64 v[12:13], v4 offset:3584
    ds_read_b64 v[14:15], v4 offset:3592
    ds_read_b128 v[24:27], v5 offset:3120
    ds_read_b128 v[28:31], v5 offset:3152
    s_waitcnt lgkmcnt(6)
    v_mfma_f32_32x32x16_bf16 v[80:95], v[32:35], v[48:51], v[80:95]
    v_mfma_f32_32x32x16_bf16 v[80:95], v[36:39], v[52:55], v[80:95]
    ds_read_b64 v[32:33], v4 offset:3680
    ds_read_b64 v[34:35], v4 offset:3688
    ds_read_b64 v[36:37], v4 offset:3648
    ds_read_b64 v[38:39], v4 offset:3656
    ds_read_b128 v[48:51], v5 offset:3040
    ds_read_b128 v[52:55], v5 offset:3072
    s_waitcnt lgkmcnt(6)
    v_mfma_f32_32x32x16_bf16 v[80:95], v[8:11], v[24:27], v[80:95]
    v_mfma_f32_32x32x16_bf16 v[80:95], v[12:15], v[28:31], v[80:95]
    ds_read_b64 v[8:9], v4 offset:3744
    ds_read_b64 v[10:11], v4 offset:3752
    ds_read_b64 v[12:13], v4 offset:3712
    ds_read_b64 v[14:15], v4 offset:3720
    ds_read_b128 v[24:27], v5 offset:2960
    ds_read_b128 v[28:31], v5 offset:2992
    s_waitcnt lgkmcnt(6)
    v_mfma_f32_32x32x16_bf16 v[80:95], v[32:35], v[48:51], v[80:95]
    v_mfma_f32_32x32x16_bf16 v[80:95], v[36:39], v[52:55], v[80:95]
    ds_read_b64 v[32:33], v4 offset:3808
    ds_read_b64 v[34:35], v4 offset:3816
    ds_read_b64 v[36:37], v4 offset:3776
    ds_read_b64 v[38:39], v4 offset:3784
    ds_read_b128 v[48:51], v5 offset:2880
    ds_read_b128 v[52:55], v5 offset:2912
    s_waitcnt lgkmcnt(6)
    v_mfma_f32_32x32x16_bf16 v[80:95], v[8:11], v[24:27], v[80:95]
    v_mfma_f32_32x32x16_bf16 v[80:95], v[12:15], v[28:31], v[80:95]
    ds_read_b64 v[8:9], v4 offset:3872
    ds_read_b64 v[10:11], v4 offset:3880
    ds_read_b64 v[12:13], v4 offset:3840
    ds_read_b64 v[14:15], v4 offset:3848
    ds_read_b128 v[24:27], v5 offset:2800
    ds_read_b128 v[28:31], v5 offset:2832
    s_waitcnt lgkmcnt(6)
    v_mfma_f32_32x32x16_bf16 v[80:95], v[32:35], v[48:51], v[80:95]
    v_mfma_f32_32x32x16_bf16 v[80:95], v[36:39], v[52:55], v[80:95]
    ds_read_b64 v[32:33], v4 offset:3936
    ds_read_b64 v[34:35], v4 offset:3944
    ds_read_b64 v[36:37], v4 offset:3904
    ds_read_b64 v[38:39], v4 offset:3912
    ds_read_b128 v[48:51], v5 offset:2720
    ds_read_b128 v[52:55], v5 offset:2752
    s_waitcnt lgkmcnt(6)
    v_mfma_f32_32x32x16_bf16 v[80:95], v[8:11], v[24:27], v[80:95]
    v_mfma_f32_32x32x16_bf16 v[80:95], v[12:15], v[28:31], v[80:95]
    ds_read_b64 v[8:9], v4 offset:4000
    ds_read_b64 v[10:11], v4 offset:4008
    ds_read_b64 v[12:13], v4 offset:3968
    ds_read_b64 v[14:15], v4 offset:3976
    ds_read_b128 v[24:27], v5 offset:2640
    ds_read_b128 v[28:31], v5 offset:2672
    s_waitcnt lgkmcnt(6)
    v_mfma_f32_32x32x16_bf16 v[80:95], v[32:35], v[48:51], v[80:95]
    v_mfma_f32_32x32x16_bf16 v[80:95], v[36:39], v[52:55], v[80:95]
    ds_read_b64 v[32:33], v4 offset:4064
    ds_read_b64 v[34:35], v4 offset:4072
    ds_read_b64 v[36:37], v4 offset:4032
    ds_read_b64 v[38:39], v4 offset:4040
    ds_read_b128 v[48:51], v5 offset:2560
    ds_read_b128 v[52:55], v5 offset:2592
    s_waitcnt lgkmcnt(6)
    v_mfma_f32_32x32x16_bf16 v[80:95], v[8:11], v[24:27], v[80:95]
    v_mfma_f32_32x32x16_bf16 v[80:95], v[12:15], v[28:31], v[80:95]
    s_waitcnt lgkmcnt(0)
    v_mfma_f32_32x32x16_bf16 v[80:95], v[32:35], v[48:51], v[80:95]
    v_mfma_f32_32x32x16_bf16 v[80:95], v[36:39], v[52:55], v[80:95]
    s_nop 15
    s_nop 3
    v_mul_u32_u24 v5, 10240, v1
    v_mul_u32_u24 v7, 80, v2
    v_add_u32 v5, v5, v7
    v_lshlrev_b32 v7, 3, v3
    v_sub_u32 v5, v5, v7
    v_add_u32 v5, 72704, v5
    v_lshlrev_b32 v6, 12, v1
    v_lshl_add_u32 v6, v2, 6, v6
    v_lshl_add_u32 v6, v3, 3, v6
    v_add_u32 v6, 108544, v6
    v_readfirstlane_b32 s70, v1
    s_nop 3
    s_cmp_eq_u32 s70, 1
    s_cselect_b32 s64, s65, s64
    s_cmp_eq_u32 s70, 2
    s_cselect_b32 s64, s66, s64
    s_cmp_eq_u32 s70, 3
    s_cselect_b32 s64, s67, s64
    ds_read_u16 v8, v5 offset:14
    ds_read_u16 v9, v5 offset:12
    ds_read_u16 v10, v5 offset:10
    ds_read_u16 v11, v5 offset:8
    ds_read_u16 v12, v5 offset:30
    ds_read_u16 v13, v5 offset:28
    ds_read_u16 v14, v5 offset:26
    ds_read_u16 v15, v5 offset:24
    ds_read_u16 v16, v5 offset:46
    ds_read_u16 v17, v5 offset:44
    ds_read_u16 v18, v5 offset:42
    ds_read_u16 v19, v5 offset:40
    ds_read_u16 v20, v5 offset:62
    ds_read_u16 v21, v5 offset:60
    ds_read_u16 v22, v5 offset:58
    ds_read_u16 v23, v5 offset:56
    s_waitcnt lgkmcnt(0)
    v_lshlrev_b32 v8, 16, v8
    v_lshlrev_b32 v9, 16, v9
    v_mul_f32 v8, s64, v8
    v_mul_f32 v9, s64, v9
    v_cvt_pk_bf16_f32 v30, v8, v9
    v_lshlrev_b32 v8, 16, v30
    v_and_b32 v9, 0xffff0000, v30
    v_cvt_pk_bf16_f32 v30, v64, v65
    v_lshlrev_b32 v64, 16, v30
    v_and_b32 v65, 0xffff0000, v30
    v_add_f32 v64, v64, v8
    v_add_f32 v65, v65, v9
    v_cvt_pk_bf16_f32 v30, v64, v65
    ds_write_b32 v6, v30 offset:0
    v_lshlrev_b32 v10, 16, v10
    v_lshlrev_b32 v11, 16, v11
    v_mul_f32 v10, s64, v10
    v_mul_f32 v11, s64, v11
    v_cvt_pk_bf16_f32 v30, v10, v11
    v_lshlrev_b32 v10, 16, v30
    v_and_b32 v11, 0xffff0000, v30
    v_cvt_pk_bf16_f32 v30, v66, v67
    v_lshlrev_b32 v66, 16, v30
    v_and_b32 v67, 0xffff0000, v30
    v_add_f32 v66, v66, v10
    v_add_f32 v67, v67, v11
    v_cvt_pk_bf16_f32 v30, v66, v67
    ds_write_b32 v6, v30 offset:4
    v_lshlrev_b32 v12, 16, v12
    v_lshlrev_b32 v13, 16, v13
    v_mul_f32 v12, s64, v12
    v_mul_f32 v13, s64, v13
    v_cvt_pk_bf16_f32 v30, v12, v13
    v_lshlrev_b32 v12, 16, v30
    v_and_b32 v13, 0xffff0000, v30
    v_cvt_pk_bf16_f32 v30, v68, v69
    v_lshlrev_b32 v68, 16, v30
    v_and_b32 v69, 0xffff0000, v30
    v_add_f32 v68, v68, v12
    v_add_f32 v69, v69, v13
    v_cvt_pk_bf16_f32 v30, v68, v69
    ds_write_b32 v6, v30 offset:16
    v_lshlrev_b32 v14, 16, v14
    v_lshlrev_b32 v15, 16, v15
    v_mul_f32 v14, s64, v14
    v_mul_f32 v15, s64, v15
    v_cvt_pk_bf16_f32 v30, v14, v15
    v_lshlrev_b32 v14, 16, v30
    v_and_b32 v15, 0xffff0000, v30
    v_cvt_pk_bf16_f32 v30, v70, v71
    v_lshlrev_b32 v70, 16, v30
    v_and_b32 v71, 0xffff0000, v30
    v_add_f32 v70, v70, v14
    v_add_f32 v71, v71, v15
    v_cvt_pk_bf16_f32 v30, v70, v71
    ds_write_b32 v6, v30 offset:20
    v_lshlrev_b32 v16, 16, v16
    v_lshlrev_b32 v17, 16, v17
    v_mul_f32 v16, s64, v16
    v_mul_f32 v17, s64, v17
    v_cvt_pk_bf16_f32 v30, v16, v17
    v_lshlrev_b32 v16, 16, v30
    v_and_b32 v17, 0xffff0000, v30
    v_cvt_pk_bf16_f32 v30, v72, v73
    v_lshlrev_b32 v72, 16, v30
    v_and_b32 v73, 0xffff0000, v30
    v_add_f32 v72, v72, v16
    v_add_f32 v73, v73, v17
    v_cvt_pk_bf16_f32 v30, v72, v73
    ds_write_b32 v6, v30 offset:32
    v_lshlrev_b32 v18, 16, v18
    v_lshlrev_b32 v19, 16, v19
    v_mul_f32 v18, s64, v18
    v_mul_f32 v19, s64, v19
    v_cvt_pk_bf16_f32 v30, v18, v19
    v_lshlrev_b32 v18, 16, v30
    v_and_b32 v19, 0xffff0000, v30
    v_cvt_pk_bf16_f32 v30, v74, v75
    v_lshlrev_b32 v74, 16, v30
    v_and_b32 v75, 0xffff0000, v30
    v_add_f32 v74, v74, v18
    v_add_f32 v75, v75, v19
    v_cvt_pk_bf16_f32 v30, v74, v75
    ds_write_b32 v6, v30 offset:36
    v_lshlrev_b32 v20, 16, v20
    v_lshlrev_b32 v21, 16, v21
    v_mul_f32 v20, s64, v20
    v_mul_f32 v21, s64, v21
    v_cvt_pk_bf16_f32 v30, v20, v21
    v_lshlrev_b32 v20, 16, v30
    v_and_b32 v21, 0xffff0000, v30
    v_cvt_pk_bf16_f32 v30, v76, v77
    v_lshlrev_b32 v76, 16, v30
    v_and_b32 v77, 0xffff0000, v30
    v_add_f32 v76, v76, v20
    v_add_f32 v77, v77, v21
    v_cvt_pk_bf16_f32 v30, v76, v77
    ds_write_b32 v6, v30 offset:48
    v_lshlrev_b32 v22, 16, v22
    v_lshlrev_b32 v23, 16, v23
    v_mul_f32 v22, s64, v22
    v_mul_f32 v23, s64, v23
    v_cvt_pk_bf16_f32 v30, v22, v23
    v_lshlrev_b32 v22, 16, v30
    v_and_b32 v23, 0xffff0000, v30
    v_cvt_pk_bf16_f32 v30, v78, v79
    v_lshlrev_b32 v78, 16, v30
    v_and_b32 v79, 0xffff0000, v30
    v_add_f32 v78, v78, v22
    v_add_f32 v79, v79, v23
    v_cvt_pk_bf16_f32 v30, v78, v79
    ds_write_b32 v6, v30 offset:52
    ds_read_u16 v8, v5 offset:2574
    ds_read_u16 v9, v5 offset:2572
    ds_read_u16 v10, v5 offset:2570
    ds_read_u16 v11, v5 offset:2568
    ds_read_u16 v12, v5 offset:2590
    ds_read_u16 v13, v5 offset:2588
    ds_read_u16 v14, v5 offset:2586
    ds_read_u16 v15, v5 offset:2584
    ds_read_u16 v16, v5 offset:2606
    ds_read_u16 v17, v5 offset:2604
    ds_read_u16 v18, v5 offset:2602
    ds_read_u16 v19, v5 offset:2600
    ds_read_u16 v20, v5 offset:2622
    ds_read_u16 v21, v5 offset:2620
    ds_read_u16 v22, v5 offset:2618
    ds_read_u16 v23, v5 offset:2616
    s_waitcnt lgkmcnt(0)
    v_lshlrev_b32 v8, 16, v8
    v_lshlrev_b32 v9, 16, v9
    v_mul_f32 v8, s64, v8
    v_mul_f32 v9, s64, v9
    v_cvt_pk_bf16_f32 v30, v8, v9
    v_lshlrev_b32 v8, 16, v30
    v_and_b32 v9, 0xffff0000, v30
    v_cvt_pk_bf16_f32 v30, v80, v81
    v_lshlrev_b32 v80, 16, v30
    v_and_b32 v81, 0xffff0000, v30
    v_add_f32 v80, v80, v8
    v_add_f32 v81, v81, v9
    v_cvt_pk_bf16_f32 v30, v80, v81
    ds_write_b32 v6, v30 offset:2048
    v_lshlrev_b32 v10, 16, v10
    v_lshlrev_b32 v11, 16, v11
    v_mul_f32 v10, s64, v10
    v_mul_f32 v11, s64, v11
    v_cvt_pk_bf16_f32 v30, v10, v11
    v_lshlrev_b32 v10, 16, v30
    v_and_b32 v11, 0xffff0000, v30
    v_cvt_pk_bf16_f32 v30, v82, v83
    v_lshlrev_b32 v82, 16, v30
    v_and_b32 v83, 0xffff0000, v30
    v_add_f32 v82, v82, v10
    v_add_f32 v83, v83, v11
    v_cvt_pk_bf16_f32 v30, v82, v83
    ds_write_b32 v6, v30 offset:2052
    v_lshlrev_b32 v12, 16, v12
    v_lshlrev_b32 v13, 16, v13
    v_mul_f32 v12, s64, v12
    v_mul_f32 v13, s64, v13
    v_cvt_pk_bf16_f32 v30, v12, v13
    v_lshlrev_b32 v12, 16, v30
    v_and_b32 v13, 0xffff0000, v30
    v_cvt_pk_bf16_f32 v30, v84, v85
    v_lshlrev_b32 v84, 16, v30
    v_and_b32 v85, 0xffff0000, v30
    v_add_f32 v84, v84, v12
    v_add_f32 v85, v85, v13
    v_cvt_pk_bf16_f32 v30, v84, v85
    ds_write_b32 v6, v30 offset:2064
    v_lshlrev_b32 v14, 16, v14
    v_lshlrev_b32 v15, 16, v15
    v_mul_f32 v14, s64, v14
    v_mul_f32 v15, s64, v15
    v_cvt_pk_bf16_f32 v30, v14, v15
    v_lshlrev_b32 v14, 16, v30
    v_and_b32 v15, 0xffff0000, v30
    v_cvt_pk_bf16_f32 v30, v86, v87
    v_lshlrev_b32 v86, 16, v30
    v_and_b32 v87, 0xffff0000, v30
    v_add_f32 v86, v86, v14
    v_add_f32 v87, v87, v15
    v_cvt_pk_bf16_f32 v30, v86, v87
    ds_write_b32 v6, v30 offset:2068
    v_lshlrev_b32 v16, 16, v16
    v_lshlrev_b32 v17, 16, v17
    v_mul_f32 v16, s64, v16
    v_mul_f32 v17, s64, v17
    v_cvt_pk_bf16_f32 v30, v16, v17
    v_lshlrev_b32 v16, 16, v30
    v_and_b32 v17, 0xffff0000, v30
    v_cvt_pk_bf16_f32 v30, v88, v89
    v_lshlrev_b32 v88, 16, v30
    v_and_b32 v89, 0xffff0000, v30
    v_add_f32 v88, v88, v16
    v_add_f32 v89, v89, v17
    v_cvt_pk_bf16_f32 v30, v88, v89
    ds_write_b32 v6, v30 offset:2080
    v_lshlrev_b32 v18, 16, v18
    v_lshlrev_b32 v19, 16, v19
    v_mul_f32 v18, s64, v18
    v_mul_f32 v19, s64, v19
    v_cvt_pk_bf16_f32 v30, v18, v19
    v_lshlrev_b32 v18, 16, v30
    v_and_b32 v19, 0xffff0000, v30
    v_cvt_pk_bf16_f32 v30, v90, v91
    v_lshlrev_b32 v90, 16, v30
    v_and_b32 v91, 0xffff0000, v30
    v_add_f32 v90, v90, v18
    v_add_f32 v91, v91, v19
    v_cvt_pk_bf16_f32 v30, v90, v91
    ds_write_b32 v6, v30 offset:2084
    v_lshlrev_b32 v20, 16, v20
    v_lshlrev_b32 v21, 16, v21
    v_mul_f32 v20, s64, v20
    v_mul_f32 v21, s64, v21
    v_cvt_pk_bf16_f32 v30, v20, v21
    v_lshlrev_b32 v20, 16, v30
    v_and_b32 v21, 0xffff0000, v30
    v_cvt_pk_bf16_f32 v30, v92, v93
    v_lshlrev_b32 v92, 16, v30
    v_and_b32 v93, 0xffff0000, v30
    v_add_f32 v92, v92, v20
    v_add_f32 v93, v93, v21
    v_cvt_pk_bf16_f32 v30, v92, v93
    ds_write_b32 v6, v30 offset:2096
    v_lshlrev_b32 v22, 16, v22
    v_lshlrev_b32 v23, 16, v23
    v_mul_f32 v22, s64, v22
    v_mul_f32 v23, s64, v23
    v_cvt_pk_bf16_f32 v30, v22, v23
    v_lshlrev_b32 v22, 16, v30
    v_and_b32 v23, 0xffff0000, v30
    v_cvt_pk_bf16_f32 v30, v94, v95
    v_lshlrev_b32 v94, 16, v30
    v_and_b32 v95, 0xffff0000, v30
    v_add_f32 v94, v94, v22
    v_add_f32 v95, v95, v23
    v_cvt_pk_bf16_f32 v30, v94, v95
    ds_write_b32 v6, v30 offset:2100
    s_waitcnt lgkmcnt(0)
    s_barrier
    v_lshlrev_b32 v1, 4, v0
    v_add_u32 v3, 108544, v1
    s_lshl_b32 s60, s3, 12
    ds_read_b128 v[8:11], v3 offset:0
    s_waitcnt lgkmcnt(0)
    buffer_store_dwordx4 v[8:11], v1, s[56:59], s60 offen
    s_add_u32 s60, s60, 4096
    s_nop 1
    ds_read_b128 v[8:11], v3 offset:4096
    s_waitcnt lgkmcnt(0)
    buffer_store_dwordx4 v[8:11], v1, s[56:59], s60 offen
    s_add_u32 s60, s60, 4096
    s_nop 1
    ds_read_b128 v[8:11], v3 offset:8192
    s_waitcnt lgkmcnt(0)
    buffer_store_dwordx4 v[8:11], v1, s[56:59], s60 offen
    s_add_u32 s60, s60, 4096
    s_nop 1
    ds_read_b128 v[8:11], v3 offset:12288
    s_waitcnt lgkmcnt(0)
    buffer_store_dwordx4 v[8:11], v1, s[56:59], s60 offen
    s_add_u32 s60, s60, 4096
    s_nop 1
CONV_END:
    s_endpgm
.globl lna_kernel
.p2align 8
.type lna_kernel,@function
lna_kernel:
    s_cmp_ge_u32 s2, 128
    s_cbranch_scc1 LN_END_lna_kernel
    s_load_dwordx2 s[4:5], s[0:1], 0
    s_load_dwordx2 s[6:7], s[0:1], 96
    s_waitcnt lgkmcnt(0)
    s_mov_b32 s8, s4
    s_mov_b32 s9, s5
    s_mov_b32 s10, 2621440
    s_mov_b32 s11, 0x00020000
    s_mov_b32 s12, s6
    s_mov_b32 s13, s7
    s_mov_b32 s14, 2621440
    s_mov_b32 s15, 0x00020000
    s_add_u32 s16, s6, 2621440
    s_addc_u32 s17, s7, 0
    s_mov_b32 s18, 2621440
    s_mov_b32 s19, 0x00020000
    s_add_u32 s20, s6, 5242880
    s_addc_u32 s21, s7, 0
    s_mov_b32 s22, 2621440
    s_mov_b32 s23, 0x00020000
    v_lshlrev_b32 v1, 12, v0
    s_lshl_b32 s3, s2, 5
    v_add_u32 v1, s3, v1
    v_lshlrev_b32 v2, 1, v0
    s_mov_b32 s24, 0
    buffer_load_dwordx4 v[10:13], v1, s[12:15], s24 offen
    buffer_load_dwordx4 v[14:17], v1, s[12:15], s24 offen offset:16
    s_waitcnt vmcnt(0)
    v_cmp_gt_u32 vcc, 640, v0
    s_mov_b64 s[28:29], exec
    s_and_b64 exec, exec, vcc
    ds_write_b16 v2, v10 offset:0
    ds_write_b16_d16_hi v2, v10 offset:1288
    ds_write_b16 v2, v11 offset:2576
    ds_write_b16_d16_hi v2, v11 offset:3864
    ds_write_b16 v2, v12 offset:5152
    ds_write_b16_d16_hi v2, v12 offset:6440
    ds_write_b16 v2, v13 offset:7728
    ds_write_b16_d16_hi v2, v13 offset:9016
    ds_write_b16 v2, v14 offset:10304
    ds_write_b16_d16_hi v2, v14 offset:11592
    ds_write_b16 v2, v15 offset:12880
    ds_write_b16_d16_hi v2, v15 offset:14168
    ds_write_b16 v2, v16 offset:15456
    ds_write_b16_d16_hi v2, v16 offset:16744
    ds_write_b16 v2, v17 offset:18032
    ds_write_b16_d16_hi v2, v17 offset:19320
    s_mov_b64 exec, s[28:29]
    s_waitcnt lgkmcnt(0)
    s_barrier
    v_lshrrev_b32 v3, 6, v0
    v_and_b32 v2, 63, v0
    s_nop 0
    s_lshl_b32 s3, s2, 4
    v_add_u32 v1, s3, v3
    s_movk_i32 s24, 1280
    v_mul_lo_u32 v1, v1, s24
    v_lshl_add_u32 v1, v2, 2, v1
    s_movk_i32 s24, 1288
    v_mul_lo_u32 v3, v3, s24
    v_lshl_add_u32 v3, v2, 2, v3
    buffer_load_dword v10, v1, s[8:11], 0 offen offset:0
    buffer_load_dword v11, v1, s[8:11], 0 offen offset:256
    buffer_load_dword v12, v1, s[8:11], 0 offen offset:512
    buffer_load_dword v13, v1, s[8:11], 0 offen offset:768
    buffer_load_dword v14, v1, s[8:11], 0 offen offset:1024
    ds_read_b32 v15, v3 offset:0
    ds_read_b32 v16, v3 offset:256
    ds_read_b32 v17, v3 offset:512
    ds_read_b32 v18, v3 offset:768
    ds_read_b32 v19, v3 offset:1024
    s_waitcnt vmcnt(0) lgkmcnt(0)
    v_lshlrev_b32 v20, 16, v10
    v_and_b32 v21, 0xffff0000, v10
    v_lshlrev_b32 v30, 16, v15
    v_and_b32 v31, 0xffff0000, v15
    v_lshlrev_b32 v22, 16, v11
    v_and_b32 v23, 0xffff0000, v11
    v_lshlrev_b32 v32, 16, v16
    v_and_b32 v33, 0xffff0000, v16
    v_lshlrev_b32 v24, 16, v12
    v_and_b32 v25, 0xffff0000, v12
    v_lshlrev_b32 v34, 16, v17
    v_and_b32 v35, 0xffff0000, v17
    v_lshlrev_b32 v26, 16, v13
    v_and_b32 v27, 0xffff0000, v13
    v_lshlrev_b32 v36, 16, v18
    v_and_b32 v37, 0xffff0000, v18
    v_lshlrev_b32 v28, 16, v14
    v_and_b32 v29, 0xffff0000, v14
    v_lshlrev_b32 v38, 16, v19
    v_and_b32 v39, 0xffff0000, v19
    v_add_f32 v50, v20, v21
    v_add_f32 v50, v22, v50
    v_add_f32 v50, v23, v50
    v_add_f32 v50, v24, v50
    v_add_f32 v50, v25, v50
    v_add_f32 v50, v26, v50
    v_add_f32 v50, v27, v50
    v_add_f32 v50, v28, v50
    v_add_f32 v50, v29, v50
    s_nop 1
    v_add_f32_dpp v50, v50, v50 quad_perm:[1,0,3,2] row_mask:0xf bank_mask:0xf
    s_nop 1
    v_add_f32_dpp v50, v50, v50 quad_perm:[2,3,0,1] row_mask:0xf bank_mask:0xf
    s_nop 1
    v_add_f32_dpp v50, v50, v50 row_half_mirror row_mask:0xf bank_mask:0xf
    s_nop 1
    v_add_f32_dpp v50, v50, v50 row_mirror row_mask:0xf bank_mask:0xf
    s_nop 1
    v_readlane_b32 s40, v50, 0
    v_readlane_b32 s41, v50, 16
    v_readlane_b32 s42, v50, 32
    v_readlane_b32 s43, v50, 48
    s_nop 1
    v_mov_b32 v50, s40
    v_add_f32 v50, s41, v50
    v_add_f32 v50, s42, v50
    v_add_f32 v50, s43, v50
    v_mul_f32 v50, 0x3acccccd, v50
    v_mov_b32 v51, 0
    v_sub_f32 v52, v20, v50
    v_fmac_f32 v51, v52, v52
    v_sub_f32 v52, v21, v50
    v_fmac_f32 v51, v52, v52
    v_sub_f32 v52, v22, v50
    v_fmac_f32 v51, v52, v52
    v_sub_f32 v52, v23, v50
    v_fmac_f32 v51, v52, v52
    v_sub_f32 v52, v24, v50
    v_fmac_f32 v51, v52, v52
    v_sub_f32 v52, v25, v50
    v_fmac_f32 v51, v52, v52
    v_sub_f32 v52, v26, v50
    v_fmac_f32 v51, v52, v52
    v_sub_f32 v52, v27, v50
    v_fmac_f32 v51, v52, v52
    v_sub_f32 v52, v28, v50
    v_fmac_f32 v51, v52, v52
    v_sub_f32 v52, v29, v50
    v_fmac_f32 v51, v52, v52
    s_nop 1
    v_add_f32_dpp v51, v51, v51 quad_perm:[1,0,3,2] row_mask:0xf bank_mask:0xf
    s_nop 1
    v_add_f32_dpp v51, v51, v51 quad_perm:[2,3,0,1] row_mask:0xf bank_mask:0xf
    s_nop 1
    v_add_f32_dpp v51, v51, v51 row_half_mirror row_mask:0xf bank_mask:0xf
    s_nop 1
    v_add_f32_dpp v51, v51, v51 row_mirror row_mask:0xf bank_mask:0xf
    s_nop 1
    v_readlane_b32 s40, v51, 0
    v_readlane_b32 s41, v51, 16
    v_readlane_b32 s42, v51, 32
    v_readlane_b32 s43, v51, 48
    s_nop 1
    v_mov_b32 v51, s40
    v_add_f32 v51, s41, v51
    v_add_f32 v51, s42, v51
    v_add_f32 v51, s43, v51
    v_mul_f32 v51, 0x3acccccd, v51
    v_cvt_pk_bf16_f32 v51, v51, v51
    v_lshlrev_b32 v51, 16, v51
    v_add_f32 v51, 0x3727c5ac, v51
    v_cvt_pk_bf16_f32 v51, v51, v51
    v_lshlrev_b32 v51, 16, v51
    v_sqrt_f32 v51, v51
    s_nop 0
    v_cvt_pk_bf16_f32 v51, v51, v51
    v_lshlrev_b32 v51, 16, v51
    v_rcp_f32 v51, v51
    v_cvt_pk_bf16_f32 v50, v50, v50
    v_lshlrev_b32 v50, 16, v50
    v_sub_f32 v40, v20, v50
    v_sub_f32 v41, v21, v50
    v_cvt_pk_bf16_f32 v52, v40, v41
    v_lshlrev_b32 v40, 16, v52
    v_and_b32 v41, 0xffff0000, v52
    v_mul_f32 v40, v40, v51
    v_mul_f32 v41, v41, v51
    v_cvt_pk_bf16_f32 v52, v40, v41
    v_lshlrev_b32 v40, 16, v52
    v_and_b32 v41, 0xffff0000, v52
    v_sub_f32 v42, v22, v50
    v_sub_f32 v43, v23, v50
    v_cvt_pk_bf16_f32 v52, v42, v43
    v_lshlrev_b32 v42, 16, v52
    v_and_b32 v43, 0xffff0000, v52
    v_mul_f32 v42, v42, v51
    v_mul_f32 v43, v43, v51
    v_cvt_pk_bf16_f32 v52, v42, v43
    v_lshlrev_b32 v42, 16, v52
    v_and_b32 v43, 0xffff0000, v52
    v_sub_f32 v44, v24, v50
    v_sub_f32 v45, v25, v50
    v_cvt_pk_bf16_f32 v52, v44, v45
    v_lshlrev_b32 v44, 16, v52
    v_and_b32 v45, 0xffff0000, v52
    v_mul_f32 v44, v44, v51
    v_mul_f32 v45, v45, v51
    v_cvt_pk_bf16_f32 v52, v44, v45
    v_lshlrev_b32 v44, 16, v52
    v_and_b32 v45, 0xffff0000, v52
    v_sub_f32 v46, v26, v50
    v_sub_f32 v47, v27, v50
    v_cvt_pk_bf16_f32 v52, v46, v47
    v_lshlrev_b32 v46, 16, v52
    v_and_b32 v47, 0xffff0000, v52
    v_mul_f32 v46, v46, v51
    v_mul_f32 v47, v47, v51
    v_cvt_pk_bf16_f32 v52, v46, v47
    v_lshlrev_b32 v46, 16, v52
    v_and_b32 v47, 0xffff0000, v52
    v_sub_f32 v48, v28, v50
    v_sub_f32 v49, v29, v50
    v_cvt_pk_bf16_f32 v52, v48, v49
    v_lshlrev_b32 v48, 16, v52
    v_and_b32 v49, 0xffff0000, v52
    v_mul_f32 v48, v48, v51
    v_mul_f32 v49, v49, v51
    v_cvt_pk_bf16_f32 v52, v48, v49
    v_lshlrev_b32 v48, 16, v52
    v_and_b32 v49, 0xffff0000, v52
    v_mul_f32 v40, v40, v30
    v_mul_f32 v41, v41, v31
    v_cvt_pk_bf16_f32 v52, v40, v41
    v_lshlrev_b32 v40, 16, v52
    v_and_b32 v41, 0xffff0000, v52
    v_add_f32 v20, v20, v40
    v_add_f32 v21, v21, v41
    v_cvt_pk_bf16_f32 v10, v20, v21
    v_lshlrev_b32 v20, 16, v10
    v_and_b32 v21, 0xffff0000, v10
    v_mul_f32 v42, v42, v32
    v_mul_f32 v43, v43, v33
    v_cvt_pk_bf16_f32 v52, v42, v43
    v_lshlrev_b32 v42, 16, v52
    v_and_b32 v43, 0xffff0000, v52
    v_add_f32 v22, v22, v42
    v_add_f32 v23, v23, v43
    v_cvt_pk_bf16_f32 v11, v22, v23
    v_lshlrev_b32 v22, 16, v11
    v_and_b32 v23, 0xffff0000, v11
    v_mul_f32 v44, v44, v34
    v_mul_f32 v45, v45, v35
    v_cvt_pk_bf16_f32 v52, v44, v45
    v_lshlrev_b32 v44, 16, v52
    v_and_b32 v45, 0xffff0000, v52
    v_add_f32 v24, v24, v44
    v_add_f32 v25, v25, v45
    v_cvt_pk_bf16_f32 v12, v24, v25
    v_lshlrev_b32 v24, 16, v12
    v_and_b32 v25, 0xffff0000, v12
    v_mul_f32 v46, v46, v36
    v_mul_f32 v47, v47, v37
    v_cvt_pk_bf16_f32 v52, v46, v47
    v_lshlrev_b32 v46, 16, v52
    v_and_b32 v47, 0xffff0000, v52
    v_add_f32 v26, v26, v46
    v_add_f32 v27, v27, v47
    v_cvt_pk_bf16_f32 v13, v26, v27
    v_lshlrev_b32 v26, 16, v13
    v_and_b32 v27, 0xffff0000, v13
    v_mul_f32 v48, v48, v38
    v_mul_f32 v49, v49, v39
    v_cvt_pk_bf16_f32 v52, v48, v49
    v_lshlrev_b32 v48, 16, v52
    v_and_b32 v49, 0xffff0000, v52
    v_add_f32 v28, v28, v48
    v_add_f32 v29, v29, v49
    v_cvt_pk_bf16_f32 v14, v28, v29
    v_lshlrev_b32 v28, 16, v14
    v_and_b32 v29, 0xffff0000, v14
    buffer_store_dword v10, v1, s[16:19], 0 offen offset:0
    buffer_store_dword v11, v1, s[16:19], 0 offen offset:256
    buffer_store_dword v12, v1, s[16:19], 0 offen offset:512
    buffer_store_dword v13, v1, s[16:19], 0 offen offset:768
    buffer_store_dword v14, v1, s[16:19], 0 offen offset:1024
    v_add_f32 v50, v20, v21
    v_add_f32 v50, v22, v50
    v_add_f32 v50, v23, v50
    v_add_f32 v50, v24, v50
    v_add_f32 v50, v25, v50
    v_add_f32 v50, v26, v50
    v_add_f32 v50, v27, v50
    v_add_f32 v50, v28, v50
    v_add_f32 v50, v29, v50
    s_nop 1
    v_add_f32_dpp v50, v50, v50 quad_perm:[1,0,3,2] row_mask:0xf bank_mask:0xf
    s_nop 1
    v_add_f32_dpp v50, v50, v50 quad_perm:[2,3,0,1] row_mask:0xf bank_mask:0xf
    s_nop 1
    v_add_f32_dpp v50, v50, v50 row_half_mirror row_mask:0xf bank_mask:0xf
    s_nop 1
    v_add_f32_dpp v50, v50, v50 row_mirror row_mask:0xf bank_mask:0xf
    s_nop 1
    v_readlane_b32 s40, v50, 0
    v_readlane_b32 s41, v50, 16
    v_readlane_b32 s42, v50, 32
    v_readlane_b32 s43, v50, 48
    s_nop 1
    v_mov_b32 v50, s40
    v_add_f32 v50, s41, v50
    v_add_f32 v50, s42, v50
    v_add_f32 v50, s43, v50
    v_mul_f32 v50, 0x3acccccd, v50
    v_mov_b32 v51, 0
    v_sub_f32 v52, v20, v50
    v_fmac_f32 v51, v52, v52
    v_sub_f32 v52, v21, v50
    v_fmac_f32 v51, v52, v52
    v_sub_f32 v52, v22, v50
    v_fmac_f32 v51, v52, v52
    v_sub_f32 v52, v23, v50
    v_fmac_f32 v51, v52, v52
    v_sub_f32 v52, v24, v50
    v_fmac_f32 v51, v52, v52
    v_sub_f32 v52, v25, v50
    v_fmac_f32 v51, v52, v52
    v_sub_f32 v52, v26, v50
    v_fmac_f32 v51, v52, v52
    v_sub_f32 v52, v27, v50
    v_fmac_f32 v51, v52, v52
    v_sub_f32 v52, v28, v50
    v_fmac_f32 v51, v52, v52
    v_sub_f32 v52, v29, v50
    v_fmac_f32 v51, v52, v52
    s_nop 1
    v_add_f32_dpp v51, v51, v51 quad_perm:[1,0,3,2] row_mask:0xf bank_mask:0xf
    s_nop 1
    v_add_f32_dpp v51, v51, v51 quad_perm:[2,3,0,1] row_mask:0xf bank_mask:0xf
    s_nop 1
    v_add_f32_dpp v51, v51, v51 row_half_mirror row_mask:0xf bank_mask:0xf
    s_nop 1
    v_add_f32_dpp v51, v51, v51 row_mirror row_mask:0xf bank_mask:0xf
    s_nop 1
    v_readlane_b32 s40, v51, 0
    v_readlane_b32 s41, v51, 16
    v_readlane_b32 s42, v51, 32
    v_readlane_b32 s43, v51, 48
    s_nop 1
    v_mov_b32 v51, s40
    v_add_f32 v51, s41, v51
    v_add_f32 v51, s42, v51
    v_add_f32 v51, s43, v51
    v_mul_f32 v51, 0x3acccccd, v51
    v_cvt_pk_bf16_f32 v51, v51, v51
    v_lshlrev_b32 v51, 16, v51
    v_add_f32 v51, 0x3727c5ac, v51
    v_cvt_pk_bf16_f32 v51, v51, v51
    v_lshlrev_b32 v51, 16, v51
    v_sqrt_f32 v51, v51
    s_nop 0
    v_cvt_pk_bf16_f32 v51, v51, v51
    v_lshlrev_b32 v51, 16, v51
    v_rcp_f32 v51, v51
    v_cvt_pk_bf16_f32 v50, v50, v50
    v_lshlrev_b32 v50, 16, v50
    v_sub_f32 v40, v20, v50
    v_sub_f32 v41, v21, v50
    v_cvt_pk_bf16_f32 v52, v40, v41
    v_lshlrev_b32 v40, 16, v52
    v_and_b32 v41, 0xffff0000, v52
    v_mul_f32 v40, v40, v51
    v_mul_f32 v41, v41, v51
    v_cvt_pk_bf16_f32 v52, v40, v41
    v_lshlrev_b32 v40, 16, v52
    v_and_b32 v41, 0xffff0000, v52
    v_sub_f32 v42, v22, v50
    v_sub_f32 v43, v23, v50
    v_cvt_pk_bf16_f32 v52, v42, v43
    v_lshlrev_b32 v42, 16, v52
    v_and_b32 v43, 0xffff0000, v52
    v_mul_f32 v42, v42, v51
    v_mul_f32 v43, v43, v51
    v_cvt_pk_bf16_f32 v52, v42, v43
    v_lshlrev_b32 v42, 16, v52
    v_and_b32 v43, 0xffff0000, v52
    v_sub_f32 v44, v24, v50
    v_sub_f32 v45, v25, v50
    v_cvt_pk_bf16_f32 v52, v44, v45
    v_lshlrev_b32 v44, 16, v52
    v_and_b32 v45, 0xffff0000, v52
    v_mul_f32 v44, v44, v51
    v_mul_f32 v45, v45, v51
    v_cvt_pk_bf16_f32 v52, v44, v45
    v_lshlrev_b32 v44, 16, v52
    v_and_b32 v45, 0xffff0000, v52
    v_sub_f32 v46, v26, v50
    v_sub_f32 v47, v27, v50
    v_cvt_pk_bf16_f32 v52, v46, v47
    v_lshlrev_b32 v46, 16, v52
    v_and_b32 v47, 0xffff0000, v52
    v_mul_f32 v46, v46, v51
    v_mul_f32 v47, v47, v51
    v_cvt_pk_bf16_f32 v52, v46, v47
    v_lshlrev_b32 v46, 16, v52
    v_and_b32 v47, 0xffff0000, v52
    v_sub_f32 v48, v28, v50
    v_sub_f32 v49, v29, v50
    v_cvt_pk_bf16_f32 v52, v48, v49
    v_lshlrev_b32 v48, 16, v52
    v_and_b32 v49, 0xffff0000, v52
    v_mul_f32 v48, v48, v51
    v_mul_f32 v49, v49, v51
    v_cvt_pk_bf16_f32 v52, v48, v49
    v_lshlrev_b32 v48, 16, v52
    v_and_b32 v49, 0xffff0000, v52
    v_cvt_pk_bf16_f32 v60, v40, v41
    v_cvt_pk_bf16_f32 v61, v42, v43
    v_cvt_pk_bf16_f32 v62, v44, v45
    v_cvt_pk_bf16_f32 v63, v46, v47
    v_cvt_pk_bf16_f32 v64, v48, v49
    buffer_store_dword v60, v1, s[20:23], 0 offen offset:0
    buffer_store_dword v61, v1, s[20:23], 0 offen offset:256
    buffer_store_dword v62, v1, s[20:23], 0 offen offset:512
    buffer_store_dword v63, v1, s[20:23], 0 offen offset:768
    buffer_store_dword v64, v1, s[20:23], 0 offen offset:1024
    v_add_u32 v1, 1280, v1
LN_END_lna_kernel:
    s_endpgm
.globl lnb_kernel
.p2align 8
.type lnb_kernel,@function
lnb_kernel:
    s_cmp_ge_u32 s2, 128
    s_cbranch_scc1 LN_END_lnb_kernel
    s_load_dwordx2 s[4:5], s[0:1], 0
    s_load_dwordx2 s[6:7], s[0:1], 96
    s_waitcnt lgkmcnt(0)
    s_add_u32 s8, s6, 7864320
    s_addc_u32 s9, s7, 0
    s_mov_b32 s10, 2621440
    s_mov_b32 s11, 0x00020000
    s_mov_b32 s12, s6
    s_mov_b32 s13, s7
    s_mov_b32 s14, 2621440
    s_mov_b32 s15, 0x00020000
    s_add_u32 s16, s6, 2621440
    s_addc_u32 s17, s7, 0
    s_mov_b32 s18, 2621440
    s_mov_b32 s19, 0x00020000
    s_add_u32 s20, s6, 5242880
    s_addc_u32 s21, s7, 0
    s_mov_b32 s22, 2621440
    s_mov_b32 s23, 0x00020000
    v_lshlrev_b32 v1, 12, v0
    s_lshl_b32 s3, s2, 5
    v_add_u32 v1, s3, v1
    v_lshlrev_b32 v2, 1, v0
    s_mov_b32 s24, 0
    buffer_load_dwordx4 v[10:13], v1, s[12:15], s24 offen
    buffer_load_dwordx4 v[14:17], v1, s[12:15], s24 offen offset:16
    s_waitcnt vmcnt(0)
    v_cmp_gt_u32 vcc, 640, v0
    s_mov_b64 s[28:29], exec
    s_and_b64 exec, exec, vcc
    ds_write_b16 v2, v10 offset:0
    ds_write_b16_d16_hi v2, v10 offset:1288
    ds_write_b16 v2, v11 offset:2576
    ds_write_b16_d16_hi v2, v11 offset:3864
    ds_write_b16 v2, v12 offset:5152
    ds_write_b16_d16_hi v2, v12 offset:6440
    ds_write_b16 v2, v13 offset:7728
    ds_write_b16_d16_hi v2, v13 offset:9016
    ds_write_b16 v2, v14 offset:10304
    ds_write_b16_d16_hi v2, v14 offset:11592
    ds_write_b16 v2, v15 offset:12880
    ds_write_b16_d16_hi v2, v15 offset:14168
    ds_write_b16 v2, v16 offset:15456
    ds_write_b16_d16_hi v2, v16 offset:16744
    ds_write_b16 v2, v17 offset:18032
    ds_write_b16_d16_hi v2, v17 offset:19320
    s_mov_b64 exec, s[28:29]
    s_waitcnt lgkmcnt(0)
    s_barrier
    v_lshrrev_b32 v3, 6, v0
    v_and_b32 v2, 63, v0
    s_nop 0
    s_lshl_b32 s3, s2, 4
    v_add_u32 v1, s3, v3
    s_movk_i32 s24, 1280
    v_mul_lo_u32 v1, v1, s24
    v_lshl_add_u32 v1, v2, 2, v1
    s_movk_i32 s24, 1288
    v_mul_lo_u32 v3, v3, s24
    v_lshl_add_u32 v3, v2, 2, v3
    buffer_load_dword v10, v1, s[8:11], 0 offen offset:0
    buffer_load_dword v11, v1, s[8:11], 0 offen offset:256
    buffer_load_dword v12, v1, s[8:11], 0 offen offset:512
    buffer_load_dword v13, v1, s[8:11], 0 offen offset:768
    buffer_load_dword v14, v1, s[8:11], 0 offen offset:1024
    ds_read_b32 v15, v3 offset:0
    ds_read_b32 v16, v3 offset:256
    ds_read_b32 v17, v3 offset:512
    ds_read_b32 v18, v3 offset:768
    ds_read_b32 v19, v3 offset:1024
    s_waitcnt vmcnt(0) lgkmcnt(0)
    v_lshlrev_b32 v20, 16, v10
    v_and_b32 v21, 0xffff0000, v10
    v_lshlrev_b32 v30, 16, v15
    v_and_b32 v31, 0xffff0000, v15
    v_lshlrev_b32 v22, 16, v11
    v_and_b32 v23, 0xffff0000, v11
    v_lshlrev_b32 v32, 16, v16
    v_and_b32 v33, 0xffff0000, v16
    v_lshlrev_b32 v24, 16, v12
    v_and_b32 v25, 0xffff0000, v12
    v_lshlrev_b32 v34, 16, v17
    v_and_b32 v35, 0xffff0000, v17
    v_lshlrev_b32 v26, 16, v13
    v_and_b32 v27, 0xffff0000, v13
    v_lshlrev_b32 v36, 16, v18
    v_and_b32 v37, 0xffff0000, v18
    v_lshlrev_b32 v28, 16, v14
    v_and_b32 v29, 0xffff0000, v14
    v_lshlrev_b32 v38, 16, v19
    v_and_b32 v39, 0xffff0000, v19
    v_add_f32 v50, v20, v21
    v_add_f32 v50, v22, v50
    v_add_f32 v50, v23, v50
    v_add_f32 v50, v24, v50
    v_add_f32 v50, v25, v50
    v_add_f32 v50, v26, v50
    v_add_f32 v50, v27, v50
    v_add_f32 v50, v28, v50
    v_add_f32 v50, v29, v50
    s_nop 1
    v_add_f32_dpp v50, v50, v50 quad_perm:[1,0,3,2] row_mask:0xf bank_mask:0xf
    s_nop 1
    v_add_f32_dpp v50, v50, v50 quad_perm:[2,3,0,1] row_mask:0xf bank_mask:0xf
    s_nop 1
    v_add_f32_dpp v50, v50, v50 row_half_mirror row_mask:0xf bank_mask:0xf
    s_nop 1
    v_add_f32_dpp v50, v50, v50 row_mirror row_mask:0xf bank_mask:0xf
    s_nop 1
    v_readlane_b32 s40, v50, 0
    v_readlane_b32 s41, v50, 16
    v_readlane_b32 s42, v50, 32
    v_readlane_b32 s43, v50, 48
    s_nop 1
    v_mov_b32 v50, s40
    v_add_f32 v50, s41, v50
    v_add_f32 v50, s42, v50
    v_add_f32 v50, s43, v50
    v_mul_f32 v50, 0x3acccccd, v50
    v_mov_b32 v51, 0
    v_sub_f32 v52, v20, v50
    v_fmac_f32 v51, v52, v52
    v_sub_f32 v52, v21, v50
    v_fmac_f32 v51, v52, v52
    v_sub_f32 v52, v22, v50
    v_fmac_f32 v51, v52, v52
    v_sub_f32 v52, v23, v50
    v_fmac_f32 v51, v52, v52
    v_sub_f32 v52, v24, v50
    v_fmac_f32 v51, v52, v52
    v_sub_f32 v52, v25, v50
    v_fmac_f32 v51, v52, v52
    v_sub_f32 v52, v26, v50
    v_fmac_f32 v51, v52, v52
    v_sub_f32 v52, v27, v50
    v_fmac_f32 v51, v52, v52
    v_sub_f32 v52, v28, v50
    v_fmac_f32 v51, v52, v52
    v_sub_f32 v52, v29, v50
    v_fmac_f32 v51, v52, v52
    s_nop 1
    v_add_f32_dpp v51, v51, v51 quad_perm:[1,0,3,2] row_mask:0xf bank_mask:0xf
    s_nop 1
    v_add_f32_dpp v51, v51, v51 quad_perm:[2,3,0,1] row_mask:0xf bank_mask:0xf
    s_nop 1
    v_add_f32_dpp v51, v51, v51 row_half_mirror row_mask:0xf bank_mask:0xf
    s_nop 1
    v_add_f32_dpp v51, v51, v51 row_mirror row_mask:0xf bank_mask:0xf
    s_nop 1
    v_readlane_b32 s40, v51, 0
    v_readlane_b32 s41, v51, 16
    v_readlane_b32 s42, v51, 32
    v_readlane_b32 s43, v51, 48
    s_nop 1
    v_mov_b32 v51, s40
    v_add_f32 v51, s41, v51
    v_add_f32 v51, s42, v51
    v_add_f32 v51, s43, v51
    v_mul_f32 v51, 0x3acccccd, v51
    v_cvt_pk_bf16_f32 v51, v51, v51
    v_lshlrev_b32 v51, 16, v51
    v_add_f32 v51, 0x3727c5ac, v51
    v_cvt_pk_bf16_f32 v51, v51, v51
    v_lshlrev_b32 v51, 16, v51
    v_sqrt_f32 v51, v51
    s_nop 0
    v_cvt_pk_bf16_f32 v51, v51, v51
    v_lshlrev_b32 v51, 16, v51
    v_rcp_f32 v51, v51
    v_cvt_pk_bf16_f32 v50, v50, v50
    v_lshlrev_b32 v50, 16, v50
    v_sub_f32 v40, v20, v50
    v_sub_f32 v41, v21, v50
    v_cvt_pk_bf16_f32 v52, v40, v41
    v_lshlrev_b32 v40, 16, v52
    v_and_b32 v41, 0xffff0000, v52
    v_mul_f32 v40, v40, v51
    v_mul_f32 v41, v41, v51
    v_cvt_pk_bf16_f32 v52, v40, v41
    v_lshlrev_b32 v40, 16, v52
    v_and_b32 v41, 0xffff0000, v52
    v_sub_f32 v42, v22, v50
    v_sub_f32 v43, v23, v50
    v_cvt_pk_bf16_f32 v52, v42, v43
    v_lshlrev_b32 v42, 16, v52
    v_and_b32 v43, 0xffff0000, v52
    v_mul_f32 v42, v42, v51
    v_mul_f32 v43, v43, v51
    v_cvt_pk_bf16_f32 v52, v42, v43
    v_lshlrev_b32 v42, 16, v52
    v_and_b32 v43, 0xffff0000, v52
    v_sub_f32 v44, v24, v50
    v_sub_f32 v45, v25, v50
    v_cvt_pk_bf16_f32 v52, v44, v45
    v_lshlrev_b32 v44, 16, v52
    v_and_b32 v45, 0xffff0000, v52
    v_mul_f32 v44, v44, v51
    v_mul_f32 v45, v45, v51
    v_cvt_pk_bf16_f32 v52, v44, v45
    v_lshlrev_b32 v44, 16, v52
    v_and_b32 v45, 0xffff0000, v52
    v_sub_f32 v46, v26, v50
    v_sub_f32 v47, v27, v50
    v_cvt_pk_bf16_f32 v52, v46, v47
    v_lshlrev_b32 v46, 16, v52
    v_and_b32 v47, 0xffff0000, v52
    v_mul_f32 v46, v46, v51
    v_mul_f32 v47, v47, v51
    v_cvt_pk_bf16_f32 v52, v46, v47
    v_lshlrev_b32 v46, 16, v52
    v_and_b32 v47, 0xffff0000, v52
    v_sub_f32 v48, v28, v50
    v_sub_f32 v49, v29, v50
    v_cvt_pk_bf16_f32 v52, v48, v49
    v_lshlrev_b32 v48, 16, v52
    v_and_b32 v49, 0xffff0000, v52
    v_mul_f32 v48, v48, v51
    v_mul_f32 v49, v49, v51
    v_cvt_pk_bf16_f32 v52, v48, v49
    v_lshlrev_b32 v48, 16, v52
    v_and_b32 v49, 0xffff0000, v52
    v_mul_f32 v40, v40, v30
    v_mul_f32 v41, v41, v31
    v_cvt_pk_bf16_f32 v52, v40, v41
    v_lshlrev_b32 v40, 16, v52
    v_and_b32 v41, 0xffff0000, v52
    v_add_f32 v20, v20, v40
    v_add_f32 v21, v21, v41
    v_cvt_pk_bf16_f32 v10, v20, v21
    v_lshlrev_b32 v20, 16, v10
    v_and_b32 v21, 0xffff0000, v10
    v_mul_f32 v42, v42, v32
    v_mul_f32 v43, v43, v33
    v_cvt_pk_bf16_f32 v52, v42, v43
    v_lshlrev_b32 v42, 16, v52
    v_and_b32 v43, 0xffff0000, v52
    v_add_f32 v22, v22, v42
    v_add_f32 v23, v23, v43
    v_cvt_pk_bf16_f32 v11, v22, v23
    v_lshlrev_b32 v22, 16, v11
    v_and_b32 v23, 0xffff0000, v11
    v_mul_f32 v44, v44, v34
    v_mul_f32 v45, v45, v35
    v_cvt_pk_bf16_f32 v52, v44, v45
    v_lshlrev_b32 v44, 16, v52
    v_and_b32 v45, 0xffff0000, v52
    v_add_f32 v24, v24, v44
    v_add_f32 v25, v25, v45
    v_cvt_pk_bf16_f32 v12, v24, v25
    v_lshlrev_b32 v24, 16, v12
    v_and_b32 v25, 0xffff0000, v12
    v_mul_f32 v46, v46, v36
    v_mul_f32 v47, v47, v37
    v_cvt_pk_bf16_f32 v52, v46, v47
    v_lshlrev_b32 v46, 16, v52
    v_and_b32 v47, 0xffff0000, v52
    v_add_f32 v26, v26, v46
    v_add_f32 v27, v27, v47
    v_cvt_pk_bf16_f32 v13, v26, v27
    v_lshlrev_b32 v26, 16, v13
    v_and_b32 v27, 0xffff0000, v13
    v_mul_f32 v48, v48, v38
    v_mul_f32 v49, v49, v39
    v_cvt_pk_bf16_f32 v52, v48, v49
    v_lshlrev_b32 v48, 16, v52
    v_and_b32 v49, 0xffff0000, v52
    v_add_f32 v28, v28, v48
    v_add_f32 v29, v29, v49
    v_cvt_pk_bf16_f32 v14, v28, v29
    v_lshlrev_b32 v28, 16, v14
    v_and_b32 v29, 0xffff0000, v14
    buffer_store_dword v10, v1, s[16:19], 0 offen offset:0
    buffer_store_dword v11, v1, s[16:19], 0 offen offset:256
    buffer_store_dword v12, v1, s[16:19], 0 offen offset:512
    buffer_store_dword v13, v1, s[16:19], 0 offen offset:768
    buffer_store_dword v14, v1, s[16:19], 0 offen offset:1024
    v_add_f32 v50, v20, v21
    v_add_f32 v50, v22, v50
    v_add_f32 v50, v23, v50
    v_add_f32 v50, v24, v50
    v_add_f32 v50, v25, v50
    v_add_f32 v50, v26, v50
    v_add_f32 v50, v27, v50
    v_add_f32 v50, v28, v50
    v_add_f32 v50, v29, v50
    s_nop 1
    v_add_f32_dpp v50, v50, v50 quad_perm:[1,0,3,2] row_mask:0xf bank_mask:0xf
    s_nop 1
    v_add_f32_dpp v50, v50, v50 quad_perm:[2,3,0,1] row_mask:0xf bank_mask:0xf
    s_nop 1
    v_add_f32_dpp v50, v50, v50 row_half_mirror row_mask:0xf bank_mask:0xf
    s_nop 1
    v_add_f32_dpp v50, v50, v50 row_mirror row_mask:0xf bank_mask:0xf
    s_nop 1
    v_readlane_b32 s40, v50, 0
    v_readlane_b32 s41, v50, 16
    v_readlane_b32 s42, v50, 32
    v_readlane_b32 s43, v50, 48
    s_nop 1
    v_mov_b32 v50, s40
    v_add_f32 v50, s41, v50
    v_add_f32 v50, s42, v50
    v_add_f32 v50, s43, v50
    v_mul_f32 v50, 0x3acccccd, v50
    v_mov_b32 v51, 0
    v_sub_f32 v52, v20, v50
    v_fmac_f32 v51, v52, v52
    v_sub_f32 v52, v21, v50
    v_fmac_f32 v51, v52, v52
    v_sub_f32 v52, v22, v50
    v_fmac_f32 v51, v52, v52
    v_sub_f32 v52, v23, v50
    v_fmac_f32 v51, v52, v52
    v_sub_f32 v52, v24, v50
    v_fmac_f32 v51, v52, v52
    v_sub_f32 v52, v25, v50
    v_fmac_f32 v51, v52, v52
    v_sub_f32 v52, v26, v50
    v_fmac_f32 v51, v52, v52
    v_sub_f32 v52, v27, v50
    v_fmac_f32 v51, v52, v52
    v_sub_f32 v52, v28, v50
    v_fmac_f32 v51, v52, v52
    v_sub_f32 v52, v29, v50
    v_fmac_f32 v51, v52, v52
    s_nop 1
    v_add_f32_dpp v51, v51, v51 quad_perm:[1,0,3,2] row_mask:0xf bank_mask:0xf
    s_nop 1
    v_add_f32_dpp v51, v51, v51 quad_perm:[2,3,0,1] row_mask:0xf bank_mask:0xf
    s_nop 1
    v_add_f32_dpp v51, v51, v51 row_half_mirror row_mask:0xf bank_mask:0xf
    s_nop 1
    v_add_f32_dpp v51, v51, v51 row_mirror row_mask:0xf bank_mask:0xf
    s_nop 1
    v_readlane_b32 s40, v51, 0
    v_readlane_b32 s41, v51, 16
    v_readlane_b32 s42, v51, 32
    v_readlane_b32 s43, v51, 48
    s_nop 1
    v_mov_b32 v51, s40
    v_add_f32 v51, s41, v51
    v_add_f32 v51, s42, v51
    v_add_f32 v51, s43, v51
    v_mul_f32 v51, 0x3acccccd, v51
    v_cvt_pk_bf16_f32 v51, v51, v51
    v_lshlrev_b32 v51, 16, v51
    v_add_f32 v51, 0x3727c5ac, v51
    v_cvt_pk_bf16_f32 v51, v51, v51
    v_lshlrev_b32 v51, 16, v51
    v_sqrt_f32 v51, v51
    s_nop 0
    v_cvt_pk_bf16_f32 v51, v51, v51
    v_lshlrev_b32 v51, 16, v51
    v_rcp_f32 v51, v51
    v_cvt_pk_bf16_f32 v50, v50, v50
    v_lshlrev_b32 v50, 16, v50
    v_sub_f32 v40, v20, v50
    v_sub_f32 v41, v21, v50
    v_cvt_pk_bf16_f32 v52, v40, v41
    v_lshlrev_b32 v40, 16, v52
    v_and_b32 v41, 0xffff0000, v52
    v_mul_f32 v40, v40, v51
    v_mul_f32 v41, v41, v51
    v_cvt_pk_bf16_f32 v52, v40, v41
    v_lshlrev_b32 v40, 16, v52
    v_and_b32 v41, 0xffff0000, v52
    v_sub_f32 v42, v22, v50
    v_sub_f32 v43, v23, v50
    v_cvt_pk_bf16_f32 v52, v42, v43
    v_lshlrev_b32 v42, 16, v52
    v_and_b32 v43, 0xffff0000, v52
    v_mul_f32 v42, v42, v51
    v_mul_f32 v43, v43, v51
    v_cvt_pk_bf16_f32 v52, v42, v43
    v_lshlrev_b32 v42, 16, v52
    v_and_b32 v43, 0xffff0000, v52
    v_sub_f32 v44, v24, v50
    v_sub_f32 v45, v25, v50
    v_cvt_pk_bf16_f32 v52, v44, v45
    v_lshlrev_b32 v44, 16, v52
    v_and_b32 v45, 0xffff0000, v52
    v_mul_f32 v44, v44, v51
    v_mul_f32 v45, v45, v51
    v_cvt_pk_bf16_f32 v52, v44, v45
    v_lshlrev_b32 v44, 16, v52
    v_and_b32 v45, 0xffff0000, v52
    v_sub_f32 v46, v26, v50
    v_sub_f32 v47, v27, v50
    v_cvt_pk_bf16_f32 v52, v46, v47
    v_lshlrev_b32 v46, 16, v52
    v_and_b32 v47, 0xffff0000, v52
    v_mul_f32 v46, v46, v51
    v_mul_f32 v47, v47, v51
    v_cvt_pk_bf16_f32 v52, v46, v47
    v_lshlrev_b32 v46, 16, v52
    v_and_b32 v47, 0xffff0000, v52
    v_sub_f32 v48, v28, v50
    v_sub_f32 v49, v29, v50
    v_cvt_pk_bf16_f32 v52, v48, v49
    v_lshlrev_b32 v48, 16, v52
    v_and_b32 v49, 0xffff0000, v52
    v_mul_f32 v48, v48, v51
    v_mul_f32 v49, v49, v51
    v_cvt_pk_bf16_f32 v52, v48, v49
    v_lshlrev_b32 v48, 16, v52
    v_and_b32 v49, 0xffff0000, v52
    v_cvt_pk_bf16_f32 v60, v40, v41
    v_cvt_pk_bf16_f32 v61, v42, v43
    v_cvt_pk_bf16_f32 v62, v44, v45
    v_cvt_pk_bf16_f32 v63, v46, v47
    v_cvt_pk_bf16_f32 v64, v48, v49
    buffer_store_dword v60, v1, s[20:23], 0 offen offset:0
    buffer_store_dword v61, v1, s[20:23], 0 offen offset:256
    buffer_store_dword v62, v1, s[20:23], 0 offen offset:512
    buffer_store_dword v63, v1, s[20:23], 0 offen offset:768
    buffer_store_dword v64, v1, s[20:23], 0 offen offset:1024
    v_add_u32 v1, 1280, v1
LN_END_lnb_kernel:
    s_endpgm
.globl g1_kernel
.p2align 8
.type g1_kernel,@function
g1_kernel:
    s_cmp_ge_u32 s2, 432
    s_cbranch_scc1 GEMM_END_g1_kernel
    s_load_dwordx4 s[4:7], s[0:1], 56
    s_load_dwordx4 s[8:11], s[0:1], 72
    s_load_dwordx2 s[12:13], s[0:1], 96
    s_and_b32 s14, s2, 15
    s_lshr_b32 s15, s2, 4
    s_waitcnt lgkmcnt(0)
    s_add_u32 s16, s12, 5242880
    s_addc_u32 s17, s13, 0
    s_mov_b32 s18, 2621440
    s_mov_b32 s19, 0x00020000
    s_mov_b32 s20, s4
    s_mov_b32 s21, s5
    s_mov_b32 s22, 2211840
    s_mov_b32 s23, 0x00020000
    s_mov_b32 s24, s6
    s_mov_b32 s25, s7
    s_mov_b32 s26, 2211840
    s_mov_b32 s27, 0x00020000
    s_add_u32 s28, s12, 10485760
    s_addc_u32 s29, s13, 0
    s_mov_b32 s30, 7077888
    s_mov_b32 s31, 0x00020000
    v_lshrrev_b32 v18, 6, v0
    s_nop 0
    v_readfirstlane_b32 s40, v18
    v_and_b32 v19, 63, v0
    v_lshrrev_b32 v1, 3, v19
    v_and_b32 v2, 7, v0
    v_xor_b32 v4, v2, v1
    v_lshlrev_b32 v4, 4, v4
    s_lshl_b32 s32, s14, 7
    v_lshl_add_u32 v3, v18, 5, v1
    v_add_u32 v3, s32, v3
    s_movk_i32 s33, 1280
    v_mul_lo_u32 v3, v3, s33
    v_add_u32 v3, v3, v4
    v_bfe_u32 v4, v1, 1, 1
    v_lshlrev_b32 v4, 2, v4
    v_xor_b32 v4, v2, v4
    v_lshlrev_b32 v4, 4, v4
    v_lshl_add_u32 v7, v18, 4, v1
    s_movk_i32 s33, 3456
    v_mul_lo_u32 v7, v7, s33
    v_add_u32 v7, v7, v4
    s_lshl_b32 s32, s15, 7
    v_add_u32 v7, s32, v7
    s_lshl_b32 s41, s40, 12
    s_lshl_b32 s42, s40, 11
    s_add_u32 s42, s42, 16384
    v_lshrrev_b32 v11, 6, v0
    v_and_b32 v12, 1, v11
    v_lshrrev_b32 v11, 1, v11
    v_and_b32 v13, 31, v0
    v_bfe_u32 v14, v0, 5, 1
    v_lshl_add_u32 v15, v11, 6, v13
    v_and_b32 v17, 7, v15
    v_lshlrev_b32 v15, 7, v15
    v_add_u32 v18, 0, v14
    v_xor_b32 v18, v18, v17
    v_lshl_add_u32 v24, v18, 4, v15
    v_add_u32 v18, 2, v14
    v_xor_b32 v18, v18, v17
    v_lshl_add_u32 v25, v18, 4, v15
    v_add_u32 v18, 4, v14
    v_xor_b32 v18, v18, v17
    v_lshl_add_u32 v26, v18, 4, v15
    v_add_u32 v18, 6, v14
    v_xor_b32 v18, v18, v17
    v_lshl_add_u32 v27, v18, 4, v15
    v_bfe_u32 v16, v0, 2, 2
    v_lshl_add_u32 v16, v14, 3, v16
    v_lshlrev_b32 v16, 7, v16
    v_lshlrev_b32 v17, 6, v12
    v_add_u32 v16, v16, v17
    v_bfe_u32 v17, v0, 4, 1
    v_lshl_add_u32 v16, v17, 5, v16
    v_and_b32 v17, 3, v0
    v_lshl_add_u32 v16, v17, 3, v16
    v_add_u32 v16, 16384, v16
    v_bfe_u32 v17, v0, 3, 1
    v_lshlrev_b32 v17, 6, v17
    v_xor_b32 v16, v16, v17
    v_mov_b32 v96, 0
    v_mov_b32 v97, 0
    v_mov_b32 v98, 0
    v_mov_b32 v99, 0
    v_mov_b32 v100, 0
    v_mov_b32 v101, 0
    v_mov_b32 v102, 0
    v_mov_b32 v103, 0
    v_mov_b32 v104, 0
    v_mov_b32 v105, 0
    v_mov_b32 v106, 0
    v_mov_b32 v107, 0
    v_mov_b32 v108, 0
    v_mov_b32 v109, 0
    v_mov_b32 v110, 0
    v_mov_b32 v111, 0
    v_mov_b32 v112, 0
    v_mov_b32 v113, 0
    v_mov_b32 v114, 0
    v_mov_b32 v115, 0
    v_mov_b32 v116, 0
    v_mov_b32 v117, 0
    v_mov_b32 v118, 0
    v_mov_b32 v119, 0
    v_mov_b32 v120, 0
    v_mov_b32 v121, 0
    v_mov_b32 v122, 0
    v_mov_b32 v123, 0
    v_mov_b32 v124, 0
    v_mov_b32 v125, 0
    v_mov_b32 v126, 0
    v_mov_b32 v127, 0
    v_mov_b32 v128, 0
    v_mov_b32 v129, 0
    v_mov_b32 v130, 0
    v_mov_b32 v131, 0
    v_mov_b32 v132, 0
    v_mov_b32 v133, 0
    v_mov_b32 v134, 0
    v_mov_b32 v135, 0
    v_mov_b32 v136, 0
    v_mov_b32 v137, 0
    v_mov_b32 v138, 0
    v_mov_b32 v139, 0
    v_mov_b32 v140, 0
    v_mov_b32 v141, 0
    v_mov_b32 v142, 0
    v_mov_b32 v143, 0
    v_mov_b32 v144, 0
    v_mov_b32 v145, 0
    v_mov_b32 v146, 0
    v_mov_b32 v147, 0
    v_mov_b32 v148, 0
    v_mov_b32 v149, 0
    v_mov_b32 v150, 0
    v_mov_b32 v151, 0
    v_mov_b32 v152, 0
    v_mov_b32 v153, 0
    v_mov_b32 v154, 0
    v_mov_b32 v155, 0
    v_mov_b32 v156, 0
    v_mov_b32 v157, 0
    v_mov_b32 v158, 0
    v_mov_b32 v159, 0
    s_mov_b32 s34, 0
    s_add_u32 m0, s41, 0
    s_mov_b32 s35, 0
    buffer_load_dwordx4 v3, s[16:19], s35 offen lds
    s_add_u32 m0, s41, 1024
    s_mov_b32 s35, 10240
    buffer_load_dwordx4 v3, s[16:19], s35 offen lds
    s_add_u32 m0, s41, 2048
    s_mov_b32 s35, 20480
    buffer_load_dwordx4 v3, s[16:19], s35 offen lds
    s_add_u32 m0, s41, 3072
    s_mov_b32 s35, 30720
    buffer_load_dwordx4 v3, s[16:19], s35 offen lds
    s_add_u32 m0, s42, 0
    s_mov_b32 s35, 0
    buffer_load_dwordx4 v7, s[20:23], s35 offen lds
    s_add_u32 m0, s42, 1024
    s_mov_b32 s35, 27648
    buffer_load_dwordx4 v7, s[20:23], s35 offen lds
    s_add_u32 m0, s42, 8192
    s_mov_b32 s35, 0
    buffer_load_dwordx4 v7, s[24:27], s35 offen lds
    s_add_u32 m0, s42, 9216
    s_mov_b32 s35, 27648
    buffer_load_dwordx4 v7, s[24:27], s35 offen lds
    s_waitcnt vmcnt(0)
    s_barrier
    s_add_u32 m0, s41, 32768
    s_mov_b32 s35, 128
    buffer_load_dwordx4 v3, s[16:19], s35 offen lds
    s_add_u32 m0, s41, 33792
    s_mov_b32 s35, 10368
    buffer_load_dwordx4 v3, s[16:19], s35 offen lds
    s_add_u32 m0, s41, 34816
    s_mov_b32 s35, 20608
    buffer_load_dwordx4 v3, s[16:19], s35 offen lds
    s_add_u32 m0, s41, 35840
    s_mov_b32 s35, 30848
    buffer_load_dwordx4 v3, s[16:19], s35 offen lds
    s_add_u32 m0, s42, 32768
    s_mov_b32 s35, 221184
    buffer_load_dwordx4 v7, s[20:23], s35 offen lds
    s_add_u32 m0, s42, 33792
    s_mov_b32 s35, 248832
    buffer_load_dwordx4 v7, s[20:23], s35 offen lds
    s_add_u32 m0, s42, 40960
    s_mov_b32 s35, 221184
    buffer_load_dwordx4 v7, s[24:27], s35 offen lds
    s_add_u32 m0, s42, 41984
    s_mov_b32 s35, 248832
    buffer_load_dwordx4 v7, s[24:27], s35 offen lds
    ds_read_b128 v[64:67], v24 offset:0
    ds_read_b128 v[68:71], v24 offset:4096
    ds_read_b64_tr_b16 v[72:73], v16 offset:0
    ds_read_b64_tr_b16 v[74:75], v16 offset:512
    ds_read_b64_tr_b16 v[76:77], v16 offset:8192
    ds_read_b64_tr_b16 v[78:79], v16 offset:8704
    ds_read_b128 v[80:83], v25 offset:0
    ds_read_b128 v[84:87], v25 offset:4096
    ds_read_b64_tr_b16 v[88:89], v16 offset:2048
    ds_read_b64_tr_b16 v[90:91], v16 offset:2560
    ds_read_b64_tr_b16 v[92:93], v16 offset:10240
    ds_read_b64_tr_b16 v[94:95], v16 offset:10752
    s_waitcnt lgkmcnt(6)
    v_mfma_f32_32x32x16_bf16 v[96:111], v[72:75], v[64:67], v[96:111]
    v_mfma_f32_32x32x16_bf16 v[112:127], v[72:75], v[68:71], v[112:127]
    v_mfma_f32_32x32x16_bf16 v[128:143], v[76:79], v[64:67], v[128:143]
    v_mfma_f32_32x32x16_bf16 v[144:159], v[76:79], v[68:71], v[144:159]
    ds_read_b128 v[64:67], v26 offset:0
    ds_read_b128 v[68:71], v26 offset:4096
    ds_read_b64_tr_b16 v[72:73], v16 offset:4096
    ds_read_b64_tr_b16 v[74:75], v16 offset:4608
    ds_read_b64_tr_b16 v[76:77], v16 offset:12288
    ds_read_b64_tr_b16 v[78:79], v16 offset:12800
    s_waitcnt lgkmcnt(6)
    v_mfma_f32_32x32x16_bf16 v[96:111], v[88:91], v[80:83], v[96:111]
    v_mfma_f32_32x32x16_bf16 v[112:127], v[88:91], v[84:87], v[112:127]
    v_mfma_f32_32x32x16_bf16 v[128:143], v[92:95], v[80:83], v[128:143]
    v_mfma_f32_32x32x16_bf16 v[144:159], v[92:95], v[84:87], v[144:159]
    ds_read_b128 v[80:83], v27 offset:0
    ds_read_b128 v[84:87], v27 offset:4096
    ds_read_b64_tr_b16 v[88:89], v16 offset:6144
    ds_read_b64_tr_b16 v[90:91], v16 offset:6656
    ds_read_b64_tr_b16 v[92:93], v16 offset:14336
    ds_read_b64_tr_b16 v[94:95], v16 offset:14848
    s_waitcnt lgkmcnt(6)
    v_mfma_f32_32x32x16_bf16 v[96:111], v[72:75], v[64:67], v[96:111]
    v_mfma_f32_32x32x16_bf16 v[112:127], v[72:75], v[68:71], v[112:127]
    v_mfma_f32_32x32x16_bf16 v[128:143], v[76:79], v[64:67], v[128:143]
    v_mfma_f32_32x32x16_bf16 v[144:159], v[76:79], v[68:71], v[144:159]
    s_waitcnt lgkmcnt(0)
    v_mfma_f32_32x32x16_bf16 v[96:111], v[88:91], v[80:83], v[96:111]
    v_mfma_f32_32x32x16_bf16 v[112:127], v[88:91], v[84:87], v[112:127]
    v_mfma_f32_32x32x16_bf16 v[128:143], v[92:95], v[80:83], v[128:143]
    v_mfma_f32_32x32x16_bf16 v[144:159], v[92:95], v[84:87], v[144:159]
    s_waitcnt vmcnt(0)
    s_barrier
    s_add_u32 m0, s41, 0
    s_mov_b32 s35, 256
    buffer_load_dwordx4 v3, s[16:19], s35 offen lds
    s_add_u32 m0, s41, 1024
    s_mov_b32 s35, 10496
    buffer_load_dwordx4 v3, s[16:19], s35 offen lds
    s_add_u32 m0, s41, 2048
    s_mov_b32 s35, 20736
    buffer_load_dwordx4 v3, s[16:19], s35 offen lds
    s_add_u32 m0, s41, 3072
    s_mov_b32 s35, 30976
    buffer_load_dwordx4 v3, s[16:19], s35 offen lds
    s_add_u32 m0, s42, 0
    s_mov_b32 s35, 442368
    buffer_load_dwordx4 v7, s[20:23], s35 offen lds
    s_add_u32 m0, s42, 1024
    s_mov_b32 s35, 470016
    buffer_load_dwordx4 v7, s[20:23], s35 offen lds
    s_add_u32 m0, s42, 8192
    s_mov_b32 s35, 442368
    buffer_load_dwordx4 v7, s[24:27], s35 offen lds
    s_add_u32 m0, s42, 9216
    s_mov_b32 s35, 470016
    buffer_load_dwordx4 v7, s[24:27], s35 offen lds
    ds_read_b128 v[64:67], v24 offset:32768
    ds_read_b128 v[68:71], v24 offset:36864
    ds_read_b64_tr_b16 v[72:73], v16 offset:32768
    ds_read_b64_tr_b16 v[74:75], v16 offset:33280
    ds_read_b64_tr_b16 v[76:77], v16 offset:40960
    ds_read_b64_tr_b16 v[78:79], v16 offset:41472
    ds_read_b128 v[80:83], v25 offset:32768
    ds_read_b128 v[84:87], v25 offset:36864
    ds_read_b64_tr_b16 v[88:89], v16 offset:34816
    ds_read_b64_tr_b16 v[90:91], v16 offset:35328
    ds_read_b64_tr_b16 v[92:93], v16 offset:43008
    ds_read_b64_tr_b16 v[94:95], v16 offset:43520
    s_waitcnt lgkmcnt(6)
    v_mfma_f32_32x32x16_bf16 v[96:111], v[72:75], v[64:67], v[96:111]
    v_mfma_f32_32x32x16_bf16 v[112:127], v[72:75], v[68:71], v[112:127]
    v_mfma_f32_32x32x16_bf16 v[128:143], v[76:79], v[64:67], v[128:143]
    v_mfma_f32_32x32x16_bf16 v[144:159], v[76:79], v[68:71], v[144:159]
    ds_read_b128 v[64:67], v26 offset:32768
    ds_read_b128 v[68:71], v26 offset:36864
    ds_read_b64_tr_b16 v[72:73], v16 offset:36864
    ds_read_b64_tr_b16 v[74:75], v16 offset:37376
    ds_read_b64_tr_b16 v[76:77], v16 offset:45056
    ds_read_b64_tr_b16 v[78:79], v16 offset:45568
    s_waitcnt lgkmcnt(6)
    v_mfma_f32_32x32x16_bf16 v[96:111], v[88:91], v[80:83], v[96:111]
    v_mfma_f32_32x32x16_bf16 v[112:127], v[88:91], v[84:87], v[112:127]
    v_mfma_f32_32x32x16_bf16 v[128:143], v[92:95], v[80:83], v[128:143]
    v_mfma_f32_32x32x16_bf16 v[144:159], v[92:95], v[84:87], v[144:159]
    ds_read_b128 v[80:83], v27 offset:32768
    ds_read_b128 v[84:87], v27 offset:36864
    ds_read_b64_tr_b16 v[88:89], v16 offset:38912
    ds_read_b64_tr_b16 v[90:91], v16 offset:39424
    ds_read_b64_tr_b16 v[92:93], v16 offset:47104
    ds_read_b64_tr_b16 v[94:95], v16 offset:47616
    s_waitcnt lgkmcnt(6)
    v_mfma_f32_32x32x16_bf16 v[96:111], v[72:75], v[64:67], v[96:111]
    v_mfma_f32_32x32x16_bf16 v[112:127], v[72:75], v[68:71], v[112:127]
    v_mfma_f32_32x32x16_bf16 v[128:143], v[76:79], v[64:67], v[128:143]
    v_mfma_f32_32x32x16_bf16 v[144:159], v[76:79], v[68:71], v[144:159]
    s_waitcnt lgkmcnt(0)
    v_mfma_f32_32x32x16_bf16 v[96:111], v[88:91], v[80:83], v[96:111]
    v_mfma_f32_32x32x16_bf16 v[112:127], v[88:91], v[84:87], v[112:127]
    v_mfma_f32_32x32x16_bf16 v[128:143], v[92:95], v[80:83], v[128:143]
    v_mfma_f32_32x32x16_bf16 v[144:159], v[92:95], v[84:87], v[144:159]
    s_waitcnt vmcnt(0)
    s_barrier
    s_add_u32 m0, s41, 32768
    s_mov_b32 s35, 384
    buffer_load_dwordx4 v3, s[16:19], s35 offen lds
    s_add_u32 m0, s41, 33792
    s_mov_b32 s35, 10624
    buffer_load_dwordx4 v3, s[16:19], s35 offen lds
    s_add_u32 m0, s41, 34816
    s_mov_b32 s35, 20864
    buffer_load_dwordx4 v3, s[16:19], s35 offen lds
    s_add_u32 m0, s41, 35840
    s_mov_b32 s35, 31104
    buffer_load_dwordx4 v3, s[16:19], s35 offen lds
    s_add_u32 m0, s42, 32768
    s_mov_b32 s35, 663552
    buffer_load_dwordx4 v7, s[20:23], s35 offen lds
    s_add_u32 m0, s42, 33792
    s_mov_b32 s35, 691200
    buffer_load_dwordx4 v7, s[20:23], s35 offen lds
    s_add_u32 m0, s42, 40960
    s_mov_b32 s35, 663552
    buffer_load_dwordx4 v7, s[24:27], s35 offen lds
    s_add_u32 m0, s42, 41984
    s_mov_b32 s35, 691200
    buffer_load_dwordx4 v7, s[24:27], s35 offen lds
    ds_read_b128 v[64:67], v24 offset:0
    ds_read_b128 v[68:71], v24 offset:4096
    ds_read_b64_tr_b16 v[72:73], v16 offset:0
    ds_read_b64_tr_b16 v[74:75], v16 offset:512
    ds_read_b64_tr_b16 v[76:77], v16 offset:8192
    ds_read_b64_tr_b16 v[78:79], v16 offset:8704
    ds_read_b128 v[80:83], v25 offset:0
    ds_read_b128 v[84:87], v25 offset:4096
    ds_read_b64_tr_b16 v[88:89], v16 offset:2048
    ds_read_b64_tr_b16 v[90:91], v16 offset:2560
    ds_read_b64_tr_b16 v[92:93], v16 offset:10240
    ds_read_b64_tr_b16 v[94:95], v16 offset:10752
    s_waitcnt lgkmcnt(6)
    v_mfma_f32_32x32x16_bf16 v[96:111], v[72:75], v[64:67], v[96:111]
    v_mfma_f32_32x32x16_bf16 v[112:127], v[72:75], v[68:71], v[112:127]
    v_mfma_f32_32x32x16_bf16 v[128:143], v[76:79], v[64:67], v[128:143]
    v_mfma_f32_32x32x16_bf16 v[144:159], v[76:79], v[68:71], v[144:159]
    ds_read_b128 v[64:67], v26 offset:0
    ds_read_b128 v[68:71], v26 offset:4096
    ds_read_b64_tr_b16 v[72:73], v16 offset:4096
    ds_read_b64_tr_b16 v[74:75], v16 offset:4608
    ds_read_b64_tr_b16 v[76:77], v16 offset:12288
    ds_read_b64_tr_b16 v[78:79], v16 offset:12800
    s_waitcnt lgkmcnt(6)
    v_mfma_f32_32x32x16_bf16 v[96:111], v[88:91], v[80:83], v[96:111]
    v_mfma_f32_32x32x16_bf16 v[112:127], v[88:91], v[84:87], v[112:127]
    v_mfma_f32_32x32x16_bf16 v[128:143], v[92:95], v[80:83], v[128:143]
    v_mfma_f32_32x32x16_bf16 v[144:159], v[92:95], v[84:87], v[144:159]
    ds_read_b128 v[80:83], v27 offset:0
    ds_read_b128 v[84:87], v27 offset:4096
    ds_read_b64_tr_b16 v[88:89], v16 offset:6144
    ds_read_b64_tr_b16 v[90:91], v16 offset:6656
    ds_read_b64_tr_b16 v[92:93], v16 offset:14336
    ds_read_b64_tr_b16 v[94:95], v16 offset:14848
    s_waitcnt lgkmcnt(6)
    v_mfma_f32_32x32x16_bf16 v[96:111], v[72:75], v[64:67], v[96:111]
    v_mfma_f32_32x32x16_bf16 v[112:127], v[72:75], v[68:71], v[112:127]
    v_mfma_f32_32x32x16_bf16 v[128:143], v[76:79], v[64:67], v[128:143]
    v_mfma_f32_32x32x16_bf16 v[144:159], v[76:79], v[68:71], v[144:159]
    s_waitcnt lgkmcnt(0)
    v_mfma_f32_32x32x16_bf16 v[96:111], v[88:91], v[80:83], v[96:111]
    v_mfma_f32_32x32x16_bf16 v[112:127], v[88:91], v[84:87], v[112:127]
    v_mfma_f32_32x32x16_bf16 v[128:143], v[92:95], v[80:83], v[128:143]
    v_mfma_f32_32x32x16_bf16 v[144:159], v[92:95], v[84:87], v[144:159]
    s_waitcnt vmcnt(0)
    s_barrier
    s_add_u32 m0, s41, 0
    s_mov_b32 s35, 512
    buffer_load_dwordx4 v3, s[16:19], s35 offen lds
    s_add_u32 m0, s41, 1024
    s_mov_b32 s35, 10752
    buffer_load_dwordx4 v3, s[16:19], s35 offen lds
    s_add_u32 m0, s41, 2048
    s_mov_b32 s35, 20992
    buffer_load_dwordx4 v3, s[16:19], s35 offen lds
    s_add_u32 m0, s41, 3072
    s_mov_b32 s35, 31232
    buffer_load_dwordx4 v3, s[16:19], s35 offen lds
    s_add_u32 m0, s42, 0
    s_mov_b32 s35, 884736
    buffer_load_dwordx4 v7, s[20:23], s35 offen lds
    s_add_u32 m0, s42, 1024
    s_mov_b32 s35, 912384
    buffer_load_dwordx4 v7, s[20:23], s35 offen lds
    s_add_u32 m0, s42, 8192
    s_mov_b32 s35, 884736
    buffer_load_dwordx4 v7, s[24:27], s35 offen lds
    s_add_u32 m0, s42, 9216
    s_mov_b32 s35, 912384
    buffer_load_dwordx4 v7, s[24:27], s35 offen lds
    ds_read_b128 v[64:67], v24 offset:32768
    ds_read_b128 v[68:71], v24 offset:36864
    ds_read_b64_tr_b16 v[72:73], v16 offset:32768
    ds_read_b64_tr_b16 v[74:75], v16 offset:33280
    ds_read_b64_tr_b16 v[76:77], v16 offset:40960
    ds_read_b64_tr_b16 v[78:79], v16 offset:41472
    ds_read_b128 v[80:83], v25 offset:32768
    ds_read_b128 v[84:87], v25 offset:36864
    ds_read_b64_tr_b16 v[88:89], v16 offset:34816
    ds_read_b64_tr_b16 v[90:91], v16 offset:35328
    ds_read_b64_tr_b16 v[92:93], v16 offset:43008
    ds_read_b64_tr_b16 v[94:95], v16 offset:43520
    s_waitcnt lgkmcnt(6)
    v_mfma_f32_32x32x16_bf16 v[96:111], v[72:75], v[64:67], v[96:111]
    v_mfma_f32_32x32x16_bf16 v[112:127], v[72:75], v[68:71], v[112:127]
    v_mfma_f32_32x32x16_bf16 v[128:143], v[76:79], v[64:67], v[128:143]
    v_mfma_f32_32x32x16_bf16 v[144:159], v[76:79], v[68:71], v[144:159]
    ds_read_b128 v[64:67], v26 offset:32768
    ds_read_b128 v[68:71], v26 offset:36864
    ds_read_b64_tr_b16 v[72:73], v16 offset:36864
    ds_read_b64_tr_b16 v[74:75], v16 offset:37376
    ds_read_b64_tr_b16 v[76:77], v16 offset:45056
    ds_read_b64_tr_b16 v[78:79], v16 offset:45568
    s_waitcnt lgkmcnt(6)
    v_mfma_f32_32x32x16_bf16 v[96:111], v[88:91], v[80:83], v[96:111]
    v_mfma_f32_32x32x16_bf16 v[112:127], v[88:91], v[84:87], v[112:127]
    v_mfma_f32_32x32x16_bf16 v[128:143], v[92:95], v[80:83], v[128:143]
    v_mfma_f32_32x32x16_bf16 v[144:159], v[92:95], v[84:87], v[144:159]
    ds_read_b128 v[80:83], v27 offset:32768
    ds_read_b128 v[84:87], v27 offset:36864
    ds_read_b64_tr_b16 v[88:89], v16 offset:38912
    ds_read_b64_tr_b16 v[90:91], v16 offset:39424
    ds_read_b64_tr_b16 v[92:93], v16 offset:47104
    ds_read_b64_tr_b16 v[94:95], v16 offset:47616
    s_waitcnt lgkmcnt(6)
    v_mfma_f32_32x32x16_bf16 v[96:111], v[72:75], v[64:67], v[96:111]
    v_mfma_f32_32x32x16_bf16 v[112:127], v[72:75], v[68:71], v[112:127]
    v_mfma_f32_32x32x16_bf16 v[128:143], v[76:79], v[64:67], v[128:143]
    v_mfma_f32_32x32x16_bf16 v[144:159], v[76:79], v[68:71], v[144:159]
    s_waitcnt lgkmcnt(0)
    v_mfma_f32_32x32x16_bf16 v[96:111], v[88:91], v[80:83], v[96:111]
    v_mfma_f32_32x32x16_bf16 v[112:127], v[88:91], v[84:87], v[112:127]
    v_mfma_f32_32x32x16_bf16 v[128:143], v[92:95], v[80:83], v[128:143]
    v_mfma_f32_32x32x16_bf16 v[144:159], v[92:95], v[84:87], v[144:159]
    s_waitcnt vmcnt(0)
    s_barrier
    s_add_u32 m0, s41, 32768
    s_mov_b32 s35, 640
    buffer_load_dwordx4 v3, s[16:19], s35 offen lds
    s_add_u32 m0, s41, 33792
    s_mov_b32 s35, 10880
    buffer_load_dwordx4 v3, s[16:19], s35 offen lds
    s_add_u32 m0, s41, 34816
    s_mov_b32 s35, 21120
    buffer_load_dwordx4 v3, s[16:19], s35 offen lds
    s_add_u32 m0, s41, 35840
    s_mov_b32 s35, 31360
    buffer_load_dwordx4 v3, s[16:19], s35 offen lds
    s_add_u32 m0, s42, 32768
    s_mov_b32 s35, 1105920
    buffer_load_dwordx4 v7, s[20:23], s35 offen lds
    s_add_u32 m0, s42, 33792
    s_mov_b32 s35, 1133568
    buffer_load_dwordx4 v7, s[20:23], s35 offen lds
    s_add_u32 m0, s42, 40960
    s_mov_b32 s35, 1105920
    buffer_load_dwordx4 v7, s[24:27], s35 offen lds
    s_add_u32 m0, s42, 41984
    s_mov_b32 s35, 1133568
    buffer_load_dwordx4 v7, s[24:27], s35 offen lds
    ds_read_b128 v[64:67], v24 offset:0
    ds_read_b128 v[68:71], v24 offset:4096
    ds_read_b64_tr_b16 v[72:73], v16 offset:0
    ds_read_b64_tr_b16 v[74:75], v16 offset:512
    ds_read_b64_tr_b16 v[76:77], v16 offset:8192
    ds_read_b64_tr_b16 v[78:79], v16 offset:8704
    ds_read_b128 v[80:83], v25 offset:0
    ds_read_b128 v[84:87], v25 offset:4096
    ds_read_b64_tr_b16 v[88:89], v16 offset:2048
    ds_read_b64_tr_b16 v[90:91], v16 offset:2560
    ds_read_b64_tr_b16 v[92:93], v16 offset:10240
    ds_read_b64_tr_b16 v[94:95], v16 offset:10752
    s_waitcnt lgkmcnt(6)
    v_mfma_f32_32x32x16_bf16 v[96:111], v[72:75], v[64:67], v[96:111]
    v_mfma_f32_32x32x16_bf16 v[112:127], v[72:75], v[68:71], v[112:127]
    v_mfma_f32_32x32x16_bf16 v[128:143], v[76:79], v[64:67], v[128:143]
    v_mfma_f32_32x32x16_bf16 v[144:159], v[76:79], v[68:71], v[144:159]
    ds_read_b128 v[64:67], v26 offset:0
    ds_read_b128 v[68:71], v26 offset:4096
    ds_read_b64_tr_b16 v[72:73], v16 offset:4096
    ds_read_b64_tr_b16 v[74:75], v16 offset:4608
    ds_read_b64_tr_b16 v[76:77], v16 offset:12288
    ds_read_b64_tr_b16 v[78:79], v16 offset:12800
    s_waitcnt lgkmcnt(6)
    v_mfma_f32_32x32x16_bf16 v[96:111], v[88:91], v[80:83], v[96:111]
    v_mfma_f32_32x32x16_bf16 v[112:127], v[88:91], v[84:87], v[112:127]
    v_mfma_f32_32x32x16_bf16 v[128:143], v[92:95], v[80:83], v[128:143]
    v_mfma_f32_32x32x16_bf16 v[144:159], v[92:95], v[84:87], v[144:159]
    ds_read_b128 v[80:83], v27 offset:0
    ds_read_b128 v[84:87], v27 offset:4096
    ds_read_b64_tr_b16 v[88:89], v16 offset:6144
    ds_read_b64_tr_b16 v[90:91], v16 offset:6656
    ds_read_b64_tr_b16 v[92:93], v16 offset:14336
    ds_read_b64_tr_b16 v[94:95], v16 offset:14848
    s_waitcnt lgkmcnt(6)
    v_mfma_f32_32x32x16_bf16 v[96:111], v[72:75], v[64:67], v[96:111]
    v_mfma_f32_32x32x16_bf16 v[112:127], v[72:75], v[68:71], v[112:127]
    v_mfma_f32_32x32x16_bf16 v[128:143], v[76:79], v[64:67], v[128:143]
    v_mfma_f32_32x32x16_bf16 v[144:159], v[76:79], v[68:71], v[144:159]
    s_waitcnt lgkmcnt(0)
    v_mfma_f32_32x32x16_bf16 v[96:111], v[88:91], v[80:83], v[96:111]
    v_mfma_f32_32x32x16_bf16 v[112:127], v[88:91], v[84:87], v[112:127]
    v_mfma_f32_32x32x16_bf16 v[128:143], v[92:95], v[80:83], v[128:143]
    v_mfma_f32_32x32x16_bf16 v[144:159], v[92:95], v[84:87], v[144:159]
    s_waitcnt vmcnt(0)
    s_barrier
    s_add_u32 m0, s41, 0
    s_mov_b32 s35, 768
    buffer_load_dwordx4 v3, s[16:19], s35 offen lds
    s_add_u32 m0, s41, 1024
    s_mov_b32 s35, 11008
    buffer_load_dwordx4 v3, s[16:19], s35 offen lds
    s_add_u32 m0, s41, 2048
    s_mov_b32 s35, 21248
    buffer_load_dwordx4 v3, s[16:19], s35 offen lds
    s_add_u32 m0, s41, 3072
    s_mov_b32 s35, 31488
    buffer_load_dwordx4 v3, s[16:19], s35 offen lds
    s_add_u32 m0, s42, 0
    s_mov_b32 s35, 1327104
    buffer_load_dwordx4 v7, s[20:23], s35 offen lds
    s_add_u32 m0, s42, 1024
    s_mov_b32 s35, 1354752
    buffer_load_dwordx4 v7, s[20:23], s35 offen lds
    s_add_u32 m0, s42, 8192
    s_mov_b32 s35, 1327104
    buffer_load_dwordx4 v7, s[24:27], s35 offen lds
    s_add_u32 m0, s42, 9216
    s_mov_b32 s35, 1354752
    buffer_load_dwordx4 v7, s[24:27], s35 offen lds
    ds_read_b128 v[64:67], v24 offset:32768
    ds_read_b128 v[68:71], v24 offset:36864
    ds_read_b64_tr_b16 v[72:73], v16 offset:32768
    ds_read_b64_tr_b16 v[74:75], v16 offset:33280
    ds_read_b64_tr_b16 v[76:77], v16 offset:40960
    ds_read_b64_tr_b16 v[78:79], v16 offset:41472
    ds_read_b128 v[80:83], v25 offset:32768
    ds_read_b128 v[84:87], v25 offset:36864
    ds_read_b64_tr_b16 v[88:89], v16 offset:34816
    ds_read_b64_tr_b16 v[90:91], v16 offset:35328
    ds_read_b64_tr_b16 v[92:93], v16 offset:43008
    ds_read_b64_tr_b16 v[94:95], v16 offset:43520
    s_waitcnt lgkmcnt(6)
    v_mfma_f32_32x32x16_bf16 v[96:111], v[72:75], v[64:67], v[96:111]
    v_mfma_f32_32x32x16_bf16 v[112:127], v[72:75], v[68:71], v[112:127]
    v_mfma_f32_32x32x16_bf16 v[128:143], v[76:79], v[64:67], v[128:143]
    v_mfma_f32_32x32x16_bf16 v[144:159], v[76:79], v[68:71], v[144:159]
    ds_read_b128 v[64:67], v26 offset:32768
    ds_read_b128 v[68:71], v26 offset:36864
    ds_read_b64_tr_b16 v[72:73], v16 offset:36864
    ds_read_b64_tr_b16 v[74:75], v16 offset:37376
    ds_read_b64_tr_b16 v[76:77], v16 offset:45056
    ds_read_b64_tr_b16 v[78:79], v16 offset:45568
    s_waitcnt lgkmcnt(6)
    v_mfma_f32_32x32x16_bf16 v[96:111], v[88:91], v[80:83], v[96:111]
    v_mfma_f32_32x32x16_bf16 v[112:127], v[88:91], v[84:87], v[112:127]
    v_mfma_f32_32x32x16_bf16 v[128:143], v[92:95], v[80:83], v[128:143]
    v_mfma_f32_32x32x16_bf16 v[144:159], v[92:95], v[84:87], v[144:159]
    ds_read_b128 v[80:83], v27 offset:32768
    ds_read_b128 v[84:87], v27 offset:36864
    ds_read_b64_tr_b16 v[88:89], v16 offset:38912
    ds_read_b64_tr_b16 v[90:91], v16 offset:39424
    ds_read_b64_tr_b16 v[92:93], v16 offset:47104
    ds_read_b64_tr_b16 v[94:95], v16 offset:47616
    s_waitcnt lgkmcnt(6)
    v_mfma_f32_32x32x16_bf16 v[96:111], v[72:75], v[64:67], v[96:111]
    v_mfma_f32_32x32x16_bf16 v[112:127], v[72:75], v[68:71], v[112:127]
    v_mfma_f32_32x32x16_bf16 v[128:143], v[76:79], v[64:67], v[128:143]
    v_mfma_f32_32x32x16_bf16 v[144:159], v[76:79], v[68:71], v[144:159]
    s_waitcnt lgkmcnt(0)
    v_mfma_f32_32x32x16_bf16 v[96:111], v[88:91], v[80:83], v[96:111]
    v_mfma_f32_32x32x16_bf16 v[112:127], v[88:91], v[84:87], v[112:127]
    v_mfma_f32_32x32x16_bf16 v[128:143], v[92:95], v[80:83], v[128:143]
    v_mfma_f32_32x32x16_bf16 v[144:159], v[92:95], v[84:87], v[144:159]
    s_waitcnt vmcnt(0)
    s_barrier
    s_add_u32 m0, s41, 32768
    s_mov_b32 s35, 896
    buffer_load_dwordx4 v3, s[16:19], s35 offen lds
    s_add_u32 m0, s41, 33792
    s_mov_b32 s35, 11136
    buffer_load_dwordx4 v3, s[16:19], s35 offen lds
    s_add_u32 m0, s41, 34816
    s_mov_b32 s35, 21376
    buffer_load_dwordx4 v3, s[16:19], s35 offen lds
    s_add_u32 m0, s41, 35840
    s_mov_b32 s35, 31616
    buffer_load_dwordx4 v3, s[16:19], s35 offen lds
    s_add_u32 m0, s42, 32768
    s_mov_b32 s35, 1548288
    buffer_load_dwordx4 v7, s[20:23], s35 offen lds
    s_add_u32 m0, s42, 33792
    s_mov_b32 s35, 1575936
    buffer_load_dwordx4 v7, s[20:23], s35 offen lds
    s_add_u32 m0, s42, 40960
    s_mov_b32 s35, 1548288
    buffer_load_dwordx4 v7, s[24:27], s35 offen lds
    s_add_u32 m0, s42, 41984
    s_mov_b32 s35, 1575936
    buffer_load_dwordx4 v7, s[24:27], s35 offen lds
    ds_read_b128 v[64:67], v24 offset:0
    ds_read_b128 v[68:71], v24 offset:4096
    ds_read_b64_tr_b16 v[72:73], v16 offset:0
    ds_read_b64_tr_b16 v[74:75], v16 offset:512
    ds_read_b64_tr_b16 v[76:77], v16 offset:8192
    ds_read_b64_tr_b16 v[78:79], v16 offset:8704
    ds_read_b128 v[80:83], v25 offset:0
    ds_read_b128 v[84:87], v25 offset:4096
    ds_read_b64_tr_b16 v[88:89], v16 offset:2048
    ds_read_b64_tr_b16 v[90:91], v16 offset:2560
    ds_read_b64_tr_b16 v[92:93], v16 offset:10240
    ds_read_b64_tr_b16 v[94:95], v16 offset:10752
    s_waitcnt lgkmcnt(6)
    v_mfma_f32_32x32x16_bf16 v[96:111], v[72:75], v[64:67], v[96:111]
    v_mfma_f32_32x32x16_bf16 v[112:127], v[72:75], v[68:71], v[112:127]
    v_mfma_f32_32x32x16_bf16 v[128:143], v[76:79], v[64:67], v[128:143]
    v_mfma_f32_32x32x16_bf16 v[144:159], v[76:79], v[68:71], v[144:159]
    ds_read_b128 v[64:67], v26 offset:0
    ds_read_b128 v[68:71], v26 offset:4096
    ds_read_b64_tr_b16 v[72:73], v16 offset:4096
    ds_read_b64_tr_b16 v[74:75], v16 offset:4608
    ds_read_b64_tr_b16 v[76:77], v16 offset:12288
    ds_read_b64_tr_b16 v[78:79], v16 offset:12800
    s_waitcnt lgkmcnt(6)
    v_mfma_f32_32x32x16_bf16 v[96:111], v[88:91], v[80:83], v[96:111]
    v_mfma_f32_32x32x16_bf16 v[112:127], v[88:91], v[84:87], v[112:127]
    v_mfma_f32_32x32x16_bf16 v[128:143], v[92:95], v[80:83], v[128:143]
    v_mfma_f32_32x32x16_bf16 v[144:159], v[92:95], v[84:87], v[144:159]
    ds_read_b128 v[80:83], v27 offset:0
    ds_read_b128 v[84:87], v27 offset:4096
    ds_read_b64_tr_b16 v[88:89], v16 offset:6144
    ds_read_b64_tr_b16 v[90:91], v16 offset:6656
    ds_read_b64_tr_b16 v[92:93], v16 offset:14336
    ds_read_b64_tr_b16 v[94:95], v16 offset:14848
    s_waitcnt lgkmcnt(6)
    v_mfma_f32_32x32x16_bf16 v[96:111], v[72:75], v[64:67], v[96:111]
    v_mfma_f32_32x32x16_bf16 v[112:127], v[72:75], v[68:71], v[112:127]
    v_mfma_f32_32x32x16_bf16 v[128:143], v[76:79], v[64:67], v[128:143]
    v_mfma_f32_32x32x16_bf16 v[144:159], v[76:79], v[68:71], v[144:159]
    s_waitcnt lgkmcnt(0)
    v_mfma_f32_32x32x16_bf16 v[96:111], v[88:91], v[80:83], v[96:111]
    v_mfma_f32_32x32x16_bf16 v[112:127], v[88:91], v[84:87], v[112:127]
    v_mfma_f32_32x32x16_bf16 v[128:143], v[92:95], v[80:83], v[128:143]
    v_mfma_f32_32x32x16_bf16 v[144:159], v[92:95], v[84:87], v[144:159]
    s_waitcnt vmcnt(0)
    s_barrier
    s_add_u32 m0, s41, 0
    s_mov_b32 s35, 1024
    buffer_load_dwordx4 v3, s[16:19], s35 offen lds
    s_add_u32 m0, s41, 1024
    s_mov_b32 s35, 11264
    buffer_load_dwordx4 v3, s[16:19], s35 offen lds
    s_add_u32 m0, s41, 2048
    s_mov_b32 s35, 21504
    buffer_load_dwordx4 v3, s[16:19], s35 offen lds
    s_add_u32 m0, s41, 3072
    s_mov_b32 s35, 31744
    buffer_load_dwordx4 v3, s[16:19], s35 offen lds
    s_add_u32 m0, s42, 0
    s_mov_b32 s35, 1769472
    buffer_load_dwordx4 v7, s[20:23], s35 offen lds
    s_add_u32 m0, s42, 1024
    s_mov_b32 s35, 1797120
    buffer_load_dwordx4 v7, s[20:23], s35 offen lds
    s_add_u32 m0, s42, 8192
    s_mov_b32 s35, 1769472
    buffer_load_dwordx4 v7, s[24:27], s35 offen lds
    s_add_u32 m0, s42, 9216
    s_mov_b32 s35, 1797120
    buffer_load_dwordx4 v7, s[24:27], s35 offen lds
    ds_read_b128 v[64:67], v24 offset:32768
    ds_read_b128 v[68:71], v24 offset:36864
    ds_read_b64_tr_b16 v[72:73], v16 offset:32768
    ds_read_b64_tr_b16 v[74:75], v16 offset:33280
    ds_read_b64_tr_b16 v[76:77], v16 offset:40960
    ds_read_b64_tr_b16 v[78:79], v16 offset:41472
    ds_read_b128 v[80:83], v25 offset:32768
    ds_read_b128 v[84:87], v25 offset:36864
    ds_read_b64_tr_b16 v[88:89], v16 offset:34816
    ds_read_b64_tr_b16 v[90:91], v16 offset:35328
    ds_read_b64_tr_b16 v[92:93], v16 offset:43008
    ds_read_b64_tr_b16 v[94:95], v16 offset:43520
    s_waitcnt lgkmcnt(6)
    v_mfma_f32_32x32x16_bf16 v[96:111], v[72:75], v[64:67], v[96:111]
    v_mfma_f32_32x32x16_bf16 v[112:127], v[72:75], v[68:71], v[112:127]
    v_mfma_f32_32x32x16_bf16 v[128:143], v[76:79], v[64:67], v[128:143]
    v_mfma_f32_32x32x16_bf16 v[144:159], v[76:79], v[68:71], v[144:159]
    ds_read_b128 v[64:67], v26 offset:32768
    ds_read_b128 v[68:71], v26 offset:36864
    ds_read_b64_tr_b16 v[72:73], v16 offset:36864
    ds_read_b64_tr_b16 v[74:75], v16 offset:37376
    ds_read_b64_tr_b16 v[76:77], v16 offset:45056
    ds_read_b64_tr_b16 v[78:79], v16 offset:45568
    s_waitcnt lgkmcnt(6)
    v_mfma_f32_32x32x16_bf16 v[96:111], v[88:91], v[80:83], v[96:111]
    v_mfma_f32_32x32x16_bf16 v[112:127], v[88:91], v[84:87], v[112:127]
    v_mfma_f32_32x32x16_bf16 v[128:143], v[92:95], v[80:83], v[128:143]
    v_mfma_f32_32x32x16_bf16 v[144:159], v[92:95], v[84:87], v[144:159]
    ds_read_b128 v[80:83], v27 offset:32768
    ds_read_b128 v[84:87], v27 offset:36864
    ds_read_b64_tr_b16 v[88:89], v16 offset:38912
    ds_read_b64_tr_b16 v[90:91], v16 offset:39424
    ds_read_b64_tr_b16 v[92:93], v16 offset:47104
    ds_read_b64_tr_b16 v[94:95], v16 offset:47616
    s_waitcnt lgkmcnt(6)
    v_mfma_f32_32x32x16_bf16 v[96:111], v[72:75], v[64:67], v[96:111]
    v_mfma_f32_32x32x16_bf16 v[112:127], v[72:75], v[68:71], v[112:127]
    v_mfma_f32_32x32x16_bf16 v[128:143], v[76:79], v[64:67], v[128:143]
    v_mfma_f32_32x32x16_bf16 v[144:159], v[76:79], v[68:71], v[144:159]
    s_waitcnt lgkmcnt(0)
    v_mfma_f32_32x32x16_bf16 v[96:111], v[88:91], v[80:83], v[96:111]
    v_mfma_f32_32x32x16_bf16 v[112:127], v[88:91], v[84:87], v[112:127]
    v_mfma_f32_32x32x16_bf16 v[128:143], v[92:95], v[80:83], v[128:143]
    v_mfma_f32_32x32x16_bf16 v[144:159], v[92:95], v[84:87], v[144:159]
    s_waitcnt vmcnt(0)
    s_barrier
    s_add_u32 m0, s41, 32768
    s_mov_b32 s35, 1152
    buffer_load_dwordx4 v3, s[16:19], s35 offen lds
    s_add_u32 m0, s41, 33792
    s_mov_b32 s35, 11392
    buffer_load_dwordx4 v3, s[16:19], s35 offen lds
    s_add_u32 m0, s41, 34816
    s_mov_b32 s35, 21632
    buffer_load_dwordx4 v3, s[16:19], s35 offen lds
    s_add_u32 m0, s41, 35840
    s_mov_b32 s35, 31872
    buffer_load_dwordx4 v3, s[16:19], s35 offen lds
    s_add_u32 m0, s42, 32768
    s_mov_b32 s35, 1990656
    buffer_load_dwordx4 v7, s[20:23], s35 offen lds
    s_add_u32 m0, s42, 33792
    s_mov_b32 s35, 2018304
    buffer_load_dwordx4 v7, s[20:23], s35 offen lds
    s_add_u32 m0, s42, 40960
    s_mov_b32 s35, 1990656
    buffer_load_dwordx4 v7, s[24:27], s35 offen lds
    s_add_u32 m0, s42, 41984
    s_mov_b32 s35, 2018304
    buffer_load_dwordx4 v7, s[24:27], s35 offen lds
    ds_read_b128 v[64:67], v24 offset:0
    ds_read_b128 v[68:71], v24 offset:4096
    ds_read_b64_tr_b16 v[72:73], v16 offset:0
    ds_read_b64_tr_b16 v[74:75], v16 offset:512
    ds_read_b64_tr_b16 v[76:77], v16 offset:8192
    ds_read_b64_tr_b16 v[78:79], v16 offset:8704
    ds_read_b128 v[80:83], v25 offset:0
    ds_read_b128 v[84:87], v25 offset:4096
    ds_read_b64_tr_b16 v[88:89], v16 offset:2048
    ds_read_b64_tr_b16 v[90:91], v16 offset:2560
    ds_read_b64_tr_b16 v[92:93], v16 offset:10240
    ds_read_b64_tr_b16 v[94:95], v16 offset:10752
    s_waitcnt lgkmcnt(6)
    v_mfma_f32_32x32x16_bf16 v[96:111], v[72:75], v[64:67], v[96:111]
    v_mfma_f32_32x32x16_bf16 v[112:127], v[72:75], v[68:71], v[112:127]
    v_mfma_f32_32x32x16_bf16 v[128:143], v[76:79], v[64:67], v[128:143]
    v_mfma_f32_32x32x16_bf16 v[144:159], v[76:79], v[68:71], v[144:159]
    ds_read_b128 v[64:67], v26 offset:0
    ds_read_b128 v[68:71], v26 offset:4096
    ds_read_b64_tr_b16 v[72:73], v16 offset:4096
    ds_read_b64_tr_b16 v[74:75], v16 offset:4608
    ds_read_b64_tr_b16 v[76:77], v16 offset:12288
    ds_read_b64_tr_b16 v[78:79], v16 offset:12800
    s_waitcnt lgkmcnt(6)
    v_mfma_f32_32x32x16_bf16 v[96:111], v[88:91], v[80:83], v[96:111]
    v_mfma_f32_32x32x16_bf16 v[112:127], v[88:91], v[84:87], v[112:127]
    v_mfma_f32_32x32x16_bf16 v[128:143], v[92:95], v[80:83], v[128:143]
    v_mfma_f32_32x32x16_bf16 v[144:159], v[92:95], v[84:87], v[144:159]
    ds_read_b128 v[80:83], v27 offset:0
    ds_read_b128 v[84:87], v27 offset:4096
    ds_read_b64_tr_b16 v[88:89], v16 offset:6144
    ds_read_b64_tr_b16 v[90:91], v16 offset:6656
    ds_read_b64_tr_b16 v[92:93], v16 offset:14336
    ds_read_b64_tr_b16 v[94:95], v16 offset:14848
    s_waitcnt lgkmcnt(6)
    v_mfma_f32_32x32x16_bf16 v[96:111], v[72:75], v[64:67], v[96:111]
    v_mfma_f32_32x32x16_bf16 v[112:127], v[72:75], v[68:71], v[112:127]
    v_mfma_f32_32x32x16_bf16 v[128:143], v[76:79], v[64:67], v[128:143]
    v_mfma_f32_32x32x16_bf16 v[144:159], v[76:79], v[68:71], v[144:159]
    s_waitcnt lgkmcnt(0)
    v_mfma_f32_32x32x16_bf16 v[96:111], v[88:91], v[80:83], v[96:111]
    v_mfma_f32_32x32x16_bf16 v[112:127], v[88:91], v[84:87], v[112:127]
    v_mfma_f32_32x32x16_bf16 v[128:143], v[92:95], v[80:83], v[128:143]
    v_mfma_f32_32x32x16_bf16 v[144:159], v[92:95], v[84:87], v[144:159]
    s_waitcnt vmcnt(0)
    s_barrier
    ds_read_b128 v[64:67], v24 offset:32768
    ds_read_b128 v[68:71], v24 offset:36864
    ds_read_b64_tr_b16 v[72:73], v16 offset:32768
    ds_read_b64_tr_b16 v[74:75], v16 offset:33280
    ds_read_b64_tr_b16 v[76:77], v16 offset:40960
    ds_read_b64_tr_b16 v[78:79], v16 offset:41472
    ds_read_b128 v[80:83], v25 offset:32768
    ds_read_b128 v[84:87], v25 offset:36864
    ds_read_b64_tr_b16 v[88:89], v16 offset:34816
    ds_read_b64_tr_b16 v[90:91], v16 offset:35328
    ds_read_b64_tr_b16 v[92:93], v16 offset:43008
    ds_read_b64_tr_b16 v[94:95], v16 offset:43520
    s_waitcnt lgkmcnt(6)
    v_mfma_f32_32x32x16_bf16 v[96:111], v[72:75], v[64:67], v[96:111]
    v_mfma_f32_32x32x16_bf16 v[112:127], v[72:75], v[68:71], v[112:127]
    v_mfma_f32_32x32x16_bf16 v[128:143], v[76:79], v[64:67], v[128:143]
    v_mfma_f32_32x32x16_bf16 v[144:159], v[76:79], v[68:71], v[144:159]
    ds_read_b128 v[64:67], v26 offset:32768
    ds_read_b128 v[68:71], v26 offset:36864
    ds_read_b64_tr_b16 v[72:73], v16 offset:36864
    ds_read_b64_tr_b16 v[74:75], v16 offset:37376
    ds_read_b64_tr_b16 v[76:77], v16 offset:45056
    ds_read_b64_tr_b16 v[78:79], v16 offset:45568
    s_waitcnt lgkmcnt(6)
    v_mfma_f32_32x32x16_bf16 v[96:111], v[88:91], v[80:83], v[96:111]
    v_mfma_f32_32x32x16_bf16 v[112:127], v[88:91], v[84:87], v[112:127]
    v_mfma_f32_32x32x16_bf16 v[128:143], v[92:95], v[80:83], v[128:143]
    v_mfma_f32_32x32x16_bf16 v[144:159], v[92:95], v[84:87], v[144:159]
    ds_read_b128 v[80:83], v27 offset:32768
    ds_read_b128 v[84:87], v27 offset:36864
    ds_read_b64_tr_b16 v[88:89], v16 offset:38912
    ds_read_b64_tr_b16 v[90:91], v16 offset:39424
    ds_read_b64_tr_b16 v[92:93], v16 offset:47104
    ds_read_b64_tr_b16 v[94:95], v16 offset:47616
    s_waitcnt lgkmcnt(6)
    v_mfma_f32_32x32x16_bf16 v[96:111], v[72:75], v[64:67], v[96:111]
    v_mfma_f32_32x32x16_bf16 v[112:127], v[72:75], v[68:71], v[112:127]
    v_mfma_f32_32x32x16_bf16 v[128:143], v[76:79], v[64:67], v[128:143]
    v_mfma_f32_32x32x16_bf16 v[144:159], v[76:79], v[68:71], v[144:159]
    s_waitcnt lgkmcnt(0)
    v_mfma_f32_32x32x16_bf16 v[96:111], v[88:91], v[80:83], v[96:111]
    v_mfma_f32_32x32x16_bf16 v[112:127], v[88:91], v[84:87], v[112:127]
    v_mfma_f32_32x32x16_bf16 v[128:143], v[92:95], v[80:83], v[128:143]
    v_mfma_f32_32x32x16_bf16 v[144:159], v[92:95], v[84:87], v[144:159]
    s_nop 15
    s_nop 3
    s_lshl_b32 s32, s14, 7
    v_lshl_add_u32 v1, v11, 6, v13
    v_add_u32 v1, s32, v1
    s_movk_i32 s33, 3456
    v_mul_lo_u32 v1, v1, s33
    s_lshl_b32 s32, s15, 7
    v_add_u32 v1, s32, v1
    v_lshl_add_u32 v1, v12, 6, v1
    v_lshl_add_u32 v1, v14, 3, v1
    s_mov_b32 s35, 0
    v_cvt_pk_bf16_f32 v20, v96, v97
    v_lshlrev_b32 v96, 16, v20
    v_and_b32 v97, 0xffff0000, v20
    v_cvt_pk_bf16_f32 v20, v128, v129
    v_lshlrev_b32 v128, 16, v20
    v_and_b32 v129, 0xffff0000, v20
    v_mul_f32 v96, 0xbfb8aa3b, v96
    v_exp_f32 v96, v96
    s_nop 0
    v_add_f32 v96, 1.0, v96
    v_rcp_f32 v96, v96
    s_nop 0
    v_mul_f32 v97, 0xbfb8aa3b, v97
    v_exp_f32 v97, v97
    s_nop 0
    v_add_f32 v97, 1.0, v97
    v_rcp_f32 v97, v97
    s_nop 0
    v_cvt_pk_bf16_f32 v20, v96, v97
    v_lshlrev_b32 v96, 16, v20
    v_and_b32 v97, 0xffff0000, v20
    v_mul_f32 v96, v96, v128
    v_mul_f32 v97, v97, v129
    v_cvt_pk_bf16_f32 v24, v96, v97
    v_cvt_pk_bf16_f32 v20, v98, v99
    v_lshlrev_b32 v98, 16, v20
    v_and_b32 v99, 0xffff0000, v20
    v_cvt_pk_bf16_f32 v20, v130, v131
    v_lshlrev_b32 v130, 16, v20
    v_and_b32 v131, 0xffff0000, v20
    v_mul_f32 v98, 0xbfb8aa3b, v98
    v_exp_f32 v98, v98
    s_nop 0
    v_add_f32 v98, 1.0, v98
    v_rcp_f32 v98, v98
    s_nop 0
    v_mul_f32 v99, 0xbfb8aa3b, v99
    v_exp_f32 v99, v99
    s_nop 0
    v_add_f32 v99, 1.0, v99
    v_rcp_f32 v99, v99
    s_nop 0
    v_cvt_pk_bf16_f32 v20, v98, v99
    v_lshlrev_b32 v98, 16, v20
    v_and_b32 v99, 0xffff0000, v20
    v_mul_f32 v98, v98, v130
    v_mul_f32 v99, v99, v131
    v_cvt_pk_bf16_f32 v25, v98, v99
    buffer_store_dwordx2 v[24:25], v1, s[28:31], s35 offen offset:0
    s_nop 1
    v_cvt_pk_bf16_f32 v20, v100, v101
    v_lshlrev_b32 v100, 16, v20
    v_and_b32 v101, 0xffff0000, v20
    v_cvt_pk_bf16_f32 v20, v132, v133
    v_lshlrev_b32 v132, 16, v20
    v_and_b32 v133, 0xffff0000, v20
    v_mul_f32 v100, 0xbfb8aa3b, v100
    v_exp_f32 v100, v100
    s_nop 0
    v_add_f32 v100, 1.0, v100
    v_rcp_f32 v100, v100
    s_nop 0
    v_mul_f32 v101, 0xbfb8aa3b, v101
    v_exp_f32 v101, v101
    s_nop 0
    v_add_f32 v101, 1.0, v101
    v_rcp_f32 v101, v101
    s_nop 0
    v_cvt_pk_bf16_f32 v20, v100, v101
    v_lshlrev_b32 v100, 16, v20
    v_and_b32 v101, 0xffff0000, v20
    v_mul_f32 v100, v100, v132
    v_mul_f32 v101, v101, v133
    v_cvt_pk_bf16_f32 v24, v100, v101
    v_cvt_pk_bf16_f32 v20, v102, v103
    v_lshlrev_b32 v102, 16, v20
    v_and_b32 v103, 0xffff0000, v20
    v_cvt_pk_bf16_f32 v20, v134, v135
    v_lshlrev_b32 v134, 16, v20
    v_and_b32 v135, 0xffff0000, v20
    v_mul_f32 v102, 0xbfb8aa3b, v102
    v_exp_f32 v102, v102
    s_nop 0
    v_add_f32 v102, 1.0, v102
    v_rcp_f32 v102, v102
    s_nop 0
    v_mul_f32 v103, 0xbfb8aa3b, v103
    v_exp_f32 v103, v103
    s_nop 0
    v_add_f32 v103, 1.0, v103
    v_rcp_f32 v103, v103
    s_nop 0
    v_cvt_pk_bf16_f32 v20, v102, v103
    v_lshlrev_b32 v102, 16, v20
    v_and_b32 v103, 0xffff0000, v20
    v_mul_f32 v102, v102, v134
    v_mul_f32 v103, v103, v135
    v_cvt_pk_bf16_f32 v25, v102, v103
    buffer_store_dwordx2 v[24:25], v1, s[28:31], s35 offen offset:16
    s_nop 1
    v_cvt_pk_bf16_f32 v20, v104, v105
    v_lshlrev_b32 v104, 16, v20
    v_and_b32 v105, 0xffff0000, v20
    v_cvt_pk_bf16_f32 v20, v136, v137
    v_lshlrev_b32 v136, 16, v20
    v_and_b32 v137, 0xffff0000, v20
    v_mul_f32 v104, 0xbfb8aa3b, v104
    v_exp_f32 v104, v104
    s_nop 0
    v_add_f32 v104, 1.0, v104
    v_rcp_f32 v104, v104
    s_nop 0
    v_mul_f32 v105, 0xbfb8aa3b, v105
    v_exp_f32 v105, v105
    s_nop 0
    v_add_f32 v105, 1.0, v105
    v_rcp_f32 v105, v105
    s_nop 0
    v_cvt_pk_bf16_f32 v20, v104, v105
    v_lshlrev_b32 v104, 16, v20
    v_and_b32 v105, 0xffff0000, v20
    v_mul_f32 v104, v104, v136
    v_mul_f32 v105, v105, v137
    v_cvt_pk_bf16_f32 v24, v104, v105
    v_cvt_pk_bf16_f32 v20, v106, v107
    v_lshlrev_b32 v106, 16, v20
    v_and_b32 v107, 0xffff0000, v20
    v_cvt_pk_bf16_f32 v20, v138, v139
    v_lshlrev_b32 v138, 16, v20
    v_and_b32 v139, 0xffff0000, v20
    v_mul_f32 v106, 0xbfb8aa3b, v106
    v_exp_f32 v106, v106
    s_nop 0
    v_add_f32 v106, 1.0, v106
    v_rcp_f32 v106, v106
    s_nop 0
    v_mul_f32 v107, 0xbfb8aa3b, v107
    v_exp_f32 v107, v107
    s_nop 0
    v_add_f32 v107, 1.0, v107
    v_rcp_f32 v107, v107
    s_nop 0
    v_cvt_pk_bf16_f32 v20, v106, v107
    v_lshlrev_b32 v106, 16, v20
    v_and_b32 v107, 0xffff0000, v20
    v_mul_f32 v106, v106, v138
    v_mul_f32 v107, v107, v139
    v_cvt_pk_bf16_f32 v25, v106, v107
    buffer_store_dwordx2 v[24:25], v1, s[28:31], s35 offen offset:32
    s_nop 1
    v_cvt_pk_bf16_f32 v20, v108, v109
    v_lshlrev_b32 v108, 16, v20
    v_and_b32 v109, 0xffff0000, v20
    v_cvt_pk_bf16_f32 v20, v140, v141
    v_lshlrev_b32 v140, 16, v20
    v_and_b32 v141, 0xffff0000, v20
    v_mul_f32 v108, 0xbfb8aa3b, v108
    v_exp_f32 v108, v108
    s_nop 0
    v_add_f32 v108, 1.0, v108
    v_rcp_f32 v108, v108
    s_nop 0
    v_mul_f32 v109, 0xbfb8aa3b, v109
    v_exp_f32 v109, v109
    s_nop 0
    v_add_f32 v109, 1.0, v109
    v_rcp_f32 v109, v109
    s_nop 0
    v_cvt_pk_bf16_f32 v20, v108, v109
    v_lshlrev_b32 v108, 16, v20
    v_and_b32 v109, 0xffff0000, v20
    v_mul_f32 v108, v108, v140
    v_mul_f32 v109, v109, v141
    v_cvt_pk_bf16_f32 v24, v108, v109
    v_cvt_pk_bf16_f32 v20, v110, v111
    v_lshlrev_b32 v110, 16, v20
    v_and_b32 v111, 0xffff0000, v20
    v_cvt_pk_bf16_f32 v20, v142, v143
    v_lshlrev_b32 v142, 16, v20
    v_and_b32 v143, 0xffff0000, v20
    v_mul_f32 v110, 0xbfb8aa3b, v110
    v_exp_f32 v110, v110
    s_nop 0
    v_add_f32 v110, 1.0, v110
    v_rcp_f32 v110, v110
    s_nop 0
    v_mul_f32 v111, 0xbfb8aa3b, v111
    v_exp_f32 v111, v111
    s_nop 0
    v_add_f32 v111, 1.0, v111
    v_rcp_f32 v111, v111
    s_nop 0
    v_cvt_pk_bf16_f32 v20, v110, v111
    v_lshlrev_b32 v110, 16, v20
    v_and_b32 v111, 0xffff0000, v20
    v_mul_f32 v110, v110, v142
    v_mul_f32 v111, v111, v143
    v_cvt_pk_bf16_f32 v25, v110, v111
    buffer_store_dwordx2 v[24:25], v1, s[28:31], s35 offen offset:48
    s_nop 1
    s_mov_b32 s35, 110592
    v_cvt_pk_bf16_f32 v20, v112, v113
    v_lshlrev_b32 v112, 16, v20
    v_and_b32 v113, 0xffff0000, v20
    v_cvt_pk_bf16_f32 v20, v144, v145
    v_lshlrev_b32 v144, 16, v20
    v_and_b32 v145, 0xffff0000, v20
    v_mul_f32 v112, 0xbfb8aa3b, v112
    v_exp_f32 v112, v112
    s_nop 0
    v_add_f32 v112, 1.0, v112
    v_rcp_f32 v112, v112
    s_nop 0
    v_mul_f32 v113, 0xbfb8aa3b, v113
    v_exp_f32 v113, v113
    s_nop 0
    v_add_f32 v113, 1.0, v113
    v_rcp_f32 v113, v113
    s_nop 0
    v_cvt_pk_bf16_f32 v20, v112, v113
    v_lshlrev_b32 v112, 16, v20
    v_and_b32 v113, 0xffff0000, v20
    v_mul_f32 v112, v112, v144
    v_mul_f32 v113, v113, v145
    v_cvt_pk_bf16_f32 v24, v112, v113
    v_cvt_pk_bf16_f32 v20, v114, v115
    v_lshlrev_b32 v114, 16, v20
    v_and_b32 v115, 0xffff0000, v20
    v_cvt_pk_bf16_f32 v20, v146, v147
    v_lshlrev_b32 v146, 16, v20
    v_and_b32 v147, 0xffff0000, v20
    v_mul_f32 v114, 0xbfb8aa3b, v114
    v_exp_f32 v114, v114
    s_nop 0
    v_add_f32 v114, 1.0, v114
    v_rcp_f32 v114, v114
    s_nop 0
    v_mul_f32 v115, 0xbfb8aa3b, v115
    v_exp_f32 v115, v115
    s_nop 0
    v_add_f32 v115, 1.0, v115
    v_rcp_f32 v115, v115
    s_nop 0
    v_cvt_pk_bf16_f32 v20, v114, v115
    v_lshlrev_b32 v114, 16, v20
    v_and_b32 v115, 0xffff0000, v20
    v_mul_f32 v114, v114, v146
    v_mul_f32 v115, v115, v147
    v_cvt_pk_bf16_f32 v25, v114, v115
    buffer_store_dwordx2 v[24:25], v1, s[28:31], s35 offen offset:0
    s_nop 1
    v_cvt_pk_bf16_f32 v20, v116, v117
    v_lshlrev_b32 v116, 16, v20
    v_and_b32 v117, 0xffff0000, v20
    v_cvt_pk_bf16_f32 v20, v148, v149
    v_lshlrev_b32 v148, 16, v20
    v_and_b32 v149, 0xffff0000, v20
    v_mul_f32 v116, 0xbfb8aa3b, v116
    v_exp_f32 v116, v116
    s_nop 0
    v_add_f32 v116, 1.0, v116
    v_rcp_f32 v116, v116
    s_nop 0
    v_mul_f32 v117, 0xbfb8aa3b, v117
    v_exp_f32 v117, v117
    s_nop 0
    v_add_f32 v117, 1.0, v117
    v_rcp_f32 v117, v117
    s_nop 0
    v_cvt_pk_bf16_f32 v20, v116, v117
    v_lshlrev_b32 v116, 16, v20
    v_and_b32 v117, 0xffff0000, v20
    v_mul_f32 v116, v116, v148
    v_mul_f32 v117, v117, v149
    v_cvt_pk_bf16_f32 v24, v116, v117
    v_cvt_pk_bf16_f32 v20, v118, v119
    v_lshlrev_b32 v118, 16, v20
    v_and_b32 v119, 0xffff0000, v20
    v_cvt_pk_bf16_f32 v20, v150, v151
    v_lshlrev_b32 v150, 16, v20
    v_and_b32 v151, 0xffff0000, v20
    v_mul_f32 v118, 0xbfb8aa3b, v118
    v_exp_f32 v118, v118
    s_nop 0
    v_add_f32 v118, 1.0, v118
    v_rcp_f32 v118, v118
    s_nop 0
    v_mul_f32 v119, 0xbfb8aa3b, v119
    v_exp_f32 v119, v119
    s_nop 0
    v_add_f32 v119, 1.0, v119
    v_rcp_f32 v119, v119
    s_nop 0
    v_cvt_pk_bf16_f32 v20, v118, v119
    v_lshlrev_b32 v118, 16, v20
    v_and_b32 v119, 0xffff0000, v20
    v_mul_f32 v118, v118, v150
    v_mul_f32 v119, v119, v151
    v_cvt_pk_bf16_f32 v25, v118, v119
    buffer_store_dwordx2 v[24:25], v1, s[28:31], s35 offen offset:16
    s_nop 1
    v_cvt_pk_bf16_f32 v20, v120, v121
    v_lshlrev_b32 v120, 16, v20
    v_and_b32 v121, 0xffff0000, v20
    v_cvt_pk_bf16_f32 v20, v152, v153
    v_lshlrev_b32 v152, 16, v20
    v_and_b32 v153, 0xffff0000, v20
    v_mul_f32 v120, 0xbfb8aa3b, v120
    v_exp_f32 v120, v120
    s_nop 0
    v_add_f32 v120, 1.0, v120
    v_rcp_f32 v120, v120
    s_nop 0
    v_mul_f32 v121, 0xbfb8aa3b, v121
    v_exp_f32 v121, v121
    s_nop 0
    v_add_f32 v121, 1.0, v121
    v_rcp_f32 v121, v121
    s_nop 0
    v_cvt_pk_bf16_f32 v20, v120, v121
    v_lshlrev_b32 v120, 16, v20
    v_and_b32 v121, 0xffff0000, v20
    v_mul_f32 v120, v120, v152
    v_mul_f32 v121, v121, v153
    v_cvt_pk_bf16_f32 v24, v120, v121
    v_cvt_pk_bf16_f32 v20, v122, v123
    v_lshlrev_b32 v122, 16, v20
    v_and_b32 v123, 0xffff0000, v20
    v_cvt_pk_bf16_f32 v20, v154, v155
    v_lshlrev_b32 v154, 16, v20
    v_and_b32 v155, 0xffff0000, v20
    v_mul_f32 v122, 0xbfb8aa3b, v122
    v_exp_f32 v122, v122
    s_nop 0
    v_add_f32 v122, 1.0, v122
    v_rcp_f32 v122, v122
    s_nop 0
    v_mul_f32 v123, 0xbfb8aa3b, v123
    v_exp_f32 v123, v123
    s_nop 0
    v_add_f32 v123, 1.0, v123
    v_rcp_f32 v123, v123
    s_nop 0
    v_cvt_pk_bf16_f32 v20, v122, v123
    v_lshlrev_b32 v122, 16, v20
    v_and_b32 v123, 0xffff0000, v20
    v_mul_f32 v122, v122, v154
    v_mul_f32 v123, v123, v155
    v_cvt_pk_bf16_f32 v25, v122, v123
    buffer_store_dwordx2 v[24:25], v1, s[28:31], s35 offen offset:32
    s_nop 1
    v_cvt_pk_bf16_f32 v20, v124, v125
    v_lshlrev_b32 v124, 16, v20
    v_and_b32 v125, 0xffff0000, v20
    v_cvt_pk_bf16_f32 v20, v156, v157
    v_lshlrev_b32 v156, 16, v20
    v_and_b32 v157, 0xffff0000, v20
    v_mul_f32 v124, 0xbfb8aa3b, v124
    v_exp_f32 v124, v124
    s_nop 0
    v_add_f32 v124, 1.0, v124
    v_rcp_f32 v124, v124
    s_nop 0
    v_mul_f32 v125, 0xbfb8aa3b, v125
    v_exp_f32 v125, v125
    s_nop 0
    v_add_f32 v125, 1.0, v125
    v_rcp_f32 v125, v125
    s_nop 0
    v_cvt_pk_bf16_f32 v20, v124, v125
    v_lshlrev_b32 v124, 16, v20
    v_and_b32 v125, 0xffff0000, v20
    v_mul_f32 v124, v124, v156
    v_mul_f32 v125, v125, v157
    v_cvt_pk_bf16_f32 v24, v124, v125
    v_cvt_pk_bf16_f32 v20, v126, v127
    v_lshlrev_b32 v126, 16, v20
    v_and_b32 v127, 0xffff0000, v20
    v_cvt_pk_bf16_f32 v20, v158, v159
    v_lshlrev_b32 v158, 16, v20
    v_and_b32 v159, 0xffff0000, v20
    v_mul_f32 v126, 0xbfb8aa3b, v126
    v_exp_f32 v126, v126
    s_nop 0
    v_add_f32 v126, 1.0, v126
    v_rcp_f32 v126, v126
    s_nop 0
    v_mul_f32 v127, 0xbfb8aa3b, v127
    v_exp_f32 v127, v127
    s_nop 0
    v_add_f32 v127, 1.0, v127
    v_rcp_f32 v127, v127
    s_nop 0
    v_cvt_pk_bf16_f32 v20, v126, v127
    v_lshlrev_b32 v126, 16, v20
    v_and_b32 v127, 0xffff0000, v20
    v_mul_f32 v126, v126, v158
    v_mul_f32 v127, v127, v159
    v_cvt_pk_bf16_f32 v25, v126, v127
    buffer_store_dwordx2 v[24:25], v1, s[28:31], s35 offen offset:48
    s_nop 1
GEMM_END_g1_kernel:
    s_endpgm
.globl g2a_kernel
.p2align 8
.type g2a_kernel,@function
g2a_kernel:
    s_cmp_ge_u32 s2, 160
    s_cbranch_scc1 GEMM_END_g2a_kernel
    s_load_dwordx4 s[4:7], s[0:1], 56
    s_load_dwordx4 s[8:11], s[0:1], 72
    s_load_dwordx2 s[12:13], s[0:1], 96
    s_and_b32 s14, s2, 15
    s_lshr_b32 s15, s2, 4
    s_waitcnt lgkmcnt(0)
    s_add_u32 s16, s12, 10485760
    s_addc_u32 s17, s13, 0
    s_mov_b32 s18, 7077888
    s_mov_b32 s19, 0x00020000
    s_mov_b32 s20, s8
    s_mov_b32 s21, s9
    s_mov_b32 s22, 2211840
    s_mov_b32 s23, 0x00020000
    s_add_u32 s24, s12, 2621440
    s_addc_u32 s25, s13, 0
    s_mov_b32 s26, 2621440
    s_mov_b32 s27, 0x00020000
    s_add_u32 s28, s12, 7864320
    s_addc_u32 s29, s13, 0
    s_mov_b32 s30, 2621440
    s_mov_b32 s31, 0x00020000
    v_lshrrev_b32 v18, 6, v0
    s_nop 0
    v_readfirstlane_b32 s40, v18
    v_and_b32 v19, 63, v0
    v_lshrrev_b32 v1, 3, v19
    v_and_b32 v2, 7, v0
    v_xor_b32 v4, v2, v1
    v_lshlrev_b32 v4, 4, v4
    s_lshl_b32 s32, s14, 7
    v_lshl_add_u32 v3, v18, 5, v1
    v_add_u32 v3, s32, v3
    s_movk_i32 s33, 3456
    v_mul_lo_u32 v3, v3, s33
    v_add_u32 v3, v3, v4
    v_bfe_u32 v4, v1, 1, 1
    v_lshlrev_b32 v4, 2, v4
    v_xor_b32 v4, v2, v4
    v_lshlrev_b32 v4, 4, v4
    v_lshl_add_u32 v7, v18, 4, v1
    s_movk_i32 s33, 1280
    v_mul_lo_u32 v7, v7, s33
    v_add_u32 v7, v7, v4
    s_lshl_b32 s32, s15, 7
    v_add_u32 v7, s32, v7
    s_lshl_b32 s41, s40, 12
    s_lshl_b32 s42, s40, 11
    s_add_u32 s42, s42, 16384
    v_lshrrev_b32 v11, 6, v0
    v_and_b32 v12, 1, v11
    v_lshrrev_b32 v11, 1, v11
    v_and_b32 v13, 31, v0
    v_bfe_u32 v14, v0, 5, 1
    v_lshl_add_u32 v15, v11, 6, v13
    v_and_b32 v17, 7, v15
    v_lshlrev_b32 v15, 7, v15
    v_add_u32 v18, 0, v14
    v_xor_b32 v18, v18, v17
    v_lshl_add_u32 v24, v18, 4, v15
    v_add_u32 v18, 2, v14
    v_xor_b32 v18, v18, v17
    v_lshl_add_u32 v25, v18, 4, v15
    v_add_u32 v18, 4, v14
    v_xor_b32 v18, v18, v17
    v_lshl_add_u32 v26, v18, 4, v15
    v_add_u32 v18, 6, v14
    v_xor_b32 v18, v18, v17
    v_lshl_add_u32 v27, v18, 4, v15
    v_bfe_u32 v16, v0, 2, 2
    v_lshl_add_u32 v16, v14, 3, v16
    v_lshlrev_b32 v16, 7, v16
    v_lshlrev_b32 v17, 6, v12
    v_add_u32 v16, v16, v17
    v_bfe_u32 v17, v0, 4, 1
    v_lshl_add_u32 v16, v17, 5, v16
    v_and_b32 v17, 3, v0
    v_lshl_add_u32 v16, v17, 3, v16
    v_add_u32 v16, 16384, v16
    v_bfe_u32 v17, v0, 3, 1
    v_lshlrev_b32 v17, 6, v17
    v_xor_b32 v16, v16, v17
    v_mov_b32 v96, 0
    v_mov_b32 v97, 0
    v_mov_b32 v98, 0
    v_mov_b32 v99, 0
    v_mov_b32 v100, 0
    v_mov_b32 v101, 0
    v_mov_b32 v102, 0
    v_mov_b32 v103, 0
    v_mov_b32 v104, 0
    v_mov_b32 v105, 0
    v_mov_b32 v106, 0
    v_mov_b32 v107, 0
    v_mov_b32 v108, 0
    v_mov_b32 v109, 0
    v_mov_b32 v110, 0
    v_mov_b32 v111, 0
    v_mov_b32 v112, 0
    v_mov_b32 v113, 0
    v_mov_b32 v114, 0
    v_mov_b32 v115, 0
    v_mov_b32 v116, 0
    v_mov_b32 v117, 0
    v_mov_b32 v118, 0
    v_mov_b32 v119, 0
    v_mov_b32 v120, 0
    v_mov_b32 v121, 0
    v_mov_b32 v122, 0
    v_mov_b32 v123, 0
    v_mov_b32 v124, 0
    v_mov_b32 v125, 0
    v_mov_b32 v126, 0
    v_mov_b32 v127, 0
    s_mov_b32 s34, 0
    s_add_u32 m0, s41, 0
    s_mov_b32 s35, 0
    buffer_load_dwordx4 v3, s[16:19], s35 offen lds
    s_add_u32 m0, s41, 1024
    s_mov_b32 s35, 27648
    buffer_load_dwordx4 v3, s[16:19], s35 offen lds
    s_add_u32 m0, s41, 2048
    s_mov_b32 s35, 55296
    buffer_load_dwordx4 v3, s[16:19], s35 offen lds
    s_add_u32 m0, s41, 3072
    s_mov_b32 s35, 82944
    buffer_load_dwordx4 v3, s[16:19], s35 offen lds
    s_add_u32 m0, s42, 0
    s_mov_b32 s35, 0
    buffer_load_dwordx4 v7, s[20:23], s35 offen lds
    s_add_u32 m0, s42, 1024
    s_mov_b32 s35, 10240
    buffer_load_dwordx4 v7, s[20:23], s35 offen lds
    s_add_u32 m0, s41, 24576
    s_mov_b32 s35, 128
    buffer_load_dwordx4 v3, s[16:19], s35 offen lds
    s_add_u32 m0, s41, 25600
    s_mov_b32 s35, 27776
    buffer_load_dwordx4 v3, s[16:19], s35 offen lds
    s_add_u32 m0, s41, 26624
    s_mov_b32 s35, 55424
    buffer_load_dwordx4 v3, s[16:19], s35 offen lds
    s_add_u32 m0, s41, 27648
    s_mov_b32 s35, 83072
    buffer_load_dwordx4 v3, s[16:19], s35 offen lds
    s_add_u32 m0, s42, 24576
    s_mov_b32 s35, 81920
    buffer_load_dwordx4 v7, s[20:23], s35 offen lds
    s_add_u32 m0, s42, 25600
    s_mov_b32 s35, 92160
    buffer_load_dwordx4 v7, s[20:23], s35 offen lds
    s_waitcnt vmcnt(6)
    s_barrier
    s_add_u32 m0, s41, 49152
    s_mov_b32 s35, 256
    buffer_load_dwordx4 v3, s[16:19], s35 offen lds
    s_add_u32 m0, s41, 50176
    s_mov_b32 s35, 27904
    buffer_load_dwordx4 v3, s[16:19], s35 offen lds
    s_add_u32 m0, s41, 51200
    s_mov_b32 s35, 55552
    buffer_load_dwordx4 v3, s[16:19], s35 offen lds
    s_add_u32 m0, s41, 52224
    s_mov_b32 s35, 83200
    buffer_load_dwordx4 v3, s[16:19], s35 offen lds
    s_add_u32 m0, s42, 49152
    s_mov_b32 s35, 163840
    buffer_load_dwordx4 v7, s[20:23], s35 offen lds
    s_add_u32 m0, s42, 50176
    s_mov_b32 s35, 174080
    buffer_load_dwordx4 v7, s[20:23], s35 offen lds
    ds_read_b128 v[64:67], v24 offset:0
    ds_read_b128 v[68:71], v24 offset:4096
    ds_read_b64_tr_b16 v[72:73], v16 offset:0
    ds_read_b64_tr_b16 v[74:75], v16 offset:512
    ds_read_b128 v[80:83], v25 offset:0
    ds_read_b128 v[84:87], v25 offset:4096
    ds_read_b64_tr_b16 v[88:89], v16 offset:2048
    ds_read_b64_tr_b16 v[90:91], v16 offset:2560
    s_waitcnt lgkmcnt(4)
    v_mfma_f32_32x32x16_bf16 v[96:111], v[72:75], v[64:67], v[96:111]
    v_mfma_f32_32x32x16_bf16 v[112:127], v[72:75], v[68:71], v[112:127]
    ds_read_b128 v[64:67], v26 offset:0
    ds_read_b128 v[68:71], v26 offset:4096
    ds_read_b64_tr_b16 v[72:73], v16 offset:4096
    ds_read_b64_tr_b16 v[74:75], v16 offset:4608
    s_waitcnt lgkmcnt(4)
    v_mfma_f32_32x32x16_bf16 v[96:111], v[88:91], v[80:83], v[96:111]
    v_mfma_f32_32x32x16_bf16 v[112:127], v[88:91], v[84:87], v[112:127]
    ds_read_b128 v[80:83], v27 offset:0
    ds_read_b128 v[84:87], v27 offset:4096
    ds_read_b64_tr_b16 v[88:89], v16 offset:6144
    ds_read_b64_tr_b16 v[90:91], v16 offset:6656
    s_waitcnt lgkmcnt(4)
    v_mfma_f32_32x32x16_bf16 v[96:111], v[72:75], v[64:67], v[96:111]
    v_mfma_f32_32x32x16_bf16 v[112:127], v[72:75], v[68:71], v[112:127]
    s_waitcnt lgkmcnt(0)
    v_mfma_f32_32x32x16_bf16 v[96:111], v[88:91], v[80:83], v[96:111]
    v_mfma_f32_32x32x16_bf16 v[112:127], v[88:91], v[84:87], v[112:127]
    s_waitcnt vmcnt(6)
    s_barrier
    s_add_u32 m0, s41, 0
    s_mov_b32 s35, 384
    buffer_load_dwordx4 v3, s[16:19], s35 offen lds
    s_add_u32 m0, s41, 1024
    s_mov_b32 s35, 28032
    buffer_load_dwordx4 v3, s[16:19], s35 offen lds
    s_add_u32 m0, s41, 2048
    s_mov_b32 s35, 55680
    buffer_load_dwordx4 v3, s[16:19], s35 offen lds
    s_add_u32 m0, s41, 3072
    s_mov_b32 s35, 83328
    buffer_load_dwordx4 v3, s[16:19], s35 offen lds
    s_add_u32 m0, s42, 0
    s_mov_b32 s35, 245760
    buffer_load_dwordx4 v7, s[20:23], s35 offen lds
    s_add_u32 m0, s42, 1024
    s_mov_b32 s35, 256000
    buffer_load_dwordx4 v7, s[20:23], s35 offen lds
    ds_read_b128 v[64:67], v24 offset:24576
    ds_read_b128 v[68:71], v24 offset:28672
    ds_read_b64_tr_b16 v[72:73], v16 offset:24576
    ds_read_b64_tr_b16 v[74:75], v16 offset:25088
    ds_read_b128 v[80:83], v25 offset:24576
    ds_read_b128 v[84:87], v25 offset:28672
    ds_read_b64_tr_b16 v[88:89], v16 offset:26624
    ds_read_b64_tr_b16 v[90:91], v16 offset:27136
    s_waitcnt lgkmcnt(4)
    v_mfma_f32_32x32x16_bf16 v[96:111], v[72:75], v[64:67], v[96:111]
    v_mfma_f32_32x32x16_bf16 v[112:127], v[72:75], v[68:71], v[112:127]
    ds_read_b128 v[64:67], v26 offset:24576
    ds_read_b128 v[68:71], v26 offset:28672
    ds_read_b64_tr_b16 v[72:73], v16 offset:28672
    ds_read_b64_tr_b16 v[74:75], v16 offset:29184
    s_waitcnt lgkmcnt(4)
    v_mfma_f32_32x32x16_bf16 v[96:111], v[88:91], v[80:83], v[96:111]
    v_mfma_f32_32x32x16_bf16 v[112:127], v[88:91], v[84:87], v[112:127]
    ds_read_b128 v[80:83], v27 offset:24576
    ds_read_b128 v[84:87], v27 offset:28672
    ds_read_b64_tr_b16 v[88:89], v16 offset:30720
    ds_read_b64_tr_b16 v[90:91], v16 offset:31232
    s_waitcnt lgkmcnt(4)
    v_mfma_f32_32x32x16_bf16 v[96:111], v[72:75], v[64:67], v[96:111]
    v_mfma_f32_32x32x16_bf16 v[112:127], v[72:75], v[68:71], v[112:127]
    s_waitcnt lgkmcnt(0)
    v_mfma_f32_32x32x16_bf16 v[96:111], v[88:91], v[80:83], v[96:111]
    v_mfma_f32_32x32x16_bf16 v[112:127], v[88:91], v[84:87], v[112:127]
    s_waitcnt vmcnt(6)
    s_barrier
    s_add_u32 m0, s41, 24576
    s_mov_b32 s35, 512
    buffer_load_dwordx4 v3, s[16:19], s35 offen lds
    s_add_u32 m0, s41, 25600
    s_mov_b32 s35, 28160
    buffer_load_dwordx4 v3, s[16:19], s35 offen lds
    s_add_u32 m0, s41, 26624
    s_mov_b32 s35, 55808
    buffer_load_dwordx4 v3, s[16:19], s35 offen lds
    s_add_u32 m0, s41, 27648
    s_mov_b32 s35, 83456
    buffer_load_dwordx4 v3, s[16:19], s35 offen lds
    s_add_u32 m0, s42, 24576
    s_mov_b32 s35, 327680
    buffer_load_dwordx4 v7, s[20:23], s35 offen lds
    s_add_u32 m0, s42, 25600
    s_mov_b32 s35, 337920
    buffer_load_dwordx4 v7, s[20:23], s35 offen lds
    ds_read_b128 v[64:67], v24 offset:49152
    ds_read_b128 v[68:71], v24 offset:53248
    ds_read_b64_tr_b16 v[72:73], v16 offset:49152
    ds_read_b64_tr_b16 v[74:75], v16 offset:49664
    ds_read_b128 v[80:83], v25 offset:49152
    ds_read_b128 v[84:87], v25 offset:53248
    ds_read_b64_tr_b16 v[88:89], v16 offset:51200
    ds_read_b64_tr_b16 v[90:91], v16 offset:51712
    s_waitcnt lgkmcnt(4)
    v_mfma_f32_32x32x16_bf16 v[96:111], v[72:75], v[64:67], v[96:111]
    v_mfma_f32_32x32x16_bf16 v[112:127], v[72:75], v[68:71], v[112:127]
    ds_read_b128 v[64:67], v26 offset:49152
    ds_read_b128 v[68:71], v26 offset:53248
    ds_read_b64_tr_b16 v[72:73], v16 offset:53248
    ds_read_b64_tr_b16 v[74:75], v16 offset:53760
    s_waitcnt lgkmcnt(4)
    v_mfma_f32_32x32x16_bf16 v[96:111], v[88:91], v[80:83], v[96:111]
    v_mfma_f32_32x32x16_bf16 v[112:127], v[88:91], v[84:87], v[112:127]
    ds_read_b128 v[80:83], v27 offset:49152
    ds_read_b128 v[84:87], v27 offset:53248
    ds_read_b64_tr_b16 v[88:89], v16 offset:55296
    ds_read_b64_tr_b16 v[90:91], v16 offset:55808
    s_waitcnt lgkmcnt(4)
    v_mfma_f32_32x32x16_bf16 v[96:111], v[72:75], v[64:67], v[96:111]
    v_mfma_f32_32x32x16_bf16 v[112:127], v[72:75], v[68:71], v[112:127]
    s_waitcnt lgkmcnt(0)
    v_mfma_f32_32x32x16_bf16 v[96:111], v[88:91], v[80:83], v[96:111]
    v_mfma_f32_32x32x16_bf16 v[112:127], v[88:91], v[84:87], v[112:127]
    s_waitcnt vmcnt(6)
    s_barrier
    s_add_u32 m0, s41, 49152
    s_mov_b32 s35, 640
    buffer_load_dwordx4 v3, s[16:19], s35 offen lds
    s_add_u32 m0, s41, 50176
    s_mov_b32 s35, 28288
    buffer_load_dwordx4 v3, s[16:19], s35 offen lds
    s_add_u32 m0, s41, 51200
    s_mov_b32 s35, 55936
    buffer_load_dwordx4 v3, s[16:19], s35 offen lds
    s_add_u32 m0, s41, 52224
    s_mov_b32 s35, 83584
    buffer_load_dwordx4 v3, s[16:19], s35 offen lds
    s_add_u32 m0, s42, 49152
    s_mov_b32 s35, 409600
    buffer_load_dwordx4 v7, s[20:23], s35 offen lds
    s_add_u32 m0, s42, 50176
    s_mov_b32 s35, 419840
    buffer_load_dwordx4 v7, s[20:23], s35 offen lds
    ds_read_b128 v[64:67], v24 offset:0
    ds_read_b128 v[68:71], v24 offset:4096
    ds_read_b64_tr_b16 v[72:73], v16 offset:0
    ds_read_b64_tr_b16 v[74:75], v16 offset:512
    ds_read_b128 v[80:83], v25 offset:0
    ds_read_b128 v[84:87], v25 offset:4096
    ds_read_b64_tr_b16 v[88:89], v16 offset:2048
    ds_read_b64_tr_b16 v[90:91], v16 offset:2560
    s_waitcnt lgkmcnt(4)
    v_mfma_f32_32x32x16_bf16 v[96:111], v[72:75], v[64:67], v[96:111]
    v_mfma_f32_32x32x16_bf16 v[112:127], v[72:75], v[68:71], v[112:127]
    ds_read_b128 v[64:67], v26 offset:0
    ds_read_b128 v[68:71], v26 offset:4096
    ds_read_b64_tr_b16 v[72:73], v16 offset:4096
    ds_read_b64_tr_b16 v[74:75], v16 offset:4608
    s_waitcnt lgkmcnt(4)
    v_mfma_f32_32x32x16_bf16 v[96:111], v[88:91], v[80:83], v[96:111]
    v_mfma_f32_32x32x16_bf16 v[112:127], v[88:91], v[84:87], v[112:127]
    ds_read_b128 v[80:83], v27 offset:0
    ds_read_b128 v[84:87], v27 offset:4096
    ds_read_b64_tr_b16 v[88:89], v16 offset:6144
    ds_read_b64_tr_b16 v[90:91], v16 offset:6656
    s_waitcnt lgkmcnt(4)
    v_mfma_f32_32x32x16_bf16 v[96:111], v[72:75], v[64:67], v[96:111]
    v_mfma_f32_32x32x16_bf16 v[112:127], v[72:75], v[68:71], v[112:127]
    s_waitcnt lgkmcnt(0)
    v_mfma_f32_32x32x16_bf16 v[96:111], v[88:91], v[80:83], v[96:111]
    v_mfma_f32_32x32x16_bf16 v[112:127], v[88:91], v[84:87], v[112:127]
    s_waitcnt vmcnt(6)
    s_barrier
    s_add_u32 m0, s41, 0
    s_mov_b32 s35, 768
    buffer_load_dwordx4 v3, s[16:19], s35 offen lds
    s_add_u32 m0, s41, 1024
    s_mov_b32 s35, 28416
    buffer_load_dwordx4 v3, s[16:19], s35 offen lds
    s_add_u32 m0, s41, 2048
    s_mov_b32 s35, 56064
    buffer_load_dwordx4 v3, s[16:19], s35 offen lds
    s_add_u32 m0, s41, 3072
    s_mov_b32 s35, 83712
    buffer_load_dwordx4 v3, s[16:19], s35 offen lds
    s_add_u32 m0, s42, 0
    s_mov_b32 s35, 491520
    buffer_load_dwordx4 v7, s[20:23], s35 offen lds
    s_add_u32 m0, s42, 1024
    s_mov_b32 s35, 501760
    buffer_load_dwordx4 v7, s[20:23], s35 offen lds
    ds_read_b128 v[64:67], v24 offset:24576
    ds_read_b128 v[68:71], v24 offset:28672
    ds_read_b64_tr_b16 v[72:73], v16 offset:24576
    ds_read_b64_tr_b16 v[74:75], v16 offset:25088
    ds_read_b128 v[80:83], v25 offset:24576
    ds_read_b128 v[84:87], v25 offset:28672
    ds_read_b64_tr_b16 v[88:89], v16 offset:26624
    ds_read_b64_tr_b16 v[90:91], v16 offset:27136
    s_waitcnt lgkmcnt(4)
    v_mfma_f32_32x32x16_bf16 v[96:111], v[72:75], v[64:67], v[96:111]
    v_mfma_f32_32x32x16_bf16 v[112:127], v[72:75], v[68:71], v[112:127]
    ds_read_b128 v[64:67], v26 offset:24576
    ds_read_b128 v[68:71], v26 offset:28672
    ds_read_b64_tr_b16 v[72:73], v16 offset:28672
    ds_read_b64_tr_b16 v[74:75], v16 offset:29184
    s_waitcnt lgkmcnt(4)
    v_mfma_f32_32x32x16_bf16 v[96:111], v[88:91], v[80:83], v[96:111]
    v_mfma_f32_32x32x16_bf16 v[112:127], v[88:91], v[84:87], v[112:127]
    ds_read_b128 v[80:83], v27 offset:24576
    ds_read_b128 v[84:87], v27 offset:28672
    ds_read_b64_tr_b16 v[88:89], v16 offset:30720
    ds_read_b64_tr_b16 v[90:91], v16 offset:31232
    s_waitcnt lgkmcnt(4)
    v_mfma_f32_32x32x16_bf16 v[96:111], v[72:75], v[64:67], v[96:111]
    v_mfma_f32_32x32x16_bf16 v[112:127], v[72:75], v[68:71], v[112:127]
    s_waitcnt lgkmcnt(0)
    v_mfma_f32_32x32x16_bf16 v[96:111], v[88:91], v[80:83], v[96:111]
    v_mfma_f32_32x32x16_bf16 v[112:127], v[88:91], v[84:87], v[112:127]
    s_waitcnt vmcnt(6)
    s_barrier
    s_add_u32 m0, s41, 24576
    s_mov_b32 s35, 896
    buffer_load_dwordx4 v3, s[16:19], s35 offen lds
    s_add_u32 m0, s41, 25600
    s_mov_b32 s35, 28544
    buffer_load_dwordx4 v3, s[16:19], s35 offen lds
    s_add_u32 m0, s41, 26624
    s_mov_b32 s35, 56192
    buffer_load_dwordx4 v3, s[16:19], s35 offen lds
    s_add_u32 m0, s41, 27648
    s_mov_b32 s35, 83840
    buffer_load_dwordx4 v3, s[16:19], s35 offen lds
    s_add_u32 m0, s42, 24576
    s_mov_b32 s35, 573440
    buffer_load_dwordx4 v7, s[20:23], s35 offen lds
    s_add_u32 m0, s42, 25600
    s_mov_b32 s35, 583680
    buffer_load_dwordx4 v7, s[20:23], s35 offen lds
    ds_read_b128 v[64:67], v24 offset:49152
    ds_read_b128 v[68:71], v24 offset:53248
    ds_read_b64_tr_b16 v[72:73], v16 offset:49152
    ds_read_b64_tr_b16 v[74:75], v16 offset:49664
    ds_read_b128 v[80:83], v25 offset:49152
    ds_read_b128 v[84:87], v25 offset:53248
    ds_read_b64_tr_b16 v[88:89], v16 offset:51200
    ds_read_b64_tr_b16 v[90:91], v16 offset:51712
    s_waitcnt lgkmcnt(4)
    v_mfma_f32_32x32x16_bf16 v[96:111], v[72:75], v[64:67], v[96:111]
    v_mfma_f32_32x32x16_bf16 v[112:127], v[72:75], v[68:71], v[112:127]
    ds_read_b128 v[64:67], v26 offset:49152
    ds_read_b128 v[68:71], v26 offset:53248
    ds_read_b64_tr_b16 v[72:73], v16 offset:53248
    ds_read_b64_tr_b16 v[74:75], v16 offset:53760
    s_waitcnt lgkmcnt(4)
    v_mfma_f32_32x32x16_bf16 v[96:111], v[88:91], v[80:83], v[96:111]
    v_mfma_f32_32x32x16_bf16 v[112:127], v[88:91], v[84:87], v[112:127]
    ds_read_b128 v[80:83], v27 offset:49152
    ds_read_b128 v[84:87], v27 offset:53248
    ds_read_b64_tr_b16 v[88:89], v16 offset:55296
    ds_read_b64_tr_b16 v[90:91], v16 offset:55808
    s_waitcnt lgkmcnt(4)
    v_mfma_f32_32x32x16_bf16 v[96:111], v[72:75], v[64:67], v[96:111]
    v_mfma_f32_32x32x16_bf16 v[112:127], v[72:75], v[68:71], v[112:127]
    s_waitcnt lgkmcnt(0)
    v_mfma_f32_32x32x16_bf16 v[96:111], v[88:91], v[80:83], v[96:111]
    v_mfma_f32_32x32x16_bf16 v[112:127], v[88:91], v[84:87], v[112:127]
    s_waitcnt vmcnt(6)
    s_barrier
    s_add_u32 m0, s41, 49152
    s_mov_b32 s35, 1024
    buffer_load_dwordx4 v3, s[16:19], s35 offen lds
    s_add_u32 m0, s41, 50176
    s_mov_b32 s35, 28672
    buffer_load_dwordx4 v3, s[16:19], s35 offen lds
    s_add_u32 m0, s41, 51200
    s_mov_b32 s35, 56320
    buffer_load_dwordx4 v3, s[16:19], s35 offen lds
    s_add_u32 m0, s41, 52224
    s_mov_b32 s35, 83968
    buffer_load_dwordx4 v3, s[16:19], s35 offen lds
    s_add_u32 m0, s42, 49152
    s_mov_b32 s35, 655360
    buffer_load_dwordx4 v7, s[20:23], s35 offen lds
    s_add_u32 m0, s42, 50176
    s_mov_b32 s35, 665600
    buffer_load_dwordx4 v7, s[20:23], s35 offen lds
    ds_read_b128 v[64:67], v24 offset:0
    ds_read_b128 v[68:71], v24 offset:4096
    ds_read_b64_tr_b16 v[72:73], v16 offset:0
    ds_read_b64_tr_b16 v[74:75], v16 offset:512
    ds_read_b128 v[80:83], v25 offset:0
    ds_read_b128 v[84:87], v25 offset:4096
    ds_read_b64_tr_b16 v[88:89], v16 offset:2048
    ds_read_b64_tr_b16 v[90:91], v16 offset:2560
    s_waitcnt lgkmcnt(4)
    v_mfma_f32_32x32x16_bf16 v[96:111], v[72:75], v[64:67], v[96:111]
    v_mfma_f32_32x32x16_bf16 v[112:127], v[72:75], v[68:71], v[112:127]
    ds_read_b128 v[64:67], v26 offset:0
    ds_read_b128 v[68:71], v26 offset:4096
    ds_read_b64_tr_b16 v[72:73], v16 offset:4096
    ds_read_b64_tr_b16 v[74:75], v16 offset:4608
    s_waitcnt lgkmcnt(4)
    v_mfma_f32_32x32x16_bf16 v[96:111], v[88:91], v[80:83], v[96:111]
    v_mfma_f32_32x32x16_bf16 v[112:127], v[88:91], v[84:87], v[112:127]
    ds_read_b128 v[80:83], v27 offset:0
    ds_read_b128 v[84:87], v27 offset:4096
    ds_read_b64_tr_b16 v[88:89], v16 offset:6144
    ds_read_b64_tr_b16 v[90:91], v16 offset:6656
    s_waitcnt lgkmcnt(4)
    v_mfma_f32_32x32x16_bf16 v[96:111], v[72:75], v[64:67], v[96:111]
    v_mfma_f32_32x32x16_bf16 v[112:127], v[72:75], v[68:71], v[112:127]
    s_waitcnt lgkmcnt(0)
    v_mfma_f32_32x32x16_bf16 v[96:111], v[88:91], v[80:83], v[96:111]
    v_mfma_f32_32x32x16_bf16 v[112:127], v[88:91], v[84:87], v[112:127]
    s_waitcnt vmcnt(6)
    s_barrier
    s_add_u32 m0, s41, 0
    s_mov_b32 s35, 1152
    buffer_load_dwordx4 v3, s[16:19], s35 offen lds
    s_add_u32 m0, s41, 1024
    s_mov_b32 s35, 28800
    buffer_load_dwordx4 v3, s[16:19], s35 offen lds
    s_add_u32 m0, s41, 2048
    s_mov_b32 s35, 56448
    buffer_load_dwordx4 v3, s[16:19], s35 offen lds
    s_add_u32 m0, s41, 3072
    s_mov_b32 s35, 84096
    buffer_load_dwordx4 v3, s[16:19], s35 offen lds
    s_add_u32 m0, s42, 0
    s_mov_b32 s35, 737280
    buffer_load_dwordx4 v7, s[20:23], s35 offen lds
    s_add_u32 m0, s42, 1024
    s_mov_b32 s35, 747520
    buffer_load_dwordx4 v7, s[20:23], s35 offen lds
    ds_read_b128 v[64:67], v24 offset:24576
    ds_read_b128 v[68:71], v24 offset:28672
    ds_read_b64_tr_b16 v[72:73], v16 offset:24576
    ds_read_b64_tr_b16 v[74:75], v16 offset:25088
    ds_read_b128 v[80:83], v25 offset:24576
    ds_read_b128 v[84:87], v25 offset:28672
    ds_read_b64_tr_b16 v[88:89], v16 offset:26624
    ds_read_b64_tr_b16 v[90:91], v16 offset:27136
    s_waitcnt lgkmcnt(4)
    v_mfma_f32_32x32x16_bf16 v[96:111], v[72:75], v[64:67], v[96:111]
    v_mfma_f32_32x32x16_bf16 v[112:127], v[72:75], v[68:71], v[112:127]
    ds_read_b128 v[64:67], v26 offset:24576
    ds_read_b128 v[68:71], v26 offset:28672
    ds_read_b64_tr_b16 v[72:73], v16 offset:28672
    ds_read_b64_tr_b16 v[74:75], v16 offset:29184
    s_waitcnt lgkmcnt(4)
    v_mfma_f32_32x32x16_bf16 v[96:111], v[88:91], v[80:83], v[96:111]
    v_mfma_f32_32x32x16_bf16 v[112:127], v[88:91], v[84:87], v[112:127]
    ds_read_b128 v[80:83], v27 offset:24576
    ds_read_b128 v[84:87], v27 offset:28672
    ds_read_b64_tr_b16 v[88:89], v16 offset:30720
    ds_read_b64_tr_b16 v[90:91], v16 offset:31232
    s_waitcnt lgkmcnt(4)
    v_mfma_f32_32x32x16_bf16 v[96:111], v[72:75], v[64:67], v[96:111]
    v_mfma_f32_32x32x16_bf16 v[112:127], v[72:75], v[68:71], v[112:127]
    s_waitcnt lgkmcnt(0)
    v_mfma_f32_32x32x16_bf16 v[96:111], v[88:91], v[80:83], v[96:111]
    v_mfma_f32_32x32x16_bf16 v[112:127], v[88:91], v[84:87], v[112:127]
    s_waitcnt vmcnt(6)
    s_barrier
    s_add_u32 m0, s41, 24576
    s_mov_b32 s35, 1280
    buffer_load_dwordx4 v3, s[16:19], s35 offen lds
    s_add_u32 m0, s41, 25600
    s_mov_b32 s35, 28928
    buffer_load_dwordx4 v3, s[16:19], s35 offen lds
    s_add_u32 m0, s41, 26624
    s_mov_b32 s35, 56576
    buffer_load_dwordx4 v3, s[16:19], s35 offen lds
    s_add_u32 m0, s41, 27648
    s_mov_b32 s35, 84224
    buffer_load_dwordx4 v3, s[16:19], s35 offen lds
    s_add_u32 m0, s42, 24576
    s_mov_b32 s35, 819200
    buffer_load_dwordx4 v7, s[20:23], s35 offen lds
    s_add_u32 m0, s42, 25600
    s_mov_b32 s35, 829440
    buffer_load_dwordx4 v7, s[20:23], s35 offen lds
    ds_read_b128 v[64:67], v24 offset:49152
    ds_read_b128 v[68:71], v24 offset:53248
    ds_read_b64_tr_b16 v[72:73], v16 offset:49152
    ds_read_b64_tr_b16 v[74:75], v16 offset:49664
    ds_read_b128 v[80:83], v25 offset:49152
    ds_read_b128 v[84:87], v25 offset:53248
    ds_read_b64_tr_b16 v[88:89], v16 offset:51200
    ds_read_b64_tr_b16 v[90:91], v16 offset:51712
    s_waitcnt lgkmcnt(4)
    v_mfma_f32_32x32x16_bf16 v[96:111], v[72:75], v[64:67], v[96:111]
    v_mfma_f32_32x32x16_bf16 v[112:127], v[72:75], v[68:71], v[112:127]
    ds_read_b128 v[64:67], v26 offset:49152
    ds_read_b128 v[68:71], v26 offset:53248
    ds_read_b64_tr_b16 v[72:73], v16 offset:53248
    ds_read_b64_tr_b16 v[74:75], v16 offset:53760
    s_waitcnt lgkmcnt(4)
    v_mfma_f32_32x32x16_bf16 v[96:111], v[88:91], v[80:83], v[96:111]
    v_mfma_f32_32x32x16_bf16 v[112:127], v[88:91], v[84:87], v[112:127]
    ds_read_b128 v[80:83], v27 offset:49152
    ds_read_b128 v[84:87], v27 offset:53248
    ds_read_b64_tr_b16 v[88:89], v16 offset:55296
    ds_read_b64_tr_b16 v[90:91], v16 offset:55808
    s_waitcnt lgkmcnt(4)
    v_mfma_f32_32x32x16_bf16 v[96:111], v[72:75], v[64:67], v[96:111]
    v_mfma_f32_32x32x16_bf16 v[112:127], v[72:75], v[68:71], v[112:127]
    s_waitcnt lgkmcnt(0)
    v_mfma_f32_32x32x16_bf16 v[96:111], v[88:91], v[80:83], v[96:111]
    v_mfma_f32_32x32x16_bf16 v[112:127], v[88:91], v[84:87], v[112:127]
    s_waitcnt vmcnt(6)
    s_barrier
    s_add_u32 m0, s41, 49152
    s_mov_b32 s35, 1408
    buffer_load_dwordx4 v3, s[16:19], s35 offen lds
    s_add_u32 m0, s41, 50176
    s_mov_b32 s35, 29056
    buffer_load_dwordx4 v3, s[16:19], s35 offen lds
    s_add_u32 m0, s41, 51200
    s_mov_b32 s35, 56704
    buffer_load_dwordx4 v3, s[16:19], s35 offen lds
    s_add_u32 m0, s41, 52224
    s_mov_b32 s35, 84352
    buffer_load_dwordx4 v3, s[16:19], s35 offen lds
    s_add_u32 m0, s42, 49152
    s_mov_b32 s35, 901120
    buffer_load_dwordx4 v7, s[20:23], s35 offen lds
    s_add_u32 m0, s42, 50176
    s_mov_b32 s35, 911360
    buffer_load_dwordx4 v7, s[20:23], s35 offen lds
    ds_read_b128 v[64:67], v24 offset:0
    ds_read_b128 v[68:71], v24 offset:4096
    ds_read_b64_tr_b16 v[72:73], v16 offset:0
    ds_read_b64_tr_b16 v[74:75], v16 offset:512
    ds_read_b128 v[80:83], v25 offset:0
    ds_read_b128 v[84:87], v25 offset:4096
    ds_read_b64_tr_b16 v[88:89], v16 offset:2048
    ds_read_b64_tr_b16 v[90:91], v16 offset:2560
    s_waitcnt lgkmcnt(4)
    v_mfma_f32_32x32x16_bf16 v[96:111], v[72:75], v[64:67], v[96:111]
    v_mfma_f32_32x32x16_bf16 v[112:127], v[72:75], v[68:71], v[112:127]
    ds_read_b128 v[64:67], v26 offset:0
    ds_read_b128 v[68:71], v26 offset:4096
    ds_read_b64_tr_b16 v[72:73], v16 offset:4096
    ds_read_b64_tr_b16 v[74:75], v16 offset:4608
    s_waitcnt lgkmcnt(4)
    v_mfma_f32_32x32x16_bf16 v[96:111], v[88:91], v[80:83], v[96:111]
    v_mfma_f32_32x32x16_bf16 v[112:127], v[88:91], v[84:87], v[112:127]
    ds_read_b128 v[80:83], v27 offset:0
    ds_read_b128 v[84:87], v27 offset:4096
    ds_read_b64_tr_b16 v[88:89], v16 offset:6144
    ds_read_b64_tr_b16 v[90:91], v16 offset:6656
    s_waitcnt lgkmcnt(4)
    v_mfma_f32_32x32x16_bf16 v[96:111], v[72:75], v[64:67], v[96:111]
    v_mfma_f32_32x32x16_bf16 v[112:127], v[72:75], v[68:71], v[112:127]
    s_waitcnt lgkmcnt(0)
    v_mfma_f32_32x32x16_bf16 v[96:111], v[88:91], v[80:83], v[96:111]
    v_mfma_f32_32x32x16_bf16 v[112:127], v[88:91], v[84:87], v[112:127]
    s_waitcnt vmcnt(6)
    s_barrier
    s_add_u32 m0, s41, 0
    s_mov_b32 s35, 1536
    buffer_load_dwordx4 v3, s[16:19], s35 offen lds
    s_add_u32 m0, s41, 1024
    s_mov_b32 s35, 29184
    buffer_load_dwordx4 v3, s[16:19], s35 offen lds
    s_add_u32 m0, s41, 2048
    s_mov_b32 s35, 56832
    buffer_load_dwordx4 v3, s[16:19], s35 offen lds
    s_add_u32 m0, s41, 3072
    s_mov_b32 s35, 84480
    buffer_load_dwordx4 v3, s[16:19], s35 offen lds
    s_add_u32 m0, s42, 0
    s_mov_b32 s35, 983040
    buffer_load_dwordx4 v7, s[20:23], s35 offen lds
    s_add_u32 m0, s42, 1024
    s_mov_b32 s35, 993280
    buffer_load_dwordx4 v7, s[20:23], s35 offen lds
    ds_read_b128 v[64:67], v24 offset:24576
    ds_read_b128 v[68:71], v24 offset:28672
    ds_read_b64_tr_b16 v[72:73], v16 offset:24576
    ds_read_b64_tr_b16 v[74:75], v16 offset:25088
    ds_read_b128 v[80:83], v25 offset:24576
    ds_read_b128 v[84:87], v25 offset:28672
    ds_read_b64_tr_b16 v[88:89], v16 offset:26624
    ds_read_b64_tr_b16 v[90:91], v16 offset:27136
    s_waitcnt lgkmcnt(4)
    v_mfma_f32_32x32x16_bf16 v[96:111], v[72:75], v[64:67], v[96:111]
    v_mfma_f32_32x32x16_bf16 v[112:127], v[72:75], v[68:71], v[112:127]
    ds_read_b128 v[64:67], v26 offset:24576
    ds_read_b128 v[68:71], v26 offset:28672
    ds_read_b64_tr_b16 v[72:73], v16 offset:28672
    ds_read_b64_tr_b16 v[74:75], v16 offset:29184
    s_waitcnt lgkmcnt(4)
    v_mfma_f32_32x32x16_bf16 v[96:111], v[88:91], v[80:83], v[96:111]
    v_mfma_f32_32x32x16_bf16 v[112:127], v[88:91], v[84:87], v[112:127]
    ds_read_b128 v[80:83], v27 offset:24576
    ds_read_b128 v[84:87], v27 offset:28672
    ds_read_b64_tr_b16 v[88:89], v16 offset:30720
    ds_read_b64_tr_b16 v[90:91], v16 offset:31232
    s_waitcnt lgkmcnt(4)
    v_mfma_f32_32x32x16_bf16 v[96:111], v[72:75], v[64:67], v[96:111]
    v_mfma_f32_32x32x16_bf16 v[112:127], v[72:75], v[68:71], v[112:127]
    s_waitcnt lgkmcnt(0)
    v_mfma_f32_32x32x16_bf16 v[96:111], v[88:91], v[80:83], v[96:111]
    v_mfma_f32_32x32x16_bf16 v[112:127], v[88:91], v[84:87], v[112:127]
    s_waitcnt vmcnt(6)
    s_barrier
    s_add_u32 m0, s41, 24576
    s_mov_b32 s35, 1664
    buffer_load_dwordx4 v3, s[16:19], s35 offen lds
    s_add_u32 m0, s41, 25600
    s_mov_b32 s35, 29312
    buffer_load_dwordx4 v3, s[16:19], s35 offen lds
    s_add_u32 m0, s41, 26624
    s_mov_b32 s35, 56960
    buffer_load_dwordx4 v3, s[16:19], s35 offen lds
    s_add_u32 m0, s41, 27648
    s_mov_b32 s35, 84608
    buffer_load_dwordx4 v3, s[16:19], s35 offen lds
    s_add_u32 m0, s42, 24576
    s_mov_b32 s35, 1064960
    buffer_load_dwordx4 v7, s[20:23], s35 offen lds
    s_add_u32 m0, s42, 25600
    s_mov_b32 s35, 1075200
    buffer_load_dwordx4 v7, s[20:23], s35 offen lds
    ds_read_b128 v[64:67], v24 offset:49152
    ds_read_b128 v[68:71], v24 offset:53248
    ds_read_b64_tr_b16 v[72:73], v16 offset:49152
    ds_read_b64_tr_b16 v[74:75], v16 offset:49664
    ds_read_b128 v[80:83], v25 offset:49152
    ds_read_b128 v[84:87], v25 offset:53248
    ds_read_b64_tr_b16 v[88:89], v16 offset:51200
    ds_read_b64_tr_b16 v[90:91], v16 offset:51712
    s_waitcnt lgkmcnt(4)
    v_mfma_f32_32x32x16_bf16 v[96:111], v[72:75], v[64:67], v[96:111]
    v_mfma_f32_32x32x16_bf16 v[112:127], v[72:75], v[68:71], v[112:127]
    ds_read_b128 v[64:67], v26 offset:49152
    ds_read_b128 v[68:71], v26 offset:53248
    ds_read_b64_tr_b16 v[72:73], v16 offset:53248
    ds_read_b64_tr_b16 v[74:75], v16 offset:53760
    s_waitcnt lgkmcnt(4)
    v_mfma_f32_32x32x16_bf16 v[96:111], v[88:91], v[80:83], v[96:111]
    v_mfma_f32_32x32x16_bf16 v[112:127], v[88:91], v[84:87], v[112:127]
    ds_read_b128 v[80:83], v27 offset:49152
    ds_read_b128 v[84:87], v27 offset:53248
    ds_read_b64_tr_b16 v[88:89], v16 offset:55296
    ds_read_b64_tr_b16 v[90:91], v16 offset:55808
    s_waitcnt lgkmcnt(4)
    v_mfma_f32_32x32x16_bf16 v[96:111], v[72:75], v[64:67], v[96:111]
    v_mfma_f32_32x32x16_bf16 v[112:127], v[72:75], v[68:71], v[112:127]
    s_waitcnt lgkmcnt(0)
    v_mfma_f32_32x32x16_bf16 v[96:111], v[88:91], v[80:83], v[96:111]
    v_mfma_f32_32x32x16_bf16 v[112:127], v[88:91], v[84:87], v[112:127]
    s_waitcnt vmcnt(6)
    s_barrier
    s_add_u32 m0, s41, 49152
    s_mov_b32 s35, 1792
    buffer_load_dwordx4 v3, s[16:19], s35 offen lds
    s_add_u32 m0, s41, 50176
    s_mov_b32 s35, 29440
    buffer_load_dwordx4 v3, s[16:19], s35 offen lds
    s_add_u32 m0, s41, 51200
    s_mov_b32 s35, 57088
    buffer_load_dwordx4 v3, s[16:19], s35 offen lds
    s_add_u32 m0, s41, 52224
    s_mov_b32 s35, 84736
    buffer_load_dwordx4 v3, s[16:19], s35 offen lds
    s_add_u32 m0, s42, 49152
    s_mov_b32 s35, 1146880
    buffer_load_dwordx4 v7, s[20:23], s35 offen lds
    s_add_u32 m0, s42, 50176
    s_mov_b32 s35, 1157120
    buffer_load_dwordx4 v7, s[20:23], s35 offen lds
    ds_read_b128 v[64:67], v24 offset:0
    ds_read_b128 v[68:71], v24 offset:4096
    ds_read_b64_tr_b16 v[72:73], v16 offset:0
    ds_read_b64_tr_b16 v[74:75], v16 offset:512
    ds_read_b128 v[80:83], v25 offset:0
    ds_read_b128 v[84:87], v25 offset:4096
    ds_read_b64_tr_b16 v[88:89], v16 offset:2048
    ds_read_b64_tr_b16 v[90:91], v16 offset:2560
    s_waitcnt lgkmcnt(4)
    v_mfma_f32_32x32x16_bf16 v[96:111], v[72:75], v[64:67], v[96:111]
    v_mfma_f32_32x32x16_bf16 v[112:127], v[72:75], v[68:71], v[112:127]
    ds_read_b128 v[64:67], v26 offset:0
    ds_read_b128 v[68:71], v26 offset:4096
    ds_read_b64_tr_b16 v[72:73], v16 offset:4096
    ds_read_b64_tr_b16 v[74:75], v16 offset:4608
    s_waitcnt lgkmcnt(4)
    v_mfma_f32_32x32x16_bf16 v[96:111], v[88:91], v[80:83], v[96:111]
    v_mfma_f32_32x32x16_bf16 v[112:127], v[88:91], v[84:87], v[112:127]
    ds_read_b128 v[80:83], v27 offset:0
    ds_read_b128 v[84:87], v27 offset:4096
    ds_read_b64_tr_b16 v[88:89], v16 offset:6144
    ds_read_b64_tr_b16 v[90:91], v16 offset:6656
    s_waitcnt lgkmcnt(4)
    v_mfma_f32_32x32x16_bf16 v[96:111], v[72:75], v[64:67], v[96:111]
    v_mfma_f32_32x32x16_bf16 v[112:127], v[72:75], v[68:71], v[112:127]
    s_waitcnt lgkmcnt(0)
    v_mfma_f32_32x32x16_bf16 v[96:111], v[88:91], v[80:83], v[96:111]
    v_mfma_f32_32x32x16_bf16 v[112:127], v[88:91], v[84:87], v[112:127]
    s_waitcnt vmcnt(6)
    s_barrier
    s_add_u32 m0, s41, 0
    s_mov_b32 s35, 1920
    buffer_load_dwordx4 v3, s[16:19], s35 offen lds
    s_add_u32 m0, s41, 1024
    s_mov_b32 s35, 29568
    buffer_load_dwordx4 v3, s[16:19], s35 offen lds
    s_add_u32 m0, s41, 2048
    s_mov_b32 s35, 57216
    buffer_load_dwordx4 v3, s[16:19], s35 offen lds
    s_add_u32 m0, s41, 3072
    s_mov_b32 s35, 84864
    buffer_load_dwordx4 v3, s[16:19], s35 offen lds
    s_add_u32 m0, s42, 0
    s_mov_b32 s35, 1228800
    buffer_load_dwordx4 v7, s[20:23], s35 offen lds
    s_add_u32 m0, s42, 1024
    s_mov_b32 s35, 1239040
    buffer_load_dwordx4 v7, s[20:23], s35 offen lds
    ds_read_b128 v[64:67], v24 offset:24576
    ds_read_b128 v[68:71], v24 offset:28672
    ds_read_b64_tr_b16 v[72:73], v16 offset:24576
    ds_read_b64_tr_b16 v[74:75], v16 offset:25088
    ds_read_b128 v[80:83], v25 offset:24576
    ds_read_b128 v[84:87], v25 offset:28672
    ds_read_b64_tr_b16 v[88:89], v16 offset:26624
    ds_read_b64_tr_b16 v[90:91], v16 offset:27136
    s_waitcnt lgkmcnt(4)
    v_mfma_f32_32x32x16_bf16 v[96:111], v[72:75], v[64:67], v[96:111]
    v_mfma_f32_32x32x16_bf16 v[112:127], v[72:75], v[68:71], v[112:127]
    ds_read_b128 v[64:67], v26 offset:24576
    ds_read_b128 v[68:71], v26 offset:28672
    ds_read_b64_tr_b16 v[72:73], v16 offset:28672
    ds_read_b64_tr_b16 v[74:75], v16 offset:29184
    s_waitcnt lgkmcnt(4)
    v_mfma_f32_32x32x16_bf16 v[96:111], v[88:91], v[80:83], v[96:111]
    v_mfma_f32_32x32x16_bf16 v[112:127], v[88:91], v[84:87], v[112:127]
    ds_read_b128 v[80:83], v27 offset:24576
    ds_read_b128 v[84:87], v27 offset:28672
    ds_read_b64_tr_b16 v[88:89], v16 offset:30720
    ds_read_b64_tr_b16 v[90:91], v16 offset:31232
    s_waitcnt lgkmcnt(4)
    v_mfma_f32_32x32x16_bf16 v[96:111], v[72:75], v[64:67], v[96:111]
    v_mfma_f32_32x32x16_bf16 v[112:127], v[72:75], v[68:71], v[112:127]
    s_waitcnt lgkmcnt(0)
    v_mfma_f32_32x32x16_bf16 v[96:111], v[88:91], v[80:83], v[96:111]
    v_mfma_f32_32x32x16_bf16 v[112:127], v[88:91], v[84:87], v[112:127]
    s_waitcnt vmcnt(6)
    s_barrier
    s_add_u32 m0, s41, 24576
    s_mov_b32 s35, 2048
    buffer_load_dwordx4 v3, s[16:19], s35 offen lds
    s_add_u32 m0, s41, 25600
    s_mov_b32 s35, 29696
    buffer_load_dwordx4 v3, s[16:19], s35 offen lds
    s_add_u32 m0, s41, 26624
    s_mov_b32 s35, 57344
    buffer_load_dwordx4 v3, s[16:19], s35 offen lds
    s_add_u32 m0, s41, 27648
    s_mov_b32 s35, 84992
    buffer_load_dwordx4 v3, s[16:19], s35 offen lds
    s_add_u32 m0, s42, 24576
    s_mov_b32 s35, 1310720
    buffer_load_dwordx4 v7, s[20:23], s35 offen lds
    s_add_u32 m0, s42, 25600
    s_mov_b32 s35, 1320960
    buffer_load_dwordx4 v7, s[20:23], s35 offen lds
    ds_read_b128 v[64:67], v24 offset:49152
    ds_read_b128 v[68:71], v24 offset:53248
    ds_read_b64_tr_b16 v[72:73], v16 offset:49152
    ds_read_b64_tr_b16 v[74:75], v16 offset:49664
    ds_read_b128 v[80:83], v25 offset:49152
    ds_read_b128 v[84:87], v25 offset:53248
    ds_read_b64_tr_b16 v[88:89], v16 offset:51200
    ds_read_b64_tr_b16 v[90:91], v16 offset:51712
    s_waitcnt lgkmcnt(4)
    v_mfma_f32_32x32x16_bf16 v[96:111], v[72:75], v[64:67], v[96:111]
    v_mfma_f32_32x32x16_bf16 v[112:127], v[72:75], v[68:71], v[112:127]
    ds_read_b128 v[64:67], v26 offset:49152
    ds_read_b128 v[68:71], v26 offset:53248
    ds_read_b64_tr_b16 v[72:73], v16 offset:53248
    ds_read_b64_tr_b16 v[74:75], v16 offset:53760
    s_waitcnt lgkmcnt(4)
    v_mfma_f32_32x32x16_bf16 v[96:111], v[88:91], v[80:83], v[96:111]
    v_mfma_f32_32x32x16_bf16 v[112:127], v[88:91], v[84:87], v[112:127]
    ds_read_b128 v[80:83], v27 offset:49152
    ds_read_b128 v[84:87], v27 offset:53248
    ds_read_b64_tr_b16 v[88:89], v16 offset:55296
    ds_read_b64_tr_b16 v[90:91], v16 offset:55808
    s_waitcnt lgkmcnt(4)
    v_mfma_f32_32x32x16_bf16 v[96:111], v[72:75], v[64:67], v[96:111]
    v_mfma_f32_32x32x16_bf16 v[112:127], v[72:75], v[68:71], v[112:127]
    s_waitcnt lgkmcnt(0)
    v_mfma_f32_32x32x16_bf16 v[96:111], v[88:91], v[80:83], v[96:111]
    v_mfma_f32_32x32x16_bf16 v[112:127], v[88:91], v[84:87], v[112:127]
    s_waitcnt vmcnt(6)
    s_barrier
    s_add_u32 m0, s41, 49152
    s_mov_b32 s35, 2176
    buffer_load_dwordx4 v3, s[16:19], s35 offen lds
    s_add_u32 m0, s41, 50176
    s_mov_b32 s35, 29824
    buffer_load_dwordx4 v3, s[16:19], s35 offen lds
    s_add_u32 m0, s41, 51200
    s_mov_b32 s35, 57472
    buffer_load_dwordx4 v3, s[16:19], s35 offen lds
    s_add_u32 m0, s41, 52224
    s_mov_b32 s35, 85120
    buffer_load_dwordx4 v3, s[16:19], s35 offen lds
    s_add_u32 m0, s42, 49152
    s_mov_b32 s35, 1392640
    buffer_load_dwordx4 v7, s[20:23], s35 offen lds
    s_add_u32 m0, s42, 50176
    s_mov_b32 s35, 1402880
    buffer_load_dwordx4 v7, s[20:23], s35 offen lds
    ds_read_b128 v[64:67], v24 offset:0
    ds_read_b128 v[68:71], v24 offset:4096
    ds_read_b64_tr_b16 v[72:73], v16 offset:0
    ds_read_b64_tr_b16 v[74:75], v16 offset:512
    ds_read_b128 v[80:83], v25 offset:0
    ds_read_b128 v[84:87], v25 offset:4096
    ds_read_b64_tr_b16 v[88:89], v16 offset:2048
    ds_read_b64_tr_b16 v[90:91], v16 offset:2560
    s_waitcnt lgkmcnt(4)
    v_mfma_f32_32x32x16_bf16 v[96:111], v[72:75], v[64:67], v[96:111]
    v_mfma_f32_32x32x16_bf16 v[112:127], v[72:75], v[68:71], v[112:127]
    ds_read_b128 v[64:67], v26 offset:0
    ds_read_b128 v[68:71], v26 offset:4096
    ds_read_b64_tr_b16 v[72:73], v16 offset:4096
    ds_read_b64_tr_b16 v[74:75], v16 offset:4608
    s_waitcnt lgkmcnt(4)
    v_mfma_f32_32x32x16_bf16 v[96:111], v[88:91], v[80:83], v[96:111]
    v_mfma_f32_32x32x16_bf16 v[112:127], v[88:91], v[84:87], v[112:127]
    ds_read_b128 v[80:83], v27 offset:0
    ds_read_b128 v[84:87], v27 offset:4096
    ds_read_b64_tr_b16 v[88:89], v16 offset:6144
    ds_read_b64_tr_b16 v[90:91], v16 offset:6656
    s_waitcnt lgkmcnt(4)
    v_mfma_f32_32x32x16_bf16 v[96:111], v[72:75], v[64:67], v[96:111]
    v_mfma_f32_32x32x16_bf16 v[112:127], v[72:75], v[68:71], v[112:127]
    s_waitcnt lgkmcnt(0)
    v_mfma_f32_32x32x16_bf16 v[96:111], v[88:91], v[80:83], v[96:111]
    v_mfma_f32_32x32x16_bf16 v[112:127], v[88:91], v[84:87], v[112:127]
    s_waitcnt vmcnt(6)
    s_barrier
    s_add_u32 m0, s41, 0
    s_mov_b32 s35, 2304
    buffer_load_dwordx4 v3, s[16:19], s35 offen lds
    s_add_u32 m0, s41, 1024
    s_mov_b32 s35, 29952
    buffer_load_dwordx4 v3, s[16:19], s35 offen lds
    s_add_u32 m0, s41, 2048
    s_mov_b32 s35, 57600
    buffer_load_dwordx4 v3, s[16:19], s35 offen lds
    s_add_u32 m0, s41, 3072
    s_mov_b32 s35, 85248
    buffer_load_dwordx4 v3, s[16:19], s35 offen lds
    s_add_u32 m0, s42, 0
    s_mov_b32 s35, 1474560
    buffer_load_dwordx4 v7, s[20:23], s35 offen lds
    s_add_u32 m0, s42, 1024
    s_mov_b32 s35, 1484800
    buffer_load_dwordx4 v7, s[20:23], s35 offen lds
    ds_read_b128 v[64:67], v24 offset:24576
    ds_read_b128 v[68:71], v24 offset:28672
    ds_read_b64_tr_b16 v[72:73], v16 offset:24576
    ds_read_b64_tr_b16 v[74:75], v16 offset:25088
    ds_read_b128 v[80:83], v25 offset:24576
    ds_read_b128 v[84:87], v25 offset:28672
    ds_read_b64_tr_b16 v[88:89], v16 offset:26624
    ds_read_b64_tr_b16 v[90:91], v16 offset:27136
    s_waitcnt lgkmcnt(4)
    v_mfma_f32_32x32x16_bf16 v[96:111], v[72:75], v[64:67], v[96:111]
    v_mfma_f32_32x32x16_bf16 v[112:127], v[72:75], v[68:71], v[112:127]
    ds_read_b128 v[64:67], v26 offset:24576
    ds_read_b128 v[68:71], v26 offset:28672
    ds_read_b64_tr_b16 v[72:73], v16 offset:28672
    ds_read_b64_tr_b16 v[74:75], v16 offset:29184
    s_waitcnt lgkmcnt(4)
    v_mfma_f32_32x32x16_bf16 v[96:111], v[88:91], v[80:83], v[96:111]
    v_mfma_f32_32x32x16_bf16 v[112:127], v[88:91], v[84:87], v[112:127]
    ds_read_b128 v[80:83], v27 offset:24576
    ds_read_b128 v[84:87], v27 offset:28672
    ds_read_b64_tr_b16 v[88:89], v16 offset:30720
    ds_read_b64_tr_b16 v[90:91], v16 offset:31232
    s_waitcnt lgkmcnt(4)
    v_mfma_f32_32x32x16_bf16 v[96:111], v[72:75], v[64:67], v[96:111]
    v_mfma_f32_32x32x16_bf16 v[112:127], v[72:75], v[68:71], v[112:127]
    s_waitcnt lgkmcnt(0)
    v_mfma_f32_32x32x16_bf16 v[96:111], v[88:91], v[80:83], v[96:111]
    v_mfma_f32_32x32x16_bf16 v[112:127], v[88:91], v[84:87], v[112:127]
    s_waitcnt vmcnt(6)
    s_barrier
    s_add_u32 m0, s41, 24576
    s_mov_b32 s35, 2432
    buffer_load_dwordx4 v3, s[16:19], s35 offen lds
    s_add_u32 m0, s41, 25600
    s_mov_b32 s35, 30080
    buffer_load_dwordx4 v3, s[16:19], s35 offen lds
    s_add_u32 m0, s41, 26624
    s_mov_b32 s35, 57728
    buffer_load_dwordx4 v3, s[16:19], s35 offen lds
    s_add_u32 m0, s41, 27648
    s_mov_b32 s35, 85376
    buffer_load_dwordx4 v3, s[16:19], s35 offen lds
    s_add_u32 m0, s42, 24576
    s_mov_b32 s35, 1556480
    buffer_load_dwordx4 v7, s[20:23], s35 offen lds
    s_add_u32 m0, s42, 25600
    s_mov_b32 s35, 1566720
    buffer_load_dwordx4 v7, s[20:23], s35 offen lds
    ds_read_b128 v[64:67], v24 offset:49152
    ds_read_b128 v[68:71], v24 offset:53248
    ds_read_b64_tr_b16 v[72:73], v16 offset:49152
    ds_read_b64_tr_b16 v[74:75], v16 offset:49664
    ds_read_b128 v[80:83], v25 offset:49152
    ds_read_b128 v[84:87], v25 offset:53248
    ds_read_b64_tr_b16 v[88:89], v16 offset:51200
    ds_read_b64_tr_b16 v[90:91], v16 offset:51712
    s_waitcnt lgkmcnt(4)
    v_mfma_f32_32x32x16_bf16 v[96:111], v[72:75], v[64:67], v[96:111]
    v_mfma_f32_32x32x16_bf16 v[112:127], v[72:75], v[68:71], v[112:127]
    ds_read_b128 v[64:67], v26 offset:49152
    ds_read_b128 v[68:71], v26 offset:53248
    ds_read_b64_tr_b16 v[72:73], v16 offset:53248
    ds_read_b64_tr_b16 v[74:75], v16 offset:53760
    s_waitcnt lgkmcnt(4)
    v_mfma_f32_32x32x16_bf16 v[96:111], v[88:91], v[80:83], v[96:111]
    v_mfma_f32_32x32x16_bf16 v[112:127], v[88:91], v[84:87], v[112:127]
    ds_read_b128 v[80:83], v27 offset:49152
    ds_read_b128 v[84:87], v27 offset:53248
    ds_read_b64_tr_b16 v[88:89], v16 offset:55296
    ds_read_b64_tr_b16 v[90:91], v16 offset:55808
    s_waitcnt lgkmcnt(4)
    v_mfma_f32_32x32x16_bf16 v[96:111], v[72:75], v[64:67], v[96:111]
    v_mfma_f32_32x32x16_bf16 v[112:127], v[72:75], v[68:71], v[112:127]
    s_waitcnt lgkmcnt(0)
    v_mfma_f32_32x32x16_bf16 v[96:111], v[88:91], v[80:83], v[96:111]
    v_mfma_f32_32x32x16_bf16 v[112:127], v[88:91], v[84:87], v[112:127]
    s_waitcnt vmcnt(6)
    s_barrier
    s_add_u32 m0, s41, 49152
    s_mov_b32 s35, 2560
    buffer_load_dwordx4 v3, s[16:19], s35 offen lds
    s_add_u32 m0, s41, 50176
    s_mov_b32 s35, 30208
    buffer_load_dwordx4 v3, s[16:19], s35 offen lds
    s_add_u32 m0, s41, 51200
    s_mov_b32 s35, 57856
    buffer_load_dwordx4 v3, s[16:19], s35 offen lds
    s_add_u32 m0, s41, 52224
    s_mov_b32 s35, 85504
    buffer_load_dwordx4 v3, s[16:19], s35 offen lds
    s_add_u32 m0, s42, 49152
    s_mov_b32 s35, 1638400
    buffer_load_dwordx4 v7, s[20:23], s35 offen lds
    s_add_u32 m0, s42, 50176
    s_mov_b32 s35, 1648640
    buffer_load_dwordx4 v7, s[20:23], s35 offen lds
    ds_read_b128 v[64:67], v24 offset:0
    ds_read_b128 v[68:71], v24 offset:4096
    ds_read_b64_tr_b16 v[72:73], v16 offset:0
    ds_read_b64_tr_b16 v[74:75], v16 offset:512
    ds_read_b128 v[80:83], v25 offset:0
    ds_read_b128 v[84:87], v25 offset:4096
    ds_read_b64_tr_b16 v[88:89], v16 offset:2048
    ds_read_b64_tr_b16 v[90:91], v16 offset:2560
    s_waitcnt lgkmcnt(4)
    v_mfma_f32_32x32x16_bf16 v[96:111], v[72:75], v[64:67], v[96:111]
    v_mfma_f32_32x32x16_bf16 v[112:127], v[72:75], v[68:71], v[112:127]
    ds_read_b128 v[64:67], v26 offset:0
    ds_read_b128 v[68:71], v26 offset:4096
    ds_read_b64_tr_b16 v[72:73], v16 offset:4096
    ds_read_b64_tr_b16 v[74:75], v16 offset:4608
    s_waitcnt lgkmcnt(4)
    v_mfma_f32_32x32x16_bf16 v[96:111], v[88:91], v[80:83], v[96:111]
    v_mfma_f32_32x32x16_bf16 v[112:127], v[88:91], v[84:87], v[112:127]
    ds_read_b128 v[80:83], v27 offset:0
    ds_read_b128 v[84:87], v27 offset:4096
    ds_read_b64_tr_b16 v[88:89], v16 offset:6144
    ds_read_b64_tr_b16 v[90:91], v16 offset:6656
    s_waitcnt lgkmcnt(4)
    v_mfma_f32_32x32x16_bf16 v[96:111], v[72:75], v[64:67], v[96:111]
    v_mfma_f32_32x32x16_bf16 v[112:127], v[72:75], v[68:71], v[112:127]
    s_waitcnt lgkmcnt(0)
    v_mfma_f32_32x32x16_bf16 v[96:111], v[88:91], v[80:83], v[96:111]
    v_mfma_f32_32x32x16_bf16 v[112:127], v[88:91], v[84:87], v[112:127]
    s_waitcnt vmcnt(6)
    s_barrier
    s_add_u32 m0, s41, 0
    s_mov_b32 s35, 2688
    buffer_load_dwordx4 v3, s[16:19], s35 offen lds
    s_add_u32 m0, s41, 1024
    s_mov_b32 s35, 30336
    buffer_load_dwordx4 v3, s[16:19], s35 offen lds
    s_add_u32 m0, s41, 2048
    s_mov_b32 s35, 57984
    buffer_load_dwordx4 v3, s[16:19], s35 offen lds
    s_add_u32 m0, s41, 3072
    s_mov_b32 s35, 85632
    buffer_load_dwordx4 v3, s[16:19], s35 offen lds
    s_add_u32 m0, s42, 0
    s_mov_b32 s35, 1720320
    buffer_load_dwordx4 v7, s[20:23], s35 offen lds
    s_add_u32 m0, s42, 1024
    s_mov_b32 s35, 1730560
    buffer_load_dwordx4 v7, s[20:23], s35 offen lds
    ds_read_b128 v[64:67], v24 offset:24576
    ds_read_b128 v[68:71], v24 offset:28672
    ds_read_b64_tr_b16 v[72:73], v16 offset:24576
    ds_read_b64_tr_b16 v[74:75], v16 offset:25088
    ds_read_b128 v[80:83], v25 offset:24576
    ds_read_b128 v[84:87], v25 offset:28672
    ds_read_b64_tr_b16 v[88:89], v16 offset:26624
    ds_read_b64_tr_b16 v[90:91], v16 offset:27136
    s_waitcnt lgkmcnt(4)
    v_mfma_f32_32x32x16_bf16 v[96:111], v[72:75], v[64:67], v[96:111]
    v_mfma_f32_32x32x16_bf16 v[112:127], v[72:75], v[68:71], v[112:127]
    ds_read_b128 v[64:67], v26 offset:24576
    ds_read_b128 v[68:71], v26 offset:28672
    ds_read_b64_tr_b16 v[72:73], v16 offset:28672
    ds_read_b64_tr_b16 v[74:75], v16 offset:29184
    s_waitcnt lgkmcnt(4)
    v_mfma_f32_32x32x16_bf16 v[96:111], v[88:91], v[80:83], v[96:111]
    v_mfma_f32_32x32x16_bf16 v[112:127], v[88:91], v[84:87], v[112:127]
    ds_read_b128 v[80:83], v27 offset:24576
    ds_read_b128 v[84:87], v27 offset:28672
    ds_read_b64_tr_b16 v[88:89], v16 offset:30720
    ds_read_b64_tr_b16 v[90:91], v16 offset:31232
    s_waitcnt lgkmcnt(4)
    v_mfma_f32_32x32x16_bf16 v[96:111], v[72:75], v[64:67], v[96:111]
    v_mfma_f32_32x32x16_bf16 v[112:127], v[72:75], v[68:71], v[112:127]
    s_waitcnt lgkmcnt(0)
    v_mfma_f32_32x32x16_bf16 v[96:111], v[88:91], v[80:83], v[96:111]
    v_mfma_f32_32x32x16_bf16 v[112:127], v[88:91], v[84:87], v[112:127]
    s_waitcnt vmcnt(6)
    s_barrier
    s_add_u32 m0, s41, 24576
    s_mov_b32 s35, 2816
    buffer_load_dwordx4 v3, s[16:19], s35 offen lds
    s_add_u32 m0, s41, 25600
    s_mov_b32 s35, 30464
    buffer_load_dwordx4 v3, s[16:19], s35 offen lds
    s_add_u32 m0, s41, 26624
    s_mov_b32 s35, 58112
    buffer_load_dwordx4 v3, s[16:19], s35 offen lds
    s_add_u32 m0, s41, 27648
    s_mov_b32 s35, 85760
    buffer_load_dwordx4 v3, s[16:19], s35 offen lds
    s_add_u32 m0, s42, 24576
    s_mov_b32 s35, 1802240
    buffer_load_dwordx4 v7, s[20:23], s35 offen lds
    s_add_u32 m0, s42, 25600
    s_mov_b32 s35, 1812480
    buffer_load_dwordx4 v7, s[20:23], s35 offen lds
    ds_read_b128 v[64:67], v24 offset:49152
    ds_read_b128 v[68:71], v24 offset:53248
    ds_read_b64_tr_b16 v[72:73], v16 offset:49152
    ds_read_b64_tr_b16 v[74:75], v16 offset:49664
    ds_read_b128 v[80:83], v25 offset:49152
    ds_read_b128 v[84:87], v25 offset:53248
    ds_read_b64_tr_b16 v[88:89], v16 offset:51200
    ds_read_b64_tr_b16 v[90:91], v16 offset:51712
    s_waitcnt lgkmcnt(4)
    v_mfma_f32_32x32x16_bf16 v[96:111], v[72:75], v[64:67], v[96:111]
    v_mfma_f32_32x32x16_bf16 v[112:127], v[72:75], v[68:71], v[112:127]
    ds_read_b128 v[64:67], v26 offset:49152
    ds_read_b128 v[68:71], v26 offset:53248
    ds_read_b64_tr_b16 v[72:73], v16 offset:53248
    ds_read_b64_tr_b16 v[74:75], v16 offset:53760
    s_waitcnt lgkmcnt(4)
    v_mfma_f32_32x32x16_bf16 v[96:111], v[88:91], v[80:83], v[96:111]
    v_mfma_f32_32x32x16_bf16 v[112:127], v[88:91], v[84:87], v[112:127]
    ds_read_b128 v[80:83], v27 offset:49152
    ds_read_b128 v[84:87], v27 offset:53248
    ds_read_b64_tr_b16 v[88:89], v16 offset:55296
    ds_read_b64_tr_b16 v[90:91], v16 offset:55808
    s_waitcnt lgkmcnt(4)
    v_mfma_f32_32x32x16_bf16 v[96:111], v[72:75], v[64:67], v[96:111]
    v_mfma_f32_32x32x16_bf16 v[112:127], v[72:75], v[68:71], v[112:127]
    s_waitcnt lgkmcnt(0)
    v_mfma_f32_32x32x16_bf16 v[96:111], v[88:91], v[80:83], v[96:111]
    v_mfma_f32_32x32x16_bf16 v[112:127], v[88:91], v[84:87], v[112:127]
    s_waitcnt vmcnt(6)
    s_barrier
    s_add_u32 m0, s41, 49152
    s_mov_b32 s35, 2944
    buffer_load_dwordx4 v3, s[16:19], s35 offen lds
    s_add_u32 m0, s41, 50176
    s_mov_b32 s35, 30592
    buffer_load_dwordx4 v3, s[16:19], s35 offen lds
    s_add_u32 m0, s41, 51200
    s_mov_b32 s35, 58240
    buffer_load_dwordx4 v3, s[16:19], s35 offen lds
    s_add_u32 m0, s41, 52224
    s_mov_b32 s35, 85888
    buffer_load_dwordx4 v3, s[16:19], s35 offen lds
    s_add_u32 m0, s42, 49152
    s_mov_b32 s35, 1884160
    buffer_load_dwordx4 v7, s[20:23], s35 offen lds
    s_add_u32 m0, s42, 50176
    s_mov_b32 s35, 1894400
    buffer_load_dwordx4 v7, s[20:23], s35 offen lds
    ds_read_b128 v[64:67], v24 offset:0
    ds_read_b128 v[68:71], v24 offset:4096
    ds_read_b64_tr_b16 v[72:73], v16 offset:0
    ds_read_b64_tr_b16 v[74:75], v16 offset:512
    ds_read_b128 v[80:83], v25 offset:0
    ds_read_b128 v[84:87], v25 offset:4096
    ds_read_b64_tr_b16 v[88:89], v16 offset:2048
    ds_read_b64_tr_b16 v[90:91], v16 offset:2560
    s_waitcnt lgkmcnt(4)
    v_mfma_f32_32x32x16_bf16 v[96:111], v[72:75], v[64:67], v[96:111]
    v_mfma_f32_32x32x16_bf16 v[112:127], v[72:75], v[68:71], v[112:127]
    ds_read_b128 v[64:67], v26 offset:0
    ds_read_b128 v[68:71], v26 offset:4096
    ds_read_b64_tr_b16 v[72:73], v16 offset:4096
    ds_read_b64_tr_b16 v[74:75], v16 offset:4608
    s_waitcnt lgkmcnt(4)
    v_mfma_f32_32x32x16_bf16 v[96:111], v[88:91], v[80:83], v[96:111]
    v_mfma_f32_32x32x16_bf16 v[112:127], v[88:91], v[84:87], v[112:127]
    ds_read_b128 v[80:83], v27 offset:0
    ds_read_b128 v[84:87], v27 offset:4096
    ds_read_b64_tr_b16 v[88:89], v16 offset:6144
    ds_read_b64_tr_b16 v[90:91], v16 offset:6656
    s_waitcnt lgkmcnt(4)
    v_mfma_f32_32x32x16_bf16 v[96:111], v[72:75], v[64:67], v[96:111]
    v_mfma_f32_32x32x16_bf16 v[112:127], v[72:75], v[68:71], v[112:127]
    s_waitcnt lgkmcnt(0)
    v_mfma_f32_32x32x16_bf16 v[96:111], v[88:91], v[80:83], v[96:111]
    v_mfma_f32_32x32x16_bf16 v[112:127], v[88:91], v[84:87], v[112:127]
    s_waitcnt vmcnt(6)
    s_barrier
    s_add_u32 m0, s41, 0
    s_mov_b32 s35, 3072
    buffer_load_dwordx4 v3, s[16:19], s35 offen lds
    s_add_u32 m0, s41, 1024
    s_mov_b32 s35, 30720
    buffer_load_dwordx4 v3, s[16:19], s35 offen lds
    s_add_u32 m0, s41, 2048
    s_mov_b32 s35, 58368
    buffer_load_dwordx4 v3, s[16:19], s35 offen lds
    s_add_u32 m0, s41, 3072
    s_mov_b32 s35, 86016
    buffer_load_dwordx4 v3, s[16:19], s35 offen lds
    s_add_u32 m0, s42, 0
    s_mov_b32 s35, 1966080
    buffer_load_dwordx4 v7, s[20:23], s35 offen lds
    s_add_u32 m0, s42, 1024
    s_mov_b32 s35, 1976320
    buffer_load_dwordx4 v7, s[20:23], s35 offen lds
    ds_read_b128 v[64:67], v24 offset:24576
    ds_read_b128 v[68:71], v24 offset:28672
    ds_read_b64_tr_b16 v[72:73], v16 offset:24576
    ds_read_b64_tr_b16 v[74:75], v16 offset:25088
    ds_read_b128 v[80:83], v25 offset:24576
    ds_read_b128 v[84:87], v25 offset:28672
    ds_read_b64_tr_b16 v[88:89], v16 offset:26624
    ds_read_b64_tr_b16 v[90:91], v16 offset:27136
    s_waitcnt lgkmcnt(4)
    v_mfma_f32_32x32x16_bf16 v[96:111], v[72:75], v[64:67], v[96:111]
    v_mfma_f32_32x32x16_bf16 v[112:127], v[72:75], v[68:71], v[112:127]
    ds_read_b128 v[64:67], v26 offset:24576
    ds_read_b128 v[68:71], v26 offset:28672
    ds_read_b64_tr_b16 v[72:73], v16 offset:28672
    ds_read_b64_tr_b16 v[74:75], v16 offset:29184
    s_waitcnt lgkmcnt(4)
    v_mfma_f32_32x32x16_bf16 v[96:111], v[88:91], v[80:83], v[96:111]
    v_mfma_f32_32x32x16_bf16 v[112:127], v[88:91], v[84:87], v[112:127]
    ds_read_b128 v[80:83], v27 offset:24576
    ds_read_b128 v[84:87], v27 offset:28672
    ds_read_b64_tr_b16 v[88:89], v16 offset:30720
    ds_read_b64_tr_b16 v[90:91], v16 offset:31232
    s_waitcnt lgkmcnt(4)
    v_mfma_f32_32x32x16_bf16 v[96:111], v[72:75], v[64:67], v[96:111]
    v_mfma_f32_32x32x16_bf16 v[112:127], v[72:75], v[68:71], v[112:127]
    s_waitcnt lgkmcnt(0)
    v_mfma_f32_32x32x16_bf16 v[96:111], v[88:91], v[80:83], v[96:111]
    v_mfma_f32_32x32x16_bf16 v[112:127], v[88:91], v[84:87], v[112:127]
    s_waitcnt vmcnt(6)
    s_barrier
    s_add_u32 m0, s41, 24576
    s_mov_b32 s35, 3200
    buffer_load_dwordx4 v3, s[16:19], s35 offen lds
    s_add_u32 m0, s41, 25600
    s_mov_b32 s35, 30848
    buffer_load_dwordx4 v3, s[16:19], s35 offen lds
    s_add_u32 m0, s41, 26624
    s_mov_b32 s35, 58496
    buffer_load_dwordx4 v3, s[16:19], s35 offen lds
    s_add_u32 m0, s41, 27648
    s_mov_b32 s35, 86144
    buffer_load_dwordx4 v3, s[16:19], s35 offen lds
    s_add_u32 m0, s42, 24576
    s_mov_b32 s35, 2048000
    buffer_load_dwordx4 v7, s[20:23], s35 offen lds
    s_add_u32 m0, s42, 25600
    s_mov_b32 s35, 2058240
    buffer_load_dwordx4 v7, s[20:23], s35 offen lds
    ds_read_b128 v[64:67], v24 offset:49152
    ds_read_b128 v[68:71], v24 offset:53248
    ds_read_b64_tr_b16 v[72:73], v16 offset:49152
    ds_read_b64_tr_b16 v[74:75], v16 offset:49664
    ds_read_b128 v[80:83], v25 offset:49152
    ds_read_b128 v[84:87], v25 offset:53248
    ds_read_b64_tr_b16 v[88:89], v16 offset:51200
    ds_read_b64_tr_b16 v[90:91], v16 offset:51712
    s_waitcnt lgkmcnt(4)
    v_mfma_f32_32x32x16_bf16 v[96:111], v[72:75], v[64:67], v[96:111]
    v_mfma_f32_32x32x16_bf16 v[112:127], v[72:75], v[68:71], v[112:127]
    ds_read_b128 v[64:67], v26 offset:49152
    ds_read_b128 v[68:71], v26 offset:53248
    ds_read_b64_tr_b16 v[72:73], v16 offset:53248
    ds_read_b64_tr_b16 v[74:75], v16 offset:53760
    s_waitcnt lgkmcnt(4)
    v_mfma_f32_32x32x16_bf16 v[96:111], v[88:91], v[80:83], v[96:111]
    v_mfma_f32_32x32x16_bf16 v[112:127], v[88:91], v[84:87], v[112:127]
    ds_read_b128 v[80:83], v27 offset:49152
    ds_read_b128 v[84:87], v27 offset:53248
    ds_read_b64_tr_b16 v[88:89], v16 offset:55296
    ds_read_b64_tr_b16 v[90:91], v16 offset:55808
    s_waitcnt lgkmcnt(4)
    v_mfma_f32_32x32x16_bf16 v[96:111], v[72:75], v[64:67], v[96:111]
    v_mfma_f32_32x32x16_bf16 v[112:127], v[72:75], v[68:71], v[112:127]
    s_waitcnt lgkmcnt(0)
    v_mfma_f32_32x32x16_bf16 v[96:111], v[88:91], v[80:83], v[96:111]
    v_mfma_f32_32x32x16_bf16 v[112:127], v[88:91], v[84:87], v[112:127]
    s_waitcnt vmcnt(6)
    s_barrier
    s_add_u32 m0, s41, 49152
    s_mov_b32 s35, 3328
    buffer_load_dwordx4 v3, s[16:19], s35 offen lds
    s_add_u32 m0, s41, 50176
    s_mov_b32 s35, 30976
    buffer_load_dwordx4 v3, s[16:19], s35 offen lds
    s_add_u32 m0, s41, 51200
    s_mov_b32 s35, 58624
    buffer_load_dwordx4 v3, s[16:19], s35 offen lds
    s_add_u32 m0, s41, 52224
    s_mov_b32 s35, 86272
    buffer_load_dwordx4 v3, s[16:19], s35 offen lds
    s_add_u32 m0, s42, 49152
    s_mov_b32 s35, 2129920
    buffer_load_dwordx4 v7, s[20:23], s35 offen lds
    s_add_u32 m0, s42, 50176
    s_mov_b32 s35, 2140160
    buffer_load_dwordx4 v7, s[20:23], s35 offen lds
    ds_read_b128 v[64:67], v24 offset:0
    ds_read_b128 v[68:71], v24 offset:4096
    ds_read_b64_tr_b16 v[72:73], v16 offset:0
    ds_read_b64_tr_b16 v[74:75], v16 offset:512
    ds_read_b128 v[80:83], v25 offset:0
    ds_read_b128 v[84:87], v25 offset:4096
    ds_read_b64_tr_b16 v[88:89], v16 offset:2048
    ds_read_b64_tr_b16 v[90:91], v16 offset:2560
    s_waitcnt lgkmcnt(4)
    v_mfma_f32_32x32x16_bf16 v[96:111], v[72:75], v[64:67], v[96:111]
    v_mfma_f32_32x32x16_bf16 v[112:127], v[72:75], v[68:71], v[112:127]
    ds_read_b128 v[64:67], v26 offset:0
    ds_read_b128 v[68:71], v26 offset:4096
    ds_read_b64_tr_b16 v[72:73], v16 offset:4096
    ds_read_b64_tr_b16 v[74:75], v16 offset:4608
    s_waitcnt lgkmcnt(4)
    v_mfma_f32_32x32x16_bf16 v[96:111], v[88:91], v[80:83], v[96:111]
    v_mfma_f32_32x32x16_bf16 v[112:127], v[88:91], v[84:87], v[112:127]
    ds_read_b128 v[80:83], v27 offset:0
    ds_read_b128 v[84:87], v27 offset:4096
    ds_read_b64_tr_b16 v[88:89], v16 offset:6144
    ds_read_b64_tr_b16 v[90:91], v16 offset:6656
    s_waitcnt lgkmcnt(4)
    v_mfma_f32_32x32x16_bf16 v[96:111], v[72:75], v[64:67], v[96:111]
    v_mfma_f32_32x32x16_bf16 v[112:127], v[72:75], v[68:71], v[112:127]
    s_waitcnt lgkmcnt(0)
    v_mfma_f32_32x32x16_bf16 v[96:111], v[88:91], v[80:83], v[96:111]
    v_mfma_f32_32x32x16_bf16 v[112:127], v[88:91], v[84:87], v[112:127]
    s_waitcnt vmcnt(6)
    s_barrier
    ds_read_b128 v[64:67], v24 offset:24576
    ds_read_b128 v[68:71], v24 offset:28672
    ds_read_b64_tr_b16 v[72:73], v16 offset:24576
    ds_read_b64_tr_b16 v[74:75], v16 offset:25088
    ds_read_b128 v[80:83], v25 offset:24576
    ds_read_b128 v[84:87], v25 offset:28672
    ds_read_b64_tr_b16 v[88:89], v16 offset:26624
    ds_read_b64_tr_b16 v[90:91], v16 offset:27136
    s_waitcnt lgkmcnt(4)
    v_mfma_f32_32x32x16_bf16 v[96:111], v[72:75], v[64:67], v[96:111]
    v_mfma_f32_32x32x16_bf16 v[112:127], v[72:75], v[68:71], v[112:127]
    ds_read_b128 v[64:67], v26 offset:24576
    ds_read_b128 v[68:71], v26 offset:28672
    ds_read_b64_tr_b16 v[72:73], v16 offset:28672
    ds_read_b64_tr_b16 v[74:75], v16 offset:29184
    s_waitcnt lgkmcnt(4)
    v_mfma_f32_32x32x16_bf16 v[96:111], v[88:91], v[80:83], v[96:111]
    v_mfma_f32_32x32x16_bf16 v[112:127], v[88:91], v[84:87], v[112:127]
    ds_read_b128 v[80:83], v27 offset:24576
    ds_read_b128 v[84:87], v27 offset:28672
    ds_read_b64_tr_b16 v[88:89], v16 offset:30720
    ds_read_b64_tr_b16 v[90:91], v16 offset:31232
    s_waitcnt lgkmcnt(4)
    v_mfma_f32_32x32x16_bf16 v[96:111], v[72:75], v[64:67], v[96:111]
    v_mfma_f32_32x32x16_bf16 v[112:127], v[72:75], v[68:71], v[112:127]
    s_waitcnt lgkmcnt(0)
    v_mfma_f32_32x32x16_bf16 v[96:111], v[88:91], v[80:83], v[96:111]
    v_mfma_f32_32x32x16_bf16 v[112:127], v[88:91], v[84:87], v[112:127]
    s_waitcnt vmcnt(0)
    s_barrier
    ds_read_b128 v[64:67], v24 offset:49152
    ds_read_b128 v[68:71], v24 offset:53248
    ds_read_b64_tr_b16 v[72:73], v16 offset:49152
    ds_read_b64_tr_b16 v[74:75], v16 offset:49664
    ds_read_b128 v[80:83], v25 offset:49152
    ds_read_b128 v[84:87], v25 offset:53248
    ds_read_b64_tr_b16 v[88:89], v16 offset:51200
    ds_read_b64_tr_b16 v[90:91], v16 offset:51712
    s_waitcnt lgkmcnt(4)
    v_mfma_f32_32x32x16_bf16 v[96:111], v[72:75], v[64:67], v[96:111]
    v_mfma_f32_32x32x16_bf16 v[112:127], v[72:75], v[68:71], v[112:127]
    ds_read_b128 v[64:67], v26 offset:49152
    ds_read_b128 v[68:71], v26 offset:53248
    ds_read_b64_tr_b16 v[72:73], v16 offset:53248
    ds_read_b64_tr_b16 v[74:75], v16 offset:53760
    s_waitcnt lgkmcnt(4)
    v_mfma_f32_32x32x16_bf16 v[96:111], v[88:91], v[80:83], v[96:111]
    v_mfma_f32_32x32x16_bf16 v[112:127], v[88:91], v[84:87], v[112:127]
    ds_read_b128 v[80:83], v27 offset:49152
    ds_read_b128 v[84:87], v27 offset:53248
    ds_read_b64_tr_b16 v[88:89], v16 offset:55296
    ds_read_b64_tr_b16 v[90:91], v16 offset:55808
    s_waitcnt lgkmcnt(4)
    v_mfma_f32_32x32x16_bf16 v[96:111], v[72:75], v[64:67], v[96:111]
    v_mfma_f32_32x32x16_bf16 v[112:127], v[72:75], v[68:71], v[112:127]
    s_waitcnt lgkmcnt(0)
    v_mfma_f32_32x32x16_bf16 v[96:111], v[88:91], v[80:83], v[96:111]
    v_mfma_f32_32x32x16_bf16 v[112:127], v[88:91], v[84:87], v[112:127]
    s_nop 15
    s_nop 3
    s_lshl_b32 s32, s14, 7
    v_lshl_add_u32 v1, v11, 6, v13
    v_add_u32 v1, s32, v1
    s_movk_i32 s33, 1280
    v_mul_lo_u32 v1, v1, s33
    s_lshl_b32 s32, s15, 7
    v_add_u32 v1, s32, v1
    v_lshl_add_u32 v1, v12, 6, v1
    v_lshl_add_u32 v1, v14, 3, v1
    s_mov_b32 s35, 0
    buffer_load_dwordx2 v[32:33], v1, s[24:27], s35 offen offset:0
    buffer_load_dwordx2 v[34:35], v1, s[24:27], s35 offen offset:16
    buffer_load_dwordx2 v[36:37], v1, s[24:27], s35 offen offset:32
    buffer_load_dwordx2 v[38:39], v1, s[24:27], s35 offen offset:48
    s_waitcnt vmcnt(0)
    v_cvt_pk_bf16_f32 v20, v96, v97
    v_lshlrev_b32 v96, 16, v20
    v_and_b32 v97, 0xffff0000, v20
    v_lshlrev_b32 v21, 16, v32
    v_and_b32 v22, 0xffff0000, v32
    v_add_f32 v96, v96, v21
    v_add_f32 v97, v97, v22
    v_cvt_pk_bf16_f32 v24, v96, v97
    v_cvt_pk_bf16_f32 v20, v98, v99
    v_lshlrev_b32 v98, 16, v20
    v_and_b32 v99, 0xffff0000, v20
    v_lshlrev_b32 v21, 16, v33
    v_and_b32 v22, 0xffff0000, v33
    v_add_f32 v98, v98, v21
    v_add_f32 v99, v99, v22
    v_cvt_pk_bf16_f32 v25, v98, v99
    buffer_store_dwordx2 v[24:25], v1, s[28:31], s35 offen offset:0
    s_nop 1
    v_cvt_pk_bf16_f32 v20, v100, v101
    v_lshlrev_b32 v100, 16, v20
    v_and_b32 v101, 0xffff0000, v20
    v_lshlrev_b32 v21, 16, v34
    v_and_b32 v22, 0xffff0000, v34
    v_add_f32 v100, v100, v21
    v_add_f32 v101, v101, v22
    v_cvt_pk_bf16_f32 v24, v100, v101
    v_cvt_pk_bf16_f32 v20, v102, v103
    v_lshlrev_b32 v102, 16, v20
    v_and_b32 v103, 0xffff0000, v20
    v_lshlrev_b32 v21, 16, v35
    v_and_b32 v22, 0xffff0000, v35
    v_add_f32 v102, v102, v21
    v_add_f32 v103, v103, v22
    v_cvt_pk_bf16_f32 v25, v102, v103
    buffer_store_dwordx2 v[24:25], v1, s[28:31], s35 offen offset:16
    s_nop 1
    v_cvt_pk_bf16_f32 v20, v104, v105
    v_lshlrev_b32 v104, 16, v20
    v_and_b32 v105, 0xffff0000, v20
    v_lshlrev_b32 v21, 16, v36
    v_and_b32 v22, 0xffff0000, v36
    v_add_f32 v104, v104, v21
    v_add_f32 v105, v105, v22
    v_cvt_pk_bf16_f32 v24, v104, v105
    v_cvt_pk_bf16_f32 v20, v106, v107
    v_lshlrev_b32 v106, 16, v20
    v_and_b32 v107, 0xffff0000, v20
    v_lshlrev_b32 v21, 16, v37
    v_and_b32 v22, 0xffff0000, v37
    v_add_f32 v106, v106, v21
    v_add_f32 v107, v107, v22
    v_cvt_pk_bf16_f32 v25, v106, v107
    buffer_store_dwordx2 v[24:25], v1, s[28:31], s35 offen offset:32
    s_nop 1
    v_cvt_pk_bf16_f32 v20, v108, v109
    v_lshlrev_b32 v108, 16, v20
    v_and_b32 v109, 0xffff0000, v20
    v_lshlrev_b32 v21, 16, v38
    v_and_b32 v22, 0xffff0000, v38
    v_add_f32 v108, v108, v21
    v_add_f32 v109, v109, v22
    v_cvt_pk_bf16_f32 v24, v108, v109
    v_cvt_pk_bf16_f32 v20, v110, v111
    v_lshlrev_b32 v110, 16, v20
    v_and_b32 v111, 0xffff0000, v20
    v_lshlrev_b32 v21, 16, v39
    v_and_b32 v22, 0xffff0000, v39
    v_add_f32 v110, v110, v21
    v_add_f32 v111, v111, v22
    v_cvt_pk_bf16_f32 v25, v110, v111
    buffer_store_dwordx2 v[24:25], v1, s[28:31], s35 offen offset:48
    s_nop 1
    s_mov_b32 s35, 40960
    buffer_load_dwordx2 v[32:33], v1, s[24:27], s35 offen offset:0
    buffer_load_dwordx2 v[34:35], v1, s[24:27], s35 offen offset:16
    buffer_load_dwordx2 v[36:37], v1, s[24:27], s35 offen offset:32
    buffer_load_dwordx2 v[38:39], v1, s[24:27], s35 offen offset:48
    s_waitcnt vmcnt(0)
    v_cvt_pk_bf16_f32 v20, v112, v113
    v_lshlrev_b32 v112, 16, v20
    v_and_b32 v113, 0xffff0000, v20
    v_lshlrev_b32 v21, 16, v32
    v_and_b32 v22, 0xffff0000, v32
    v_add_f32 v112, v112, v21
    v_add_f32 v113, v113, v22
    v_cvt_pk_bf16_f32 v24, v112, v113
    v_cvt_pk_bf16_f32 v20, v114, v115
    v_lshlrev_b32 v114, 16, v20
    v_and_b32 v115, 0xffff0000, v20
    v_lshlrev_b32 v21, 16, v33
    v_and_b32 v22, 0xffff0000, v33
    v_add_f32 v114, v114, v21
    v_add_f32 v115, v115, v22
    v_cvt_pk_bf16_f32 v25, v114, v115
    buffer_store_dwordx2 v[24:25], v1, s[28:31], s35 offen offset:0
    s_nop 1
    v_cvt_pk_bf16_f32 v20, v116, v117
    v_lshlrev_b32 v116, 16, v20
    v_and_b32 v117, 0xffff0000, v20
    v_lshlrev_b32 v21, 16, v34
    v_and_b32 v22, 0xffff0000, v34
    v_add_f32 v116, v116, v21
    v_add_f32 v117, v117, v22
    v_cvt_pk_bf16_f32 v24, v116, v117
    v_cvt_pk_bf16_f32 v20, v118, v119
    v_lshlrev_b32 v118, 16, v20
    v_and_b32 v119, 0xffff0000, v20
    v_lshlrev_b32 v21, 16, v35
    v_and_b32 v22, 0xffff0000, v35
    v_add_f32 v118, v118, v21
    v_add_f32 v119, v119, v22
    v_cvt_pk_bf16_f32 v25, v118, v119
    buffer_store_dwordx2 v[24:25], v1, s[28:31], s35 offen offset:16
    s_nop 1
    v_cvt_pk_bf16_f32 v20, v120, v121
    v_lshlrev_b32 v120, 16, v20
    v_and_b32 v121, 0xffff0000, v20
    v_lshlrev_b32 v21, 16, v36
    v_and_b32 v22, 0xffff0000, v36
    v_add_f32 v120, v120, v21
    v_add_f32 v121, v121, v22
    v_cvt_pk_bf16_f32 v24, v120, v121
    v_cvt_pk_bf16_f32 v20, v122, v123
    v_lshlrev_b32 v122, 16, v20
    v_and_b32 v123, 0xffff0000, v20
    v_lshlrev_b32 v21, 16, v37
    v_and_b32 v22, 0xffff0000, v37
    v_add_f32 v122, v122, v21
    v_add_f32 v123, v123, v22
    v_cvt_pk_bf16_f32 v25, v122, v123
    buffer_store_dwordx2 v[24:25], v1, s[28:31], s35 offen offset:32
    s_nop 1
    v_cvt_pk_bf16_f32 v20, v124, v125
    v_lshlrev_b32 v124, 16, v20
    v_and_b32 v125, 0xffff0000, v20
    v_lshlrev_b32 v21, 16, v38
    v_and_b32 v22, 0xffff0000, v38
    v_add_f32 v124, v124, v21
    v_add_f32 v125, v125, v22
    v_cvt_pk_bf16_f32 v24, v124, v125
    v_cvt_pk_bf16_f32 v20, v126, v127
    v_lshlrev_b32 v126, 16, v20
    v_and_b32 v127, 0xffff0000, v20
    v_lshlrev_b32 v21, 16, v39
    v_and_b32 v22, 0xffff0000, v39
    v_add_f32 v126, v126, v21
    v_add_f32 v127, v127, v22
    v_cvt_pk_bf16_f32 v25, v126, v127
    buffer_store_dwordx2 v[24:25], v1, s[28:31], s35 offen offset:48
    s_nop 1
GEMM_END_g2a_kernel:
    s_endpgm
.globl g2b_kernel
.p2align 8
.type g2b_kernel,@function
g2b_kernel:
    s_cmp_ge_u32 s2, 160
    s_cbranch_scc1 GEMM_END_g2b_kernel
    s_load_dwordx4 s[4:7], s[0:1], 56
    s_load_dwordx4 s[8:11], s[0:1], 72
    s_load_dwordx2 s[12:13], s[0:1], 96
    s_and_b32 s14, s2, 15
    s_lshr_b32 s15, s2, 4
    s_waitcnt lgkmcnt(0)
    s_add_u32 s16, s12, 10485760
    s_addc_u32 s17, s13, 0
    s_mov_b32 s18, 7077888
    s_mov_b32 s19, 0x00020000
    s_mov_b32 s20, s8
    s_mov_b32 s21, s9
    s_mov_b32 s22, 2211840
    s_mov_b32 s23, 0x00020000
    s_add_u32 s24, s12, 2621440
    s_addc_u32 s25, s13, 0
    s_mov_b32 s26, 2621440
    s_mov_b32 s27, 0x00020000
    s_mov_b32 s28, s10
    s_mov_b32 s29, s11
    s_mov_b32 s30, 2621440
    s_mov_b32 s31, 0x00020000
    v_lshrrev_b32 v18, 6, v0
    s_nop 0
    v_readfirstlane_b32 s40, v18
    v_and_b32 v19, 63, v0
    v_lshrrev_b32 v1, 3, v19
    v_and_b32 v2, 7, v0
    v_xor_b32 v4, v2, v1
    v_lshlrev_b32 v4, 4, v4
    s_lshl_b32 s32, s14, 7
    v_lshl_add_u32 v3, v18, 5, v1
    v_add_u32 v3, s32, v3
    s_movk_i32 s33, 3456
    v_mul_lo_u32 v3, v3, s33
    v_add_u32 v3, v3, v4
    v_bfe_u32 v4, v1, 1, 1
    v_lshlrev_b32 v4, 2, v4
    v_xor_b32 v4, v2, v4
    v_lshlrev_b32 v4, 4, v4
    v_lshl_add_u32 v7, v18, 4, v1
    s_movk_i32 s33, 1280
    v_mul_lo_u32 v7, v7, s33
    v_add_u32 v7, v7, v4
    s_lshl_b32 s32, s15, 7
    v_add_u32 v7, s32, v7
    s_lshl_b32 s41, s40, 12
    s_lshl_b32 s42, s40, 11
    s_add_u32 s42, s42, 16384
    v_lshrrev_b32 v11, 6, v0
    v_and_b32 v12, 1, v11
    v_lshrrev_b32 v11, 1, v11
    v_and_b32 v13, 31, v0
    v_bfe_u32 v14, v0, 5, 1
    v_lshl_add_u32 v15, v11, 6, v13
    v_and_b32 v17, 7, v15
    v_lshlrev_b32 v15, 7, v15
    v_add_u32 v18, 0, v14
    v_xor_b32 v18, v18, v17
    v_lshl_add_u32 v24, v18, 4, v15
    v_add_u32 v18, 2, v14
    v_xor_b32 v18, v18, v17
    v_lshl_add_u32 v25, v18, 4, v15
    v_add_u32 v18, 4, v14
    v_xor_b32 v18, v18, v17
    v_lshl_add_u32 v26, v18, 4, v15
    v_add_u32 v18, 6, v14
    v_xor_b32 v18, v18, v17
    v_lshl_add_u32 v27, v18, 4, v15
    v_bfe_u32 v16, v0, 2, 2
    v_lshl_add_u32 v16, v14, 3, v16
    v_lshlrev_b32 v16, 7, v16
    v_lshlrev_b32 v17, 6, v12
    v_add_u32 v16, v16, v17
    v_bfe_u32 v17, v0, 4, 1
    v_lshl_add_u32 v16, v17, 5, v16
    v_and_b32 v17, 3, v0
    v_lshl_add_u32 v16, v17, 3, v16
    v_add_u32 v16, 16384, v16
    v_bfe_u32 v17, v0, 3, 1
    v_lshlrev_b32 v17, 6, v17
    v_xor_b32 v16, v16, v17
    v_mov_b32 v96, 0
    v_mov_b32 v97, 0
    v_mov_b32 v98, 0
    v_mov_b32 v99, 0
    v_mov_b32 v100, 0
    v_mov_b32 v101, 0
    v_mov_b32 v102, 0
    v_mov_b32 v103, 0
    v_mov_b32 v104, 0
    v_mov_b32 v105, 0
    v_mov_b32 v106, 0
    v_mov_b32 v107, 0
    v_mov_b32 v108, 0
    v_mov_b32 v109, 0
    v_mov_b32 v110, 0
    v_mov_b32 v111, 0
    v_mov_b32 v112, 0
    v_mov_b32 v113, 0
    v_mov_b32 v114, 0
    v_mov_b32 v115, 0
    v_mov_b32 v116, 0
    v_mov_b32 v117, 0
    v_mov_b32 v118, 0
    v_mov_b32 v119, 0
    v_mov_b32 v120, 0
    v_mov_b32 v121, 0
    v_mov_b32 v122, 0
    v_mov_b32 v123, 0
    v_mov_b32 v124, 0
    v_mov_b32 v125, 0
    v_mov_b32 v126, 0
    v_mov_b32 v127, 0
    s_mov_b32 s34, 0
    s_add_u32 m0, s41, 0
    s_mov_b32 s35, 0
    buffer_load_dwordx4 v3, s[16:19], s35 offen lds
    s_add_u32 m0, s41, 1024
    s_mov_b32 s35, 27648
    buffer_load_dwordx4 v3, s[16:19], s35 offen lds
    s_add_u32 m0, s41, 2048
    s_mov_b32 s35, 55296
    buffer_load_dwordx4 v3, s[16:19], s35 offen lds
    s_add_u32 m0, s41, 3072
    s_mov_b32 s35, 82944
    buffer_load_dwordx4 v3, s[16:19], s35 offen lds
    s_add_u32 m0, s42, 0
    s_mov_b32 s35, 0
    buffer_load_dwordx4 v7, s[20:23], s35 offen lds
    s_add_u32 m0, s42, 1024
    s_mov_b32 s35, 10240
    buffer_load_dwordx4 v7, s[20:23], s35 offen lds
    s_add_u32 m0, s41, 24576
    s_mov_b32 s35, 128
    buffer_load_dwordx4 v3, s[16:19], s35 offen lds
    s_add_u32 m0, s41, 25600
    s_mov_b32 s35, 27776
    buffer_load_dwordx4 v3, s[16:19], s35 offen lds
    s_add_u32 m0, s41, 26624
    s_mov_b32 s35, 55424
    buffer_load_dwordx4 v3, s[16:19], s35 offen lds
    s_add_u32 m0, s41, 27648
    s_mov_b32 s35, 83072
    buffer_load_dwordx4 v3, s[16:19], s35 offen lds
    s_add_u32 m0, s42, 24576
    s_mov_b32 s35, 81920
    buffer_load_dwordx4 v7, s[20:23], s35 offen lds
    s_add_u32 m0, s42, 25600
    s_mov_b32 s35, 92160
    buffer_load_dwordx4 v7, s[20:23], s35 offen lds
    s_waitcnt vmcnt(6)
    s_barrier
    s_add_u32 m0, s41, 49152
    s_mov_b32 s35, 256
    buffer_load_dwordx4 v3, s[16:19], s35 offen lds
    s_add_u32 m0, s41, 50176
    s_mov_b32 s35, 27904
    buffer_load_dwordx4 v3, s[16:19], s35 offen lds
    s_add_u32 m0, s41, 51200
    s_mov_b32 s35, 55552
    buffer_load_dwordx4 v3, s[16:19], s35 offen lds
    s_add_u32 m0, s41, 52224
    s_mov_b32 s35, 83200
    buffer_load_dwordx4 v3, s[16:19], s35 offen lds
    s_add_u32 m0, s42, 49152
    s_mov_b32 s35, 163840
    buffer_load_dwordx4 v7, s[20:23], s35 offen lds
    s_add_u32 m0, s42, 50176
    s_mov_b32 s35, 174080
    buffer_load_dwordx4 v7, s[20:23], s35 offen lds
    ds_read_b128 v[64:67], v24 offset:0
    ds_read_b128 v[68:71], v24 offset:4096
    ds_read_b64_tr_b16 v[72:73], v16 offset:0
    ds_read_b64_tr_b16 v[74:75], v16 offset:512
    ds_read_b128 v[80:83], v25 offset:0
    ds_read_b128 v[84:87], v25 offset:4096
    ds_read_b64_tr_b16 v[88:89], v16 offset:2048
    ds_read_b64_tr_b16 v[90:91], v16 offset:2560
    s_waitcnt lgkmcnt(4)
    v_mfma_f32_32x32x16_bf16 v[96:111], v[72:75], v[64:67], v[96:111]
    v_mfma_f32_32x32x16_bf16 v[112:127], v[72:75], v[68:71], v[112:127]
    ds_read_b128 v[64:67], v26 offset:0
    ds_read_b128 v[68:71], v26 offset:4096
    ds_read_b64_tr_b16 v[72:73], v16 offset:4096
    ds_read_b64_tr_b16 v[74:75], v16 offset:4608
    s_waitcnt lgkmcnt(4)
    v_mfma_f32_32x32x16_bf16 v[96:111], v[88:91], v[80:83], v[96:111]
    v_mfma_f32_32x32x16_bf16 v[112:127], v[88:91], v[84:87], v[112:127]
    ds_read_b128 v[80:83], v27 offset:0
    ds_read_b128 v[84:87], v27 offset:4096
    ds_read_b64_tr_b16 v[88:89], v16 offset:6144
    ds_read_b64_tr_b16 v[90:91], v16 offset:6656
    s_waitcnt lgkmcnt(4)
    v_mfma_f32_32x32x16_bf16 v[96:111], v[72:75], v[64:67], v[96:111]
    v_mfma_f32_32x32x16_bf16 v[112:127], v[72:75], v[68:71], v[112:127]
    s_waitcnt lgkmcnt(0)
    v_mfma_f32_32x32x16_bf16 v[96:111], v[88:91], v[80:83], v[96:111]
    v_mfma_f32_32x32x16_bf16 v[112:127], v[88:91], v[84:87], v[112:127]
    s_waitcnt vmcnt(6)
    s_barrier
    s_add_u32 m0, s41, 0
    s_mov_b32 s35, 384
    buffer_load_dwordx4 v3, s[16:19], s35 offen lds
    s_add_u32 m0, s41, 1024
    s_mov_b32 s35, 28032
    buffer_load_dwordx4 v3, s[16:19], s35 offen lds
    s_add_u32 m0, s41, 2048
    s_mov_b32 s35, 55680
    buffer_load_dwordx4 v3, s[16:19], s35 offen lds
    s_add_u32 m0, s41, 3072
    s_mov_b32 s35, 83328
    buffer_load_dwordx4 v3, s[16:19], s35 offen lds
    s_add_u32 m0, s42, 0
    s_mov_b32 s35, 245760
    buffer_load_dwordx4 v7, s[20:23], s35 offen lds
    s_add_u32 m0, s42, 1024
    s_mov_b32 s35, 256000
    buffer_load_dwordx4 v7, s[20:23], s35 offen lds
    ds_read_b128 v[64:67], v24 offset:24576
    ds_read_b128 v[68:71], v24 offset:28672
    ds_read_b64_tr_b16 v[72:73], v16 offset:24576
    ds_read_b64_tr_b16 v[74:75], v16 offset:25088
    ds_read_b128 v[80:83], v25 offset:24576
    ds_read_b128 v[84:87], v25 offset:28672
    ds_read_b64_tr_b16 v[88:89], v16 offset:26624
    ds_read_b64_tr_b16 v[90:91], v16 offset:27136
    s_waitcnt lgkmcnt(4)
    v_mfma_f32_32x32x16_bf16 v[96:111], v[72:75], v[64:67], v[96:111]
    v_mfma_f32_32x32x16_bf16 v[112:127], v[72:75], v[68:71], v[112:127]
    ds_read_b128 v[64:67], v26 offset:24576
    ds_read_b128 v[68:71], v26 offset:28672
    ds_read_b64_tr_b16 v[72:73], v16 offset:28672
    ds_read_b64_tr_b16 v[74:75], v16 offset:29184
    s_waitcnt lgkmcnt(4)
    v_mfma_f32_32x32x16_bf16 v[96:111], v[88:91], v[80:83], v[96:111]
    v_mfma_f32_32x32x16_bf16 v[112:127], v[88:91], v[84:87], v[112:127]
    ds_read_b128 v[80:83], v27 offset:24576
    ds_read_b128 v[84:87], v27 offset:28672
    ds_read_b64_tr_b16 v[88:89], v16 offset:30720
    ds_read_b64_tr_b16 v[90:91], v16 offset:31232
    s_waitcnt lgkmcnt(4)
    v_mfma_f32_32x32x16_bf16 v[96:111], v[72:75], v[64:67], v[96:111]
    v_mfma_f32_32x32x16_bf16 v[112:127], v[72:75], v[68:71], v[112:127]
    s_waitcnt lgkmcnt(0)
    v_mfma_f32_32x32x16_bf16 v[96:111], v[88:91], v[80:83], v[96:111]
    v_mfma_f32_32x32x16_bf16 v[112:127], v[88:91], v[84:87], v[112:127]
    s_waitcnt vmcnt(6)
    s_barrier
    s_add_u32 m0, s41, 24576
    s_mov_b32 s35, 512
    buffer_load_dwordx4 v3, s[16:19], s35 offen lds
    s_add_u32 m0, s41, 25600
    s_mov_b32 s35, 28160
    buffer_load_dwordx4 v3, s[16:19], s35 offen lds
    s_add_u32 m0, s41, 26624
    s_mov_b32 s35, 55808
    buffer_load_dwordx4 v3, s[16:19], s35 offen lds
    s_add_u32 m0, s41, 27648
    s_mov_b32 s35, 83456
    buffer_load_dwordx4 v3, s[16:19], s35 offen lds
    s_add_u32 m0, s42, 24576
    s_mov_b32 s35, 327680
    buffer_load_dwordx4 v7, s[20:23], s35 offen lds
    s_add_u32 m0, s42, 25600
    s_mov_b32 s35, 337920
    buffer_load_dwordx4 v7, s[20:23], s35 offen lds
    ds_read_b128 v[64:67], v24 offset:49152
    ds_read_b128 v[68:71], v24 offset:53248
    ds_read_b64_tr_b16 v[72:73], v16 offset:49152
    ds_read_b64_tr_b16 v[74:75], v16 offset:49664
    ds_read_b128 v[80:83], v25 offset:49152
    ds_read_b128 v[84:87], v25 offset:53248
    ds_read_b64_tr_b16 v[88:89], v16 offset:51200
    ds_read_b64_tr_b16 v[90:91], v16 offset:51712
    s_waitcnt lgkmcnt(4)
    v_mfma_f32_32x32x16_bf16 v[96:111], v[72:75], v[64:67], v[96:111]
    v_mfma_f32_32x32x16_bf16 v[112:127], v[72:75], v[68:71], v[112:127]
    ds_read_b128 v[64:67], v26 offset:49152
    ds_read_b128 v[68:71], v26 offset:53248
    ds_read_b64_tr_b16 v[72:73], v16 offset:53248
    ds_read_b64_tr_b16 v[74:75], v16 offset:53760
    s_waitcnt lgkmcnt(4)
    v_mfma_f32_32x32x16_bf16 v[96:111], v[88:91], v[80:83], v[96:111]
    v_mfma_f32_32x32x16_bf16 v[112:127], v[88:91], v[84:87], v[112:127]
    ds_read_b128 v[80:83], v27 offset:49152
    ds_read_b128 v[84:87], v27 offset:53248
    ds_read_b64_tr_b16 v[88:89], v16 offset:55296
    ds_read_b64_tr_b16 v[90:91], v16 offset:55808
    s_waitcnt lgkmcnt(4)
    v_mfma_f32_32x32x16_bf16 v[96:111], v[72:75], v[64:67], v[96:111]
    v_mfma_f32_32x32x16_bf16 v[112:127], v[72:75], v[68:71], v[112:127]
    s_waitcnt lgkmcnt(0)
    v_mfma_f32_32x32x16_bf16 v[96:111], v[88:91], v[80:83], v[96:111]
    v_mfma_f32_32x32x16_bf16 v[112:127], v[88:91], v[84:87], v[112:127]
    s_waitcnt vmcnt(6)
    s_barrier
    s_add_u32 m0, s41, 49152
    s_mov_b32 s35, 640
    buffer_load_dwordx4 v3, s[16:19], s35 offen lds
    s_add_u32 m0, s41, 50176
    s_mov_b32 s35, 28288
    buffer_load_dwordx4 v3, s[16:19], s35 offen lds
    s_add_u32 m0, s41, 51200
    s_mov_b32 s35, 55936
    buffer_load_dwordx4 v3, s[16:19], s35 offen lds
    s_add_u32 m0, s41, 52224
    s_mov_b32 s35, 83584
    buffer_load_dwordx4 v3, s[16:19], s35 offen lds
    s_add_u32 m0, s42, 49152
    s_mov_b32 s35, 409600
    buffer_load_dwordx4 v7, s[20:23], s35 offen lds
    s_add_u32 m0, s42, 50176
    s_mov_b32 s35, 419840
    buffer_load_dwordx4 v7, s[20:23], s35 offen lds
    ds_read_b128 v[64:67], v24 offset:0
    ds_read_b128 v[68:71], v24 offset:4096
    ds_read_b64_tr_b16 v[72:73], v16 offset:0
    ds_read_b64_tr_b16 v[74:75], v16 offset:512
    ds_read_b128 v[80:83], v25 offset:0
    ds_read_b128 v[84:87], v25 offset:4096
    ds_read_b64_tr_b16 v[88:89], v16 offset:2048
    ds_read_b64_tr_b16 v[90:91], v16 offset:2560
    s_waitcnt lgkmcnt(4)
    v_mfma_f32_32x32x16_bf16 v[96:111], v[72:75], v[64:67], v[96:111]
    v_mfma_f32_32x32x16_bf16 v[112:127], v[72:75], v[68:71], v[112:127]
    ds_read_b128 v[64:67], v26 offset:0
    ds_read_b128 v[68:71], v26 offset:4096
    ds_read_b64_tr_b16 v[72:73], v16 offset:4096
    ds_read_b64_tr_b16 v[74:75], v16 offset:4608
    s_waitcnt lgkmcnt(4)
    v_mfma_f32_32x32x16_bf16 v[96:111], v[88:91], v[80:83], v[96:111]
    v_mfma_f32_32x32x16_bf16 v[112:127], v[88:91], v[84:87], v[112:127]
    ds_read_b128 v[80:83], v27 offset:0
    ds_read_b128 v[84:87], v27 offset:4096
    ds_read_b64_tr_b16 v[88:89], v16 offset:6144
    ds_read_b64_tr_b16 v[90:91], v16 offset:6656
    s_waitcnt lgkmcnt(4)
    v_mfma_f32_32x32x16_bf16 v[96:111], v[72:75], v[64:67], v[96:111]
    v_mfma_f32_32x32x16_bf16 v[112:127], v[72:75], v[68:71], v[112:127]
    s_waitcnt lgkmcnt(0)
    v_mfma_f32_32x32x16_bf16 v[96:111], v[88:91], v[80:83], v[96:111]
    v_mfma_f32_32x32x16_bf16 v[112:127], v[88:91], v[84:87], v[112:127]
    s_waitcnt vmcnt(6)
    s_barrier
    s_add_u32 m0, s41, 0
    s_mov_b32 s35, 768
    buffer_load_dwordx4 v3, s[16:19], s35 offen lds
    s_add_u32 m0, s41, 1024
    s_mov_b32 s35, 28416
    buffer_load_dwordx4 v3, s[16:19], s35 offen lds
    s_add_u32 m0, s41, 2048
    s_mov_b32 s35, 56064
    buffer_load_dwordx4 v3, s[16:19], s35 offen lds
    s_add_u32 m0, s41, 3072
    s_mov_b32 s35, 83712
    buffer_load_dwordx4 v3, s[16:19], s35 offen lds
    s_add_u32 m0, s42, 0
    s_mov_b32 s35, 491520
    buffer_load_dwordx4 v7, s[20:23], s35 offen lds
    s_add_u32 m0, s42, 1024
    s_mov_b32 s35, 501760
    buffer_load_dwordx4 v7, s[20:23], s35 offen lds
    ds_read_b128 v[64:67], v24 offset:24576
    ds_read_b128 v[68:71], v24 offset:28672
    ds_read_b64_tr_b16 v[72:73], v16 offset:24576
    ds_read_b64_tr_b16 v[74:75], v16 offset:25088
    ds_read_b128 v[80:83], v25 offset:24576
    ds_read_b128 v[84:87], v25 offset:28672
    ds_read_b64_tr_b16 v[88:89], v16 offset:26624
    ds_read_b64_tr_b16 v[90:91], v16 offset:27136
    s_waitcnt lgkmcnt(4)
    v_mfma_f32_32x32x16_bf16 v[96:111], v[72:75], v[64:67], v[96:111]
    v_mfma_f32_32x32x16_bf16 v[112:127], v[72:75], v[68:71], v[112:127]
    ds_read_b128 v[64:67], v26 offset:24576
    ds_read_b128 v[68:71], v26 offset:28672
    ds_read_b64_tr_b16 v[72:73], v16 offset:28672
    ds_read_b64_tr_b16 v[74:75], v16 offset:29184
    s_waitcnt lgkmcnt(4)
    v_mfma_f32_32x32x16_bf16 v[96:111], v[88:91], v[80:83], v[96:111]
    v_mfma_f32_32x32x16_bf16 v[112:127], v[88:91], v[84:87], v[112:127]
    ds_read_b128 v[80:83], v27 offset:24576
    ds_read_b128 v[84:87], v27 offset:28672
    ds_read_b64_tr_b16 v[88:89], v16 offset:30720
    ds_read_b64_tr_b16 v[90:91], v16 offset:31232
    s_waitcnt lgkmcnt(4)
    v_mfma_f32_32x32x16_bf16 v[96:111], v[72:75], v[64:67], v[96:111]
    v_mfma_f32_32x32x16_bf16 v[112:127], v[72:75], v[68:71], v[112:127]
    s_waitcnt lgkmcnt(0)
    v_mfma_f32_32x32x16_bf16 v[96:111], v[88:91], v[80:83], v[96:111]
    v_mfma_f32_32x32x16_bf16 v[112:127], v[88:91], v[84:87], v[112:127]
    s_waitcnt vmcnt(6)
    s_barrier
    s_add_u32 m0, s41, 24576
    s_mov_b32 s35, 896
    buffer_load_dwordx4 v3, s[16:19], s35 offen lds
    s_add_u32 m0, s41, 25600
    s_mov_b32 s35, 28544
    buffer_load_dwordx4 v3, s[16:19], s35 offen lds
    s_add_u32 m0, s41, 26624
    s_mov_b32 s35, 56192
    buffer_load_dwordx4 v3, s[16:19], s35 offen lds
    s_add_u32 m0, s41, 27648
    s_mov_b32 s35, 83840
    buffer_load_dwordx4 v3, s[16:19], s35 offen lds
    s_add_u32 m0, s42, 24576
    s_mov_b32 s35, 573440
    buffer_load_dwordx4 v7, s[20:23], s35 offen lds
    s_add_u32 m0, s42, 25600
    s_mov_b32 s35, 583680
    buffer_load_dwordx4 v7, s[20:23], s35 offen lds
    ds_read_b128 v[64:67], v24 offset:49152
    ds_read_b128 v[68:71], v24 offset:53248
    ds_read_b64_tr_b16 v[72:73], v16 offset:49152
    ds_read_b64_tr_b16 v[74:75], v16 offset:49664
    ds_read_b128 v[80:83], v25 offset:49152
    ds_read_b128 v[84:87], v25 offset:53248
    ds_read_b64_tr_b16 v[88:89], v16 offset:51200
    ds_read_b64_tr_b16 v[90:91], v16 offset:51712
    s_waitcnt lgkmcnt(4)
    v_mfma_f32_32x32x16_bf16 v[96:111], v[72:75], v[64:67], v[96:111]
    v_mfma_f32_32x32x16_bf16 v[112:127], v[72:75], v[68:71], v[112:127]
    ds_read_b128 v[64:67], v26 offset:49152
    ds_read_b128 v[68:71], v26 offset:53248
    ds_read_b64_tr_b16 v[72:73], v16 offset:53248
    ds_read_b64_tr_b16 v[74:75], v16 offset:53760
    s_waitcnt lgkmcnt(4)
    v_mfma_f32_32x32x16_bf16 v[96:111], v[88:91], v[80:83], v[96:111]
    v_mfma_f32_32x32x16_bf16 v[112:127], v[88:91], v[84:87], v[112:127]
    ds_read_b128 v[80:83], v27 offset:49152
    ds_read_b128 v[84:87], v27 offset:53248
    ds_read_b64_tr_b16 v[88:89], v16 offset:55296
    ds_read_b64_tr_b16 v[90:91], v16 offset:55808
    s_waitcnt lgkmcnt(4)
    v_mfma_f32_32x32x16_bf16 v[96:111], v[72:75], v[64:67], v[96:111]
    v_mfma_f32_32x32x16_bf16 v[112:127], v[72:75], v[68:71], v[112:127]
    s_waitcnt lgkmcnt(0)
    v_mfma_f32_32x32x16_bf16 v[96:111], v[88:91], v[80:83], v[96:111]
    v_mfma_f32_32x32x16_bf16 v[112:127], v[88:91], v[84:87], v[112:127]
    s_waitcnt vmcnt(6)
    s_barrier
    s_add_u32 m0, s41, 49152
    s_mov_b32 s35, 1024
    buffer_load_dwordx4 v3, s[16:19], s35 offen lds
    s_add_u32 m0, s41, 50176
    s_mov_b32 s35, 28672
    buffer_load_dwordx4 v3, s[16:19], s35 offen lds
    s_add_u32 m0, s41, 51200
    s_mov_b32 s35, 56320
    buffer_load_dwordx4 v3, s[16:19], s35 offen lds
    s_add_u32 m0, s41, 52224
    s_mov_b32 s35, 83968
    buffer_load_dwordx4 v3, s[16:19], s35 offen lds
    s_add_u32 m0, s42, 49152
    s_mov_b32 s35, 655360
    buffer_load_dwordx4 v7, s[20:23], s35 offen lds
    s_add_u32 m0, s42, 50176
    s_mov_b32 s35, 665600
    buffer_load_dwordx4 v7, s[20:23], s35 offen lds
    ds_read_b128 v[64:67], v24 offset:0
    ds_read_b128 v[68:71], v24 offset:4096
    ds_read_b64_tr_b16 v[72:73], v16 offset:0
    ds_read_b64_tr_b16 v[74:75], v16 offset:512
    ds_read_b128 v[80:83], v25 offset:0
    ds_read_b128 v[84:87], v25 offset:4096
    ds_read_b64_tr_b16 v[88:89], v16 offset:2048
    ds_read_b64_tr_b16 v[90:91], v16 offset:2560
    s_waitcnt lgkmcnt(4)
    v_mfma_f32_32x32x16_bf16 v[96:111], v[72:75], v[64:67], v[96:111]
    v_mfma_f32_32x32x16_bf16 v[112:127], v[72:75], v[68:71], v[112:127]
    ds_read_b128 v[64:67], v26 offset:0
    ds_read_b128 v[68:71], v26 offset:4096
    ds_read_b64_tr_b16 v[72:73], v16 offset:4096
    ds_read_b64_tr_b16 v[74:75], v16 offset:4608
    s_waitcnt lgkmcnt(4)
    v_mfma_f32_32x32x16_bf16 v[96:111], v[88:91], v[80:83], v[96:111]
    v_mfma_f32_32x32x16_bf16 v[112:127], v[88:91], v[84:87], v[112:127]
    ds_read_b128 v[80:83], v27 offset:0
    ds_read_b128 v[84:87], v27 offset:4096
    ds_read_b64_tr_b16 v[88:89], v16 offset:6144
    ds_read_b64_tr_b16 v[90:91], v16 offset:6656
    s_waitcnt lgkmcnt(4)
    v_mfma_f32_32x32x16_bf16 v[96:111], v[72:75], v[64:67], v[96:111]
    v_mfma_f32_32x32x16_bf16 v[112:127], v[72:75], v[68:71], v[112:127]
    s_waitcnt lgkmcnt(0)
    v_mfma_f32_32x32x16_bf16 v[96:111], v[88:91], v[80:83], v[96:111]
    v_mfma_f32_32x32x16_bf16 v[112:127], v[88:91], v[84:87], v[112:127]
    s_waitcnt vmcnt(6)
    s_barrier
    s_add_u32 m0, s41, 0
    s_mov_b32 s35, 1152
    buffer_load_dwordx4 v3, s[16:19], s35 offen lds
    s_add_u32 m0, s41, 1024
    s_mov_b32 s35, 28800
    buffer_load_dwordx4 v3, s[16:19], s35 offen lds
    s_add_u32 m0, s41, 2048
    s_mov_b32 s35, 56448
    buffer_load_dwordx4 v3, s[16:19], s35 offen lds
    s_add_u32 m0, s41, 3072
    s_mov_b32 s35, 84096
    buffer_load_dwordx4 v3, s[16:19], s35 offen lds
    s_add_u32 m0, s42, 0
    s_mov_b32 s35, 737280
    buffer_load_dwordx4 v7, s[20:23], s35 offen lds
    s_add_u32 m0, s42, 1024
    s_mov_b32 s35, 747520
    buffer_load_dwordx4 v7, s[20:23], s35 offen lds
    ds_read_b128 v[64:67], v24 offset:24576
    ds_read_b128 v[68:71], v24 offset:28672
    ds_read_b64_tr_b16 v[72:73], v16 offset:24576
    ds_read_b64_tr_b16 v[74:75], v16 offset:25088
    ds_read_b128 v[80:83], v25 offset:24576
    ds_read_b128 v[84:87], v25 offset:28672
    ds_read_b64_tr_b16 v[88:89], v16 offset:26624
    ds_read_b64_tr_b16 v[90:91], v16 offset:27136
    s_waitcnt lgkmcnt(4)
    v_mfma_f32_32x32x16_bf16 v[96:111], v[72:75], v[64:67], v[96:111]
    v_mfma_f32_32x32x16_bf16 v[112:127], v[72:75], v[68:71], v[112:127]
    ds_read_b128 v[64:67], v26 offset:24576
    ds_read_b128 v[68:71], v26 offset:28672
    ds_read_b64_tr_b16 v[72:73], v16 offset:28672
    ds_read_b64_tr_b16 v[74:75], v16 offset:29184
    s_waitcnt lgkmcnt(4)
    v_mfma_f32_32x32x16_bf16 v[96:111], v[88:91], v[80:83], v[96:111]
    v_mfma_f32_32x32x16_bf16 v[112:127], v[88:91], v[84:87], v[112:127]
    ds_read_b128 v[80:83], v27 offset:24576
    ds_read_b128 v[84:87], v27 offset:28672
    ds_read_b64_tr_b16 v[88:89], v16 offset:30720
    ds_read_b64_tr_b16 v[90:91], v16 offset:31232
    s_waitcnt lgkmcnt(4)
    v_mfma_f32_32x32x16_bf16 v[96:111], v[72:75], v[64:67], v[96:111]
    v_mfma_f32_32x32x16_bf16 v[112:127], v[72:75], v[68:71], v[112:127]
    s_waitcnt lgkmcnt(0)
    v_mfma_f32_32x32x16_bf16 v[96:111], v[88:91], v[80:83], v[96:111]
    v_mfma_f32_32x32x16_bf16 v[112:127], v[88:91], v[84:87], v[112:127]
    s_waitcnt vmcnt(6)
    s_barrier
    s_add_u32 m0, s41, 24576
    s_mov_b32 s35, 1280
    buffer_load_dwordx4 v3, s[16:19], s35 offen lds
    s_add_u32 m0, s41, 25600
    s_mov_b32 s35, 28928
    buffer_load_dwordx4 v3, s[16:19], s35 offen lds
    s_add_u32 m0, s41, 26624
    s_mov_b32 s35, 56576
    buffer_load_dwordx4 v3, s[16:19], s35 offen lds
    s_add_u32 m0, s41, 27648
    s_mov_b32 s35, 84224
    buffer_load_dwordx4 v3, s[16:19], s35 offen lds
    s_add_u32 m0, s42, 24576
    s_mov_b32 s35, 819200
    buffer_load_dwordx4 v7, s[20:23], s35 offen lds
    s_add_u32 m0, s42, 25600
    s_mov_b32 s35, 829440
    buffer_load_dwordx4 v7, s[20:23], s35 offen lds
    ds_read_b128 v[64:67], v24 offset:49152
    ds_read_b128 v[68:71], v24 offset:53248
    ds_read_b64_tr_b16 v[72:73], v16 offset:49152
    ds_read_b64_tr_b16 v[74:75], v16 offset:49664
    ds_read_b128 v[80:83], v25 offset:49152
    ds_read_b128 v[84:87], v25 offset:53248
    ds_read_b64_tr_b16 v[88:89], v16 offset:51200
    ds_read_b64_tr_b16 v[90:91], v16 offset:51712
    s_waitcnt lgkmcnt(4)
    v_mfma_f32_32x32x16_bf16 v[96:111], v[72:75], v[64:67], v[96:111]
    v_mfma_f32_32x32x16_bf16 v[112:127], v[72:75], v[68:71], v[112:127]
    ds_read_b128 v[64:67], v26 offset:49152
    ds_read_b128 v[68:71], v26 offset:53248
    ds_read_b64_tr_b16 v[72:73], v16 offset:53248
    ds_read_b64_tr_b16 v[74:75], v16 offset:53760
    s_waitcnt lgkmcnt(4)
    v_mfma_f32_32x32x16_bf16 v[96:111], v[88:91], v[80:83], v[96:111]
    v_mfma_f32_32x32x16_bf16 v[112:127], v[88:91], v[84:87], v[112:127]
    ds_read_b128 v[80:83], v27 offset:49152
    ds_read_b128 v[84:87], v27 offset:53248
    ds_read_b64_tr_b16 v[88:89], v16 offset:55296
    ds_read_b64_tr_b16 v[90:91], v16 offset:55808
    s_waitcnt lgkmcnt(4)
    v_mfma_f32_32x32x16_bf16 v[96:111], v[72:75], v[64:67], v[96:111]
    v_mfma_f32_32x32x16_bf16 v[112:127], v[72:75], v[68:71], v[112:127]
    s_waitcnt lgkmcnt(0)
    v_mfma_f32_32x32x16_bf16 v[96:111], v[88:91], v[80:83], v[96:111]
    v_mfma_f32_32x32x16_bf16 v[112:127], v[88:91], v[84:87], v[112:127]
    s_waitcnt vmcnt(6)
    s_barrier
    s_add_u32 m0, s41, 49152
    s_mov_b32 s35, 1408
    buffer_load_dwordx4 v3, s[16:19], s35 offen lds
    s_add_u32 m0, s41, 50176
    s_mov_b32 s35, 29056
    buffer_load_dwordx4 v3, s[16:19], s35 offen lds
    s_add_u32 m0, s41, 51200
    s_mov_b32 s35, 56704
    buffer_load_dwordx4 v3, s[16:19], s35 offen lds
    s_add_u32 m0, s41, 52224
    s_mov_b32 s35, 84352
    buffer_load_dwordx4 v3, s[16:19], s35 offen lds
    s_add_u32 m0, s42, 49152
    s_mov_b32 s35, 901120
    buffer_load_dwordx4 v7, s[20:23], s35 offen lds
    s_add_u32 m0, s42, 50176
    s_mov_b32 s35, 911360
    buffer_load_dwordx4 v7, s[20:23], s35 offen lds
    ds_read_b128 v[64:67], v24 offset:0
    ds_read_b128 v[68:71], v24 offset:4096
    ds_read_b64_tr_b16 v[72:73], v16 offset:0
    ds_read_b64_tr_b16 v[74:75], v16 offset:512
    ds_read_b128 v[80:83], v25 offset:0
    ds_read_b128 v[84:87], v25 offset:4096
    ds_read_b64_tr_b16 v[88:89], v16 offset:2048
    ds_read_b64_tr_b16 v[90:91], v16 offset:2560
    s_waitcnt lgkmcnt(4)
    v_mfma_f32_32x32x16_bf16 v[96:111], v[72:75], v[64:67], v[96:111]
    v_mfma_f32_32x32x16_bf16 v[112:127], v[72:75], v[68:71], v[112:127]
    ds_read_b128 v[64:67], v26 offset:0
    ds_read_b128 v[68:71], v26 offset:4096
    ds_read_b64_tr_b16 v[72:73], v16 offset:4096
    ds_read_b64_tr_b16 v[74:75], v16 offset:4608
    s_waitcnt lgkmcnt(4)
    v_mfma_f32_32x32x16_bf16 v[96:111], v[88:91], v[80:83], v[96:111]
    v_mfma_f32_32x32x16_bf16 v[112:127], v[88:91], v[84:87], v[112:127]
    ds_read_b128 v[80:83], v27 offset:0
    ds_read_b128 v[84:87], v27 offset:4096
    ds_read_b64_tr_b16 v[88:89], v16 offset:6144
    ds_read_b64_tr_b16 v[90:91], v16 offset:6656
    s_waitcnt lgkmcnt(4)
    v_mfma_f32_32x32x16_bf16 v[96:111], v[72:75], v[64:67], v[96:111]
    v_mfma_f32_32x32x16_bf16 v[112:127], v[72:75], v[68:71], v[112:127]
    s_waitcnt lgkmcnt(0)
    v_mfma_f32_32x32x16_bf16 v[96:111], v[88:91], v[80:83], v[96:111]
    v_mfma_f32_32x32x16_bf16 v[112:127], v[88:91], v[84:87], v[112:127]
    s_waitcnt vmcnt(6)
    s_barrier
    s_add_u32 m0, s41, 0
    s_mov_b32 s35, 1536
    buffer_load_dwordx4 v3, s[16:19], s35 offen lds
    s_add_u32 m0, s41, 1024
    s_mov_b32 s35, 29184
    buffer_load_dwordx4 v3, s[16:19], s35 offen lds
    s_add_u32 m0, s41, 2048
    s_mov_b32 s35, 56832
    buffer_load_dwordx4 v3, s[16:19], s35 offen lds
    s_add_u32 m0, s41, 3072
    s_mov_b32 s35, 84480
    buffer_load_dwordx4 v3, s[16:19], s35 offen lds
    s_add_u32 m0, s42, 0
    s_mov_b32 s35, 983040
    buffer_load_dwordx4 v7, s[20:23], s35 offen lds
    s_add_u32 m0, s42, 1024
    s_mov_b32 s35, 993280
    buffer_load_dwordx4 v7, s[20:23], s35 offen lds
    ds_read_b128 v[64:67], v24 offset:24576
    ds_read_b128 v[68:71], v24 offset:28672
    ds_read_b64_tr_b16 v[72:73], v16 offset:24576
    ds_read_b64_tr_b16 v[74:75], v16 offset:25088
    ds_read_b128 v[80:83], v25 offset:24576
    ds_read_b128 v[84:87], v25 offset:28672
    ds_read_b64_tr_b16 v[88:89], v16 offset:26624
    ds_read_b64_tr_b16 v[90:91], v16 offset:27136
    s_waitcnt lgkmcnt(4)
    v_mfma_f32_32x32x16_bf16 v[96:111], v[72:75], v[64:67], v[96:111]
    v_mfma_f32_32x32x16_bf16 v[112:127], v[72:75], v[68:71], v[112:127]
    ds_read_b128 v[64:67], v26 offset:24576
    ds_read_b128 v[68:71], v26 offset:28672
    ds_read_b64_tr_b16 v[72:73], v16 offset:28672
    ds_read_b64_tr_b16 v[74:75], v16 offset:29184
    s_waitcnt lgkmcnt(4)
    v_mfma_f32_32x32x16_bf16 v[96:111], v[88:91], v[80:83], v[96:111]
    v_mfma_f32_32x32x16_bf16 v[112:127], v[88:91], v[84:87], v[112:127]
    ds_read_b128 v[80:83], v27 offset:24576
    ds_read_b128 v[84:87], v27 offset:28672
    ds_read_b64_tr_b16 v[88:89], v16 offset:30720
    ds_read_b64_tr_b16 v[90:91], v16 offset:31232
    s_waitcnt lgkmcnt(4)
    v_mfma_f32_32x32x16_bf16 v[96:111], v[72:75], v[64:67], v[96:111]
    v_mfma_f32_32x32x16_bf16 v[112:127], v[72:75], v[68:71], v[112:127]
    s_waitcnt lgkmcnt(0)
    v_mfma_f32_32x32x16_bf16 v[96:111], v[88:91], v[80:83], v[96:111]
    v_mfma_f32_32x32x16_bf16 v[112:127], v[88:91], v[84:87], v[112:127]
    s_waitcnt vmcnt(6)
    s_barrier
    s_add_u32 m0, s41, 24576
    s_mov_b32 s35, 1664
    buffer_load_dwordx4 v3, s[16:19], s35 offen lds
    s_add_u32 m0, s41, 25600
    s_mov_b32 s35, 29312
    buffer_load_dwordx4 v3, s[16:19], s35 offen lds
    s_add_u32 m0, s41, 26624
    s_mov_b32 s35, 56960
    buffer_load_dwordx4 v3, s[16:19], s35 offen lds
    s_add_u32 m0, s41, 27648
    s_mov_b32 s35, 84608
    buffer_load_dwordx4 v3, s[16:19], s35 offen lds
    s_add_u32 m0, s42, 24576
    s_mov_b32 s35, 1064960
    buffer_load_dwordx4 v7, s[20:23], s35 offen lds
    s_add_u32 m0, s42, 25600
    s_mov_b32 s35, 1075200
    buffer_load_dwordx4 v7, s[20:23], s35 offen lds
    ds_read_b128 v[64:67], v24 offset:49152
    ds_read_b128 v[68:71], v24 offset:53248
    ds_read_b64_tr_b16 v[72:73], v16 offset:49152
    ds_read_b64_tr_b16 v[74:75], v16 offset:49664
    ds_read_b128 v[80:83], v25 offset:49152
    ds_read_b128 v[84:87], v25 offset:53248
    ds_read_b64_tr_b16 v[88:89], v16 offset:51200
    ds_read_b64_tr_b16 v[90:91], v16 offset:51712
    s_waitcnt lgkmcnt(4)
    v_mfma_f32_32x32x16_bf16 v[96:111], v[72:75], v[64:67], v[96:111]
    v_mfma_f32_32x32x16_bf16 v[112:127], v[72:75], v[68:71], v[112:127]
    ds_read_b128 v[64:67], v26 offset:49152
    ds_read_b128 v[68:71], v26 offset:53248
    ds_read_b64_tr_b16 v[72:73], v16 offset:53248
    ds_read_b64_tr_b16 v[74:75], v16 offset:53760
    s_waitcnt lgkmcnt(4)
    v_mfma_f32_32x32x16_bf16 v[96:111], v[88:91], v[80:83], v[96:111]
    v_mfma_f32_32x32x16_bf16 v[112:127], v[88:91], v[84:87], v[112:127]
    ds_read_b128 v[80:83], v27 offset:49152
    ds_read_b128 v[84:87], v27 offset:53248
    ds_read_b64_tr_b16 v[88:89], v16 offset:55296
    ds_read_b64_tr_b16 v[90:91], v16 offset:55808
    s_waitcnt lgkmcnt(4)
    v_mfma_f32_32x32x16_bf16 v[96:111], v[72:75], v[64:67], v[96:111]
    v_mfma_f32_32x32x16_bf16 v[112:127], v[72:75], v[68:71], v[112:127]
    s_waitcnt lgkmcnt(0)
    v_mfma_f32_32x32x16_bf16 v[96:111], v[88:91], v[80:83], v[96:111]
    v_mfma_f32_32x32x16_bf16 v[112:127], v[88:91], v[84:87], v[112:127]
    s_waitcnt vmcnt(6)
    s_barrier
    s_add_u32 m0, s41, 49152
    s_mov_b32 s35, 1792
    buffer_load_dwordx4 v3, s[16:19], s35 offen lds
    s_add_u32 m0, s41, 50176
    s_mov_b32 s35, 29440
    buffer_load_dwordx4 v3, s[16:19], s35 offen lds
    s_add_u32 m0, s41, 51200
    s_mov_b32 s35, 57088
    buffer_load_dwordx4 v3, s[16:19], s35 offen lds
    s_add_u32 m0, s41, 52224
    s_mov_b32 s35, 84736
    buffer_load_dwordx4 v3, s[16:19], s35 offen lds
    s_add_u32 m0, s42, 49152
    s_mov_b32 s35, 1146880
    buffer_load_dwordx4 v7, s[20:23], s35 offen lds
    s_add_u32 m0, s42, 50176
    s_mov_b32 s35, 1157120
    buffer_load_dwordx4 v7, s[20:23], s35 offen lds
    ds_read_b128 v[64:67], v24 offset:0
    ds_read_b128 v[68:71], v24 offset:4096
    ds_read_b64_tr_b16 v[72:73], v16 offset:0
    ds_read_b64_tr_b16 v[74:75], v16 offset:512
    ds_read_b128 v[80:83], v25 offset:0
    ds_read_b128 v[84:87], v25 offset:4096
    ds_read_b64_tr_b16 v[88:89], v16 offset:2048
    ds_read_b64_tr_b16 v[90:91], v16 offset:2560
    s_waitcnt lgkmcnt(4)
    v_mfma_f32_32x32x16_bf16 v[96:111], v[72:75], v[64:67], v[96:111]
    v_mfma_f32_32x32x16_bf16 v[112:127], v[72:75], v[68:71], v[112:127]
    ds_read_b128 v[64:67], v26 offset:0
    ds_read_b128 v[68:71], v26 offset:4096
    ds_read_b64_tr_b16 v[72:73], v16 offset:4096
    ds_read_b64_tr_b16 v[74:75], v16 offset:4608
    s_waitcnt lgkmcnt(4)
    v_mfma_f32_32x32x16_bf16 v[96:111], v[88:91], v[80:83], v[96:111]
    v_mfma_f32_32x32x16_bf16 v[112:127], v[88:91], v[84:87], v[112:127]
    ds_read_b128 v[80:83], v27 offset:0
    ds_read_b128 v[84:87], v27 offset:4096
    ds_read_b64_tr_b16 v[88:89], v16 offset:6144
    ds_read_b64_tr_b16 v[90:91], v16 offset:6656
    s_waitcnt lgkmcnt(4)
    v_mfma_f32_32x32x16_bf16 v[96:111], v[72:75], v[64:67], v[96:111]
    v_mfma_f32_32x32x16_bf16 v[112:127], v[72:75], v[68:71], v[112:127]
    s_waitcnt lgkmcnt(0)
    v_mfma_f32_32x32x16_bf16 v[96:111], v[88:91], v[80:83], v[96:111]
    v_mfma_f32_32x32x16_bf16 v[112:127], v[88:91], v[84:87], v[112:127]
    s_waitcnt vmcnt(6)
    s_barrier
    s_add_u32 m0, s41, 0
    s_mov_b32 s35, 1920
    buffer_load_dwordx4 v3, s[16:19], s35 offen lds
    s_add_u32 m0, s41, 1024
    s_mov_b32 s35, 29568
    buffer_load_dwordx4 v3, s[16:19], s35 offen lds
    s_add_u32 m0, s41, 2048
    s_mov_b32 s35, 57216
    buffer_load_dwordx4 v3, s[16:19], s35 offen lds
    s_add_u32 m0, s41, 3072
    s_mov_b32 s35, 84864
    buffer_load_dwordx4 v3, s[16:19], s35 offen lds
    s_add_u32 m0, s42, 0
    s_mov_b32 s35, 1228800
    buffer_load_dwordx4 v7, s[20:23], s35 offen lds
    s_add_u32 m0, s42, 1024
    s_mov_b32 s35, 1239040
    buffer_load_dwordx4 v7, s[20:23], s35 offen lds
    ds_read_b128 v[64:67], v24 offset:24576
    ds_read_b128 v[68:71], v24 offset:28672
    ds_read_b64_tr_b16 v[72:73], v16 offset:24576
    ds_read_b64_tr_b16 v[74:75], v16 offset:25088
    ds_read_b128 v[80:83], v25 offset:24576
    ds_read_b128 v[84:87], v25 offset:28672
    ds_read_b64_tr_b16 v[88:89], v16 offset:26624
    ds_read_b64_tr_b16 v[90:91], v16 offset:27136
    s_waitcnt lgkmcnt(4)
    v_mfma_f32_32x32x16_bf16 v[96:111], v[72:75], v[64:67], v[96:111]
    v_mfma_f32_32x32x16_bf16 v[112:127], v[72:75], v[68:71], v[112:127]
    ds_read_b128 v[64:67], v26 offset:24576
    ds_read_b128 v[68:71], v26 offset:28672
    ds_read_b64_tr_b16 v[72:73], v16 offset:28672
    ds_read_b64_tr_b16 v[74:75], v16 offset:29184
    s_waitcnt lgkmcnt(4)
    v_mfma_f32_32x32x16_bf16 v[96:111], v[88:91], v[80:83], v[96:111]
    v_mfma_f32_32x32x16_bf16 v[112:127], v[88:91], v[84:87], v[112:127]
    ds_read_b128 v[80:83], v27 offset:24576
    ds_read_b128 v[84:87], v27 offset:28672
    ds_read_b64_tr_b16 v[88:89], v16 offset:30720
    ds_read_b64_tr_b16 v[90:91], v16 offset:31232
    s_waitcnt lgkmcnt(4)
    v_mfma_f32_32x32x16_bf16 v[96:111], v[72:75], v[64:67], v[96:111]
    v_mfma_f32_32x32x16_bf16 v[112:127], v[72:75], v[68:71], v[112:127]
    s_waitcnt lgkmcnt(0)
    v_mfma_f32_32x32x16_bf16 v[96:111], v[88:91], v[80:83], v[96:111]
    v_mfma_f32_32x32x16_bf16 v[112:127], v[88:91], v[84:87], v[112:127]
    s_waitcnt vmcnt(6)
    s_barrier
    s_add_u32 m0, s41, 24576
    s_mov_b32 s35, 2048
    buffer_load_dwordx4 v3, s[16:19], s35 offen lds
    s_add_u32 m0, s41, 25600
    s_mov_b32 s35, 29696
    buffer_load_dwordx4 v3, s[16:19], s35 offen lds
    s_add_u32 m0, s41, 26624
    s_mov_b32 s35, 57344
    buffer_load_dwordx4 v3, s[16:19], s35 offen lds
    s_add_u32 m0, s41, 27648
    s_mov_b32 s35, 84992
    buffer_load_dwordx4 v3, s[16:19], s35 offen lds
    s_add_u32 m0, s42, 24576
    s_mov_b32 s35, 1310720
    buffer_load_dwordx4 v7, s[20:23], s35 offen lds
    s_add_u32 m0, s42, 25600
    s_mov_b32 s35, 1320960
    buffer_load_dwordx4 v7, s[20:23], s35 offen lds
    ds_read_b128 v[64:67], v24 offset:49152
    ds_read_b128 v[68:71], v24 offset:53248
    ds_read_b64_tr_b16 v[72:73], v16 offset:49152
    ds_read_b64_tr_b16 v[74:75], v16 offset:49664
    ds_read_b128 v[80:83], v25 offset:49152
    ds_read_b128 v[84:87], v25 offset:53248
    ds_read_b64_tr_b16 v[88:89], v16 offset:51200
    ds_read_b64_tr_b16 v[90:91], v16 offset:51712
    s_waitcnt lgkmcnt(4)
    v_mfma_f32_32x32x16_bf16 v[96:111], v[72:75], v[64:67], v[96:111]
    v_mfma_f32_32x32x16_bf16 v[112:127], v[72:75], v[68:71], v[112:127]
    ds_read_b128 v[64:67], v26 offset:49152
    ds_read_b128 v[68:71], v26 offset:53248
    ds_read_b64_tr_b16 v[72:73], v16 offset:53248
    ds_read_b64_tr_b16 v[74:75], v16 offset:53760
    s_waitcnt lgkmcnt(4)
    v_mfma_f32_32x32x16_bf16 v[96:111], v[88:91], v[80:83], v[96:111]
    v_mfma_f32_32x32x16_bf16 v[112:127], v[88:91], v[84:87], v[112:127]
    ds_read_b128 v[80:83], v27 offset:49152
    ds_read_b128 v[84:87], v27 offset:53248
    ds_read_b64_tr_b16 v[88:89], v16 offset:55296
    ds_read_b64_tr_b16 v[90:91], v16 offset:55808
    s_waitcnt lgkmcnt(4)
    v_mfma_f32_32x32x16_bf16 v[96:111], v[72:75], v[64:67], v[96:111]
    v_mfma_f32_32x32x16_bf16 v[112:127], v[72:75], v[68:71], v[112:127]
    s_waitcnt lgkmcnt(0)
    v_mfma_f32_32x32x16_bf16 v[96:111], v[88:91], v[80:83], v[96:111]
    v_mfma_f32_32x32x16_bf16 v[112:127], v[88:91], v[84:87], v[112:127]
    s_waitcnt vmcnt(6)
    s_barrier
    s_add_u32 m0, s41, 49152
    s_mov_b32 s35, 2176
    buffer_load_dwordx4 v3, s[16:19], s35 offen lds
    s_add_u32 m0, s41, 50176
    s_mov_b32 s35, 29824
    buffer_load_dwordx4 v3, s[16:19], s35 offen lds
    s_add_u32 m0, s41, 51200
    s_mov_b32 s35, 57472
    buffer_load_dwordx4 v3, s[16:19], s35 offen lds
    s_add_u32 m0, s41, 52224
    s_mov_b32 s35, 85120
    buffer_load_dwordx4 v3, s[16:19], s35 offen lds
    s_add_u32 m0, s42, 49152
    s_mov_b32 s35, 1392640
    buffer_load_dwordx4 v7, s[20:23], s35 offen lds
    s_add_u32 m0, s42, 50176
    s_mov_b32 s35, 1402880
    buffer_load_dwordx4 v7, s[20:23], s35 offen lds
    ds_read_b128 v[64:67], v24 offset:0
    ds_read_b128 v[68:71], v24 offset:4096
    ds_read_b64_tr_b16 v[72:73], v16 offset:0
    ds_read_b64_tr_b16 v[74:75], v16 offset:512
    ds_read_b128 v[80:83], v25 offset:0
    ds_read_b128 v[84:87], v25 offset:4096
    ds_read_b64_tr_b16 v[88:89], v16 offset:2048
    ds_read_b64_tr_b16 v[90:91], v16 offset:2560
    s_waitcnt lgkmcnt(4)
    v_mfma_f32_32x32x16_bf16 v[96:111], v[72:75], v[64:67], v[96:111]
    v_mfma_f32_32x32x16_bf16 v[112:127], v[72:75], v[68:71], v[112:127]
    ds_read_b128 v[64:67], v26 offset:0
    ds_read_b128 v[68:71], v26 offset:4096
    ds_read_b64_tr_b16 v[72:73], v16 offset:4096
    ds_read_b64_tr_b16 v[74:75], v16 offset:4608
    s_waitcnt lgkmcnt(4)
    v_mfma_f32_32x32x16_bf16 v[96:111], v[88:91], v[80:83], v[96:111]
    v_mfma_f32_32x32x16_bf16 v[112:127], v[88:91], v[84:87], v[112:127]
    ds_read_b128 v[80:83], v27 offset:0
    ds_read_b128 v[84:87], v27 offset:4096
    ds_read_b64_tr_b16 v[88:89], v16 offset:6144
    ds_read_b64_tr_b16 v[90:91], v16 offset:6656
    s_waitcnt lgkmcnt(4)
    v_mfma_f32_32x32x16_bf16 v[96:111], v[72:75], v[64:67], v[96:111]
    v_mfma_f32_32x32x16_bf16 v[112:127], v[72:75], v[68:71], v[112:127]
    s_waitcnt lgkmcnt(0)
    v_mfma_f32_32x32x16_bf16 v[96:111], v[88:91], v[80:83], v[96:111]
    v_mfma_f32_32x32x16_bf16 v[112:127], v[88:91], v[84:87], v[112:127]
    s_waitcnt vmcnt(6)
    s_barrier
    s_add_u32 m0, s41, 0
    s_mov_b32 s35, 2304
    buffer_load_dwordx4 v3, s[16:19], s35 offen lds
    s_add_u32 m0, s41, 1024
    s_mov_b32 s35, 29952
    buffer_load_dwordx4 v3, s[16:19], s35 offen lds
    s_add_u32 m0, s41, 2048
    s_mov_b32 s35, 57600
    buffer_load_dwordx4 v3, s[16:19], s35 offen lds
    s_add_u32 m0, s41, 3072
    s_mov_b32 s35, 85248
    buffer_load_dwordx4 v3, s[16:19], s35 offen lds
    s_add_u32 m0, s42, 0
    s_mov_b32 s35, 1474560
    buffer_load_dwordx4 v7, s[20:23], s35 offen lds
    s_add_u32 m0, s42, 1024
    s_mov_b32 s35, 1484800
    buffer_load_dwordx4 v7, s[20:23], s35 offen lds
    ds_read_b128 v[64:67], v24 offset:24576
    ds_read_b128 v[68:71], v24 offset:28672
    ds_read_b64_tr_b16 v[72:73], v16 offset:24576
    ds_read_b64_tr_b16 v[74:75], v16 offset:25088
    ds_read_b128 v[80:83], v25 offset:24576
    ds_read_b128 v[84:87], v25 offset:28672
    ds_read_b64_tr_b16 v[88:89], v16 offset:26624
    ds_read_b64_tr_b16 v[90:91], v16 offset:27136
    s_waitcnt lgkmcnt(4)
    v_mfma_f32_32x32x16_bf16 v[96:111], v[72:75], v[64:67], v[96:111]
    v_mfma_f32_32x32x16_bf16 v[112:127], v[72:75], v[68:71], v[112:127]
    ds_read_b128 v[64:67], v26 offset:24576
    ds_read_b128 v[68:71], v26 offset:28672
    ds_read_b64_tr_b16 v[72:73], v16 offset:28672
    ds_read_b64_tr_b16 v[74:75], v16 offset:29184
    s_waitcnt lgkmcnt(4)
    v_mfma_f32_32x32x16_bf16 v[96:111], v[88:91], v[80:83], v[96:111]
    v_mfma_f32_32x32x16_bf16 v[112:127], v[88:91], v[84:87], v[112:127]
    ds_read_b128 v[80:83], v27 offset:24576
    ds_read_b128 v[84:87], v27 offset:28672
    ds_read_b64_tr_b16 v[88:89], v16 offset:30720
    ds_read_b64_tr_b16 v[90:91], v16 offset:31232
    s_waitcnt lgkmcnt(4)
    v_mfma_f32_32x32x16_bf16 v[96:111], v[72:75], v[64:67], v[96:111]
    v_mfma_f32_32x32x16_bf16 v[112:127], v[72:75], v[68:71], v[112:127]
    s_waitcnt lgkmcnt(0)
    v_mfma_f32_32x32x16_bf16 v[96:111], v[88:91], v[80:83], v[96:111]
    v_mfma_f32_32x32x16_bf16 v[112:127], v[88:91], v[84:87], v[112:127]
    s_waitcnt vmcnt(6)
    s_barrier
    s_add_u32 m0, s41, 24576
    s_mov_b32 s35, 2432
    buffer_load_dwordx4 v3, s[16:19], s35 offen lds
    s_add_u32 m0, s41, 25600
    s_mov_b32 s35, 30080
    buffer_load_dwordx4 v3, s[16:19], s35 offen lds
    s_add_u32 m0, s41, 26624
    s_mov_b32 s35, 57728
    buffer_load_dwordx4 v3, s[16:19], s35 offen lds
    s_add_u32 m0, s41, 27648
    s_mov_b32 s35, 85376
    buffer_load_dwordx4 v3, s[16:19], s35 offen lds
    s_add_u32 m0, s42, 24576
    s_mov_b32 s35, 1556480
    buffer_load_dwordx4 v7, s[20:23], s35 offen lds
    s_add_u32 m0, s42, 25600
    s_mov_b32 s35, 1566720
    buffer_load_dwordx4 v7, s[20:23], s35 offen lds
    ds_read_b128 v[64:67], v24 offset:49152
    ds_read_b128 v[68:71], v24 offset:53248
    ds_read_b64_tr_b16 v[72:73], v16 offset:49152
    ds_read_b64_tr_b16 v[74:75], v16 offset:49664
    ds_read_b128 v[80:83], v25 offset:49152
    ds_read_b128 v[84:87], v25 offset:53248
    ds_read_b64_tr_b16 v[88:89], v16 offset:51200
    ds_read_b64_tr_b16 v[90:91], v16 offset:51712
    s_waitcnt lgkmcnt(4)
    v_mfma_f32_32x32x16_bf16 v[96:111], v[72:75], v[64:67], v[96:111]
    v_mfma_f32_32x32x16_bf16 v[112:127], v[72:75], v[68:71], v[112:127]
    ds_read_b128 v[64:67], v26 offset:49152
    ds_read_b128 v[68:71], v26 offset:53248
    ds_read_b64_tr_b16 v[72:73], v16 offset:53248
    ds_read_b64_tr_b16 v[74:75], v16 offset:53760
    s_waitcnt lgkmcnt(4)
    v_mfma_f32_32x32x16_bf16 v[96:111], v[88:91], v[80:83], v[96:111]
    v_mfma_f32_32x32x16_bf16 v[112:127], v[88:91], v[84:87], v[112:127]
    ds_read_b128 v[80:83], v27 offset:49152
    ds_read_b128 v[84:87], v27 offset:53248
    ds_read_b64_tr_b16 v[88:89], v16 offset:55296
    ds_read_b64_tr_b16 v[90:91], v16 offset:55808
    s_waitcnt lgkmcnt(4)
    v_mfma_f32_32x32x16_bf16 v[96:111], v[72:75], v[64:67], v[96:111]
    v_mfma_f32_32x32x16_bf16 v[112:127], v[72:75], v[68:71], v[112:127]
    s_waitcnt lgkmcnt(0)
    v_mfma_f32_32x32x16_bf16 v[96:111], v[88:91], v[80:83], v[96:111]
    v_mfma_f32_32x32x16_bf16 v[112:127], v[88:91], v[84:87], v[112:127]
    s_waitcnt vmcnt(6)
    s_barrier
    s_add_u32 m0, s41, 49152
    s_mov_b32 s35, 2560
    buffer_load_dwordx4 v3, s[16:19], s35 offen lds
    s_add_u32 m0, s41, 50176
    s_mov_b32 s35, 30208
    buffer_load_dwordx4 v3, s[16:19], s35 offen lds
    s_add_u32 m0, s41, 51200
    s_mov_b32 s35, 57856
    buffer_load_dwordx4 v3, s[16:19], s35 offen lds
    s_add_u32 m0, s41, 52224
    s_mov_b32 s35, 85504
    buffer_load_dwordx4 v3, s[16:19], s35 offen lds
    s_add_u32 m0, s42, 49152
    s_mov_b32 s35, 1638400
    buffer_load_dwordx4 v7, s[20:23], s35 offen lds
    s_add_u32 m0, s42, 50176
    s_mov_b32 s35, 1648640
    buffer_load_dwordx4 v7, s[20:23], s35 offen lds
    ds_read_b128 v[64:67], v24 offset:0
    ds_read_b128 v[68:71], v24 offset:4096
    ds_read_b64_tr_b16 v[72:73], v16 offset:0
    ds_read_b64_tr_b16 v[74:75], v16 offset:512
    ds_read_b128 v[80:83], v25 offset:0
    ds_read_b128 v[84:87], v25 offset:4096
    ds_read_b64_tr_b16 v[88:89], v16 offset:2048
    ds_read_b64_tr_b16 v[90:91], v16 offset:2560
    s_waitcnt lgkmcnt(4)
    v_mfma_f32_32x32x16_bf16 v[96:111], v[72:75], v[64:67], v[96:111]
    v_mfma_f32_32x32x16_bf16 v[112:127], v[72:75], v[68:71], v[112:127]
    ds_read_b128 v[64:67], v26 offset:0
    ds_read_b128 v[68:71], v26 offset:4096
    ds_read_b64_tr_b16 v[72:73], v16 offset:4096
    ds_read_b64_tr_b16 v[74:75], v16 offset:4608
    s_waitcnt lgkmcnt(4)
    v_mfma_f32_32x32x16_bf16 v[96:111], v[88:91], v[80:83], v[96:111]
    v_mfma_f32_32x32x16_bf16 v[112:127], v[88:91], v[84:87], v[112:127]
    ds_read_b128 v[80:83], v27 offset:0
    ds_read_b128 v[84:87], v27 offset:4096
    ds_read_b64_tr_b16 v[88:89], v16 offset:6144
    ds_read_b64_tr_b16 v[90:91], v16 offset:6656
    s_waitcnt lgkmcnt(4)
    v_mfma_f32_32x32x16_bf16 v[96:111], v[72:75], v[64:67], v[96:111]
    v_mfma_f32_32x32x16_bf16 v[112:127], v[72:75], v[68:71], v[112:127]
    s_waitcnt lgkmcnt(0)
    v_mfma_f32_32x32x16_bf16 v[96:111], v[88:91], v[80:83], v[96:111]
    v_mfma_f32_32x32x16_bf16 v[112:127], v[88:91], v[84:87], v[112:127]
    s_waitcnt vmcnt(6)
    s_barrier
    s_add_u32 m0, s41, 0
    s_mov_b32 s35, 2688
    buffer_load_dwordx4 v3, s[16:19], s35 offen lds
    s_add_u32 m0, s41, 1024
    s_mov_b32 s35, 30336
    buffer_load_dwordx4 v3, s[16:19], s35 offen lds
    s_add_u32 m0, s41, 2048
    s_mov_b32 s35, 57984
    buffer_load_dwordx4 v3, s[16:19], s35 offen lds
    s_add_u32 m0, s41, 3072
    s_mov_b32 s35, 85632
    buffer_load_dwordx4 v3, s[16:19], s35 offen lds
    s_add_u32 m0, s42, 0
    s_mov_b32 s35, 1720320
    buffer_load_dwordx4 v7, s[20:23], s35 offen lds
    s_add_u32 m0, s42, 1024
    s_mov_b32 s35, 1730560
    buffer_load_dwordx4 v7, s[20:23], s35 offen lds
    ds_read_b128 v[64:67], v24 offset:24576
    ds_read_b128 v[68:71], v24 offset:28672
    ds_read_b64_tr_b16 v[72:73], v16 offset:24576
    ds_read_b64_tr_b16 v[74:75], v16 offset:25088
    ds_read_b128 v[80:83], v25 offset:24576
    ds_read_b128 v[84:87], v25 offset:28672
    ds_read_b64_tr_b16 v[88:89], v16 offset:26624
    ds_read_b64_tr_b16 v[90:91], v16 offset:27136
    s_waitcnt lgkmcnt(4)
    v_mfma_f32_32x32x16_bf16 v[96:111], v[72:75], v[64:67], v[96:111]
    v_mfma_f32_32x32x16_bf16 v[112:127], v[72:75], v[68:71], v[112:127]
    ds_read_b128 v[64:67], v26 offset:24576
    ds_read_b128 v[68:71], v26 offset:28672
    ds_read_b64_tr_b16 v[72:73], v16 offset:28672
    ds_read_b64_tr_b16 v[74:75], v16 offset:29184
    s_waitcnt lgkmcnt(4)
    v_mfma_f32_32x32x16_bf16 v[96:111], v[88:91], v[80:83], v[96:111]
    v_mfma_f32_32x32x16_bf16 v[112:127], v[88:91], v[84:87], v[112:127]
    ds_read_b128 v[80:83], v27 offset:24576
    ds_read_b128 v[84:87], v27 offset:28672
    ds_read_b64_tr_b16 v[88:89], v16 offset:30720
    ds_read_b64_tr_b16 v[90:91], v16 offset:31232
    s_waitcnt lgkmcnt(4)
    v_mfma_f32_32x32x16_bf16 v[96:111], v[72:75], v[64:67], v[96:111]
    v_mfma_f32_32x32x16_bf16 v[112:127], v[72:75], v[68:71], v[112:127]
    s_waitcnt lgkmcnt(0)
    v_mfma_f32_32x32x16_bf16 v[96:111], v[88:91], v[80:83], v[96:111]
    v_mfma_f32_32x32x16_bf16 v[112:127], v[88:91], v[84:87], v[112:127]
    s_waitcnt vmcnt(6)
    s_barrier
    s_add_u32 m0, s41, 24576
    s_mov_b32 s35, 2816
    buffer_load_dwordx4 v3, s[16:19], s35 offen lds
    s_add_u32 m0, s41, 25600
    s_mov_b32 s35, 30464
    buffer_load_dwordx4 v3, s[16:19], s35 offen lds
    s_add_u32 m0, s41, 26624
    s_mov_b32 s35, 58112
    buffer_load_dwordx4 v3, s[16:19], s35 offen lds
    s_add_u32 m0, s41, 27648
    s_mov_b32 s35, 85760
    buffer_load_dwordx4 v3, s[16:19], s35 offen lds
    s_add_u32 m0, s42, 24576
    s_mov_b32 s35, 1802240
    buffer_load_dwordx4 v7, s[20:23], s35 offen lds
    s_add_u32 m0, s42, 25600
    s_mov_b32 s35, 1812480
    buffer_load_dwordx4 v7, s[20:23], s35 offen lds
    ds_read_b128 v[64:67], v24 offset:49152
    ds_read_b128 v[68:71], v24 offset:53248
    ds_read_b64_tr_b16 v[72:73], v16 offset:49152
    ds_read_b64_tr_b16 v[74:75], v16 offset:49664
    ds_read_b128 v[80:83], v25 offset:49152
    ds_read_b128 v[84:87], v25 offset:53248
    ds_read_b64_tr_b16 v[88:89], v16 offset:51200
    ds_read_b64_tr_b16 v[90:91], v16 offset:51712
    s_waitcnt lgkmcnt(4)
    v_mfma_f32_32x32x16_bf16 v[96:111], v[72:75], v[64:67], v[96:111]
    v_mfma_f32_32x32x16_bf16 v[112:127], v[72:75], v[68:71], v[112:127]
    ds_read_b128 v[64:67], v26 offset:49152
    ds_read_b128 v[68:71], v26 offset:53248
    ds_read_b64_tr_b16 v[72:73], v16 offset:53248
    ds_read_b64_tr_b16 v[74:75], v16 offset:53760
    s_waitcnt lgkmcnt(4)
    v_mfma_f32_32x32x16_bf16 v[96:111], v[88:91], v[80:83], v[96:111]
    v_mfma_f32_32x32x16_bf16 v[112:127], v[88:91], v[84:87], v[112:127]
    ds_read_b128 v[80:83], v27 offset:49152
    ds_read_b128 v[84:87], v27 offset:53248
    ds_read_b64_tr_b16 v[88:89], v16 offset:55296
    ds_read_b64_tr_b16 v[90:91], v16 offset:55808
    s_waitcnt lgkmcnt(4)
    v_mfma_f32_32x32x16_bf16 v[96:111], v[72:75], v[64:67], v[96:111]
    v_mfma_f32_32x32x16_bf16 v[112:127], v[72:75], v[68:71], v[112:127]
    s_waitcnt lgkmcnt(0)
    v_mfma_f32_32x32x16_bf16 v[96:111], v[88:91], v[80:83], v[96:111]
    v_mfma_f32_32x32x16_bf16 v[112:127], v[88:91], v[84:87], v[112:127]
    s_waitcnt vmcnt(6)
    s_barrier
    s_add_u32 m0, s41, 49152
    s_mov_b32 s35, 2944
    buffer_load_dwordx4 v3, s[16:19], s35 offen lds
    s_add_u32 m0, s41, 50176
    s_mov_b32 s35, 30592
    buffer_load_dwordx4 v3, s[16:19], s35 offen lds
    s_add_u32 m0, s41, 51200
    s_mov_b32 s35, 58240
    buffer_load_dwordx4 v3, s[16:19], s35 offen lds
    s_add_u32 m0, s41, 52224
    s_mov_b32 s35, 85888
    buffer_load_dwordx4 v3, s[16:19], s35 offen lds
    s_add_u32 m0, s42, 49152
    s_mov_b32 s35, 1884160
    buffer_load_dwordx4 v7, s[20:23], s35 offen lds
    s_add_u32 m0, s42, 50176
    s_mov_b32 s35, 1894400
    buffer_load_dwordx4 v7, s[20:23], s35 offen lds
    ds_read_b128 v[64:67], v24 offset:0
    ds_read_b128 v[68:71], v24 offset:4096
    ds_read_b64_tr_b16 v[72:73], v16 offset:0
    ds_read_b64_tr_b16 v[74:75], v16 offset:512
    ds_read_b128 v[80:83], v25 offset:0
    ds_read_b128 v[84:87], v25 offset:4096
    ds_read_b64_tr_b16 v[88:89], v16 offset:2048
    ds_read_b64_tr_b16 v[90:91], v16 offset:2560
    s_waitcnt lgkmcnt(4)
    v_mfma_f32_32x32x16_bf16 v[96:111], v[72:75], v[64:67], v[96:111]
    v_mfma_f32_32x32x16_bf16 v[112:127], v[72:75], v[68:71], v[112:127]
    ds_read_b128 v[64:67], v26 offset:0
    ds_read_b128 v[68:71], v26 offset:4096
    ds_read_b64_tr_b16 v[72:73], v16 offset:4096
    ds_read_b64_tr_b16 v[74:75], v16 offset:4608
    s_waitcnt lgkmcnt(4)
    v_mfma_f32_32x32x16_bf16 v[96:111], v[88:91], v[80:83], v[96:111]
    v_mfma_f32_32x32x16_bf16 v[112:127], v[88:91], v[84:87], v[112:127]
    ds_read_b128 v[80:83], v27 offset:0
    ds_read_b128 v[84:87], v27 offset:4096
    ds_read_b64_tr_b16 v[88:89], v16 offset:6144
    ds_read_b64_tr_b16 v[90:91], v16 offset:6656
    s_waitcnt lgkmcnt(4)
    v_mfma_f32_32x32x16_bf16 v[96:111], v[72:75], v[64:67], v[96:111]
    v_mfma_f32_32x32x16_bf16 v[112:127], v[72:75], v[68:71], v[112:127]
    s_waitcnt lgkmcnt(0)
    v_mfma_f32_32x32x16_bf16 v[96:111], v[88:91], v[80:83], v[96:111]
    v_mfma_f32_32x32x16_bf16 v[112:127], v[88:91], v[84:87], v[112:127]
    s_waitcnt vmcnt(6)
    s_barrier
    s_add_u32 m0, s41, 0
    s_mov_b32 s35, 3072
    buffer_load_dwordx4 v3, s[16:19], s35 offen lds
    s_add_u32 m0, s41, 1024
    s_mov_b32 s35, 30720
    buffer_load_dwordx4 v3, s[16:19], s35 offen lds
    s_add_u32 m0, s41, 2048
    s_mov_b32 s35, 58368
    buffer_load_dwordx4 v3, s[16:19], s35 offen lds
    s_add_u32 m0, s41, 3072
    s_mov_b32 s35, 86016
    buffer_load_dwordx4 v3, s[16:19], s35 offen lds
    s_add_u32 m0, s42, 0
    s_mov_b32 s35, 1966080
    buffer_load_dwordx4 v7, s[20:23], s35 offen lds
    s_add_u32 m0, s42, 1024
    s_mov_b32 s35, 1976320
    buffer_load_dwordx4 v7, s[20:23], s35 offen lds
    ds_read_b128 v[64:67], v24 offset:24576
    ds_read_b128 v[68:71], v24 offset:28672
    ds_read_b64_tr_b16 v[72:73], v16 offset:24576
    ds_read_b64_tr_b16 v[74:75], v16 offset:25088
    ds_read_b128 v[80:83], v25 offset:24576
    ds_read_b128 v[84:87], v25 offset:28672
    ds_read_b64_tr_b16 v[88:89], v16 offset:26624
    ds_read_b64_tr_b16 v[90:91], v16 offset:27136
    s_waitcnt lgkmcnt(4)
    v_mfma_f32_32x32x16_bf16 v[96:111], v[72:75], v[64:67], v[96:111]
    v_mfma_f32_32x32x16_bf16 v[112:127], v[72:75], v[68:71], v[112:127]
    ds_read_b128 v[64:67], v26 offset:24576
    ds_read_b128 v[68:71], v26 offset:28672
    ds_read_b64_tr_b16 v[72:73], v16 offset:28672
    ds_read_b64_tr_b16 v[74:75], v16 offset:29184
    s_waitcnt lgkmcnt(4)
    v_mfma_f32_32x32x16_bf16 v[96:111], v[88:91], v[80:83], v[96:111]
    v_mfma_f32_32x32x16_bf16 v[112:127], v[88:91], v[84:87], v[112:127]
    ds_read_b128 v[80:83], v27 offset:24576
    ds_read_b128 v[84:87], v27 offset:28672
    ds_read_b64_tr_b16 v[88:89], v16 offset:30720
    ds_read_b64_tr_b16 v[90:91], v16 offset:31232
    s_waitcnt lgkmcnt(4)
    v_mfma_f32_32x32x16_bf16 v[96:111], v[72:75], v[64:67], v[96:111]
    v_mfma_f32_32x32x16_bf16 v[112:127], v[72:75], v[68:71], v[112:127]
    s_waitcnt lgkmcnt(0)
    v_mfma_f32_32x32x16_bf16 v[96:111], v[88:91], v[80:83], v[96:111]
    v_mfma_f32_32x32x16_bf16 v[112:127], v[88:91], v[84:87], v[112:127]
    s_waitcnt vmcnt(6)
    s_barrier
    s_add_u32 m0, s41, 24576
    s_mov_b32 s35, 3200
    buffer_load_dwordx4 v3, s[16:19], s35 offen lds
    s_add_u32 m0, s41, 25600
    s_mov_b32 s35, 30848
    buffer_load_dwordx4 v3, s[16:19], s35 offen lds
    s_add_u32 m0, s41, 26624
    s_mov_b32 s35, 58496
    buffer_load_dwordx4 v3, s[16:19], s35 offen lds
    s_add_u32 m0, s41, 27648
    s_mov_b32 s35, 86144
    buffer_load_dwordx4 v3, s[16:19], s35 offen lds
    s_add_u32 m0, s42, 24576
    s_mov_b32 s35, 2048000
    buffer_load_dwordx4 v7, s[20:23], s35 offen lds
    s_add_u32 m0, s42, 25600
    s_mov_b32 s35, 2058240
    buffer_load_dwordx4 v7, s[20:23], s35 offen lds
    ds_read_b128 v[64:67], v24 offset:49152
    ds_read_b128 v[68:71], v24 offset:53248
    ds_read_b64_tr_b16 v[72:73], v16 offset:49152
    ds_read_b64_tr_b16 v[74:75], v16 offset:49664
    ds_read_b128 v[80:83], v25 offset:49152
    ds_read_b128 v[84:87], v25 offset:53248
    ds_read_b64_tr_b16 v[88:89], v16 offset:51200
    ds_read_b64_tr_b16 v[90:91], v16 offset:51712
    s_waitcnt lgkmcnt(4)
    v_mfma_f32_32x32x16_bf16 v[96:111], v[72:75], v[64:67], v[96:111]
    v_mfma_f32_32x32x16_bf16 v[112:127], v[72:75], v[68:71], v[112:127]
    ds_read_b128 v[64:67], v26 offset:49152
    ds_read_b128 v[68:71], v26 offset:53248
    ds_read_b64_tr_b16 v[72:73], v16 offset:53248
    ds_read_b64_tr_b16 v[74:75], v16 offset:53760
    s_waitcnt lgkmcnt(4)
    v_mfma_f32_32x32x16_bf16 v[96:111], v[88:91], v[80:83], v[96:111]
    v_mfma_f32_32x32x16_bf16 v[112:127], v[88:91], v[84:87], v[112:127]
    ds_read_b128 v[80:83], v27 offset:49152
    ds_read_b128 v[84:87], v27 offset:53248
    ds_read_b64_tr_b16 v[88:89], v16 offset:55296
    ds_read_b64_tr_b16 v[90:91], v16 offset:55808
    s_waitcnt lgkmcnt(4)
    v_mfma_f32_32x32x16_bf16 v[96:111], v[72:75], v[64:67], v[96:111]
    v_mfma_f32_32x32x16_bf16 v[112:127], v[72:75], v[68:71], v[112:127]
    s_waitcnt lgkmcnt(0)
    v_mfma_f32_32x32x16_bf16 v[96:111], v[88:91], v[80:83], v[96:111]
    v_mfma_f32_32x32x16_bf16 v[112:127], v[88:91], v[84:87], v[112:127]
    s_waitcnt vmcnt(6)
    s_barrier
    s_add_u32 m0, s41, 49152
    s_mov_b32 s35, 3328
    buffer_load_dwordx4 v3, s[16:19], s35 offen lds
    s_add_u32 m0, s41, 50176
    s_mov_b32 s35, 30976
    buffer_load_dwordx4 v3, s[16:19], s35 offen lds
    s_add_u32 m0, s41, 51200
    s_mov_b32 s35, 58624
    buffer_load_dwordx4 v3, s[16:19], s35 offen lds
    s_add_u32 m0, s41, 52224
    s_mov_b32 s35, 86272
    buffer_load_dwordx4 v3, s[16:19], s35 offen lds
    s_add_u32 m0, s42, 49152
    s_mov_b32 s35, 2129920
    buffer_load_dwordx4 v7, s[20:23], s35 offen lds
    s_add_u32 m0, s42, 50176
    s_mov_b32 s35, 2140160
    buffer_load_dwordx4 v7, s[20:23], s35 offen lds
    ds_read_b128 v[64:67], v24 offset:0
    ds_read_b128 v[68:71], v24 offset:4096
    ds_read_b64_tr_b16 v[72:73], v16 offset:0
    ds_read_b64_tr_b16 v[74:75], v16 offset:512
    ds_read_b128 v[80:83], v25 offset:0
    ds_read_b128 v[84:87], v25 offset:4096
    ds_read_b64_tr_b16 v[88:89], v16 offset:2048
    ds_read_b64_tr_b16 v[90:91], v16 offset:2560
    s_waitcnt lgkmcnt(4)
    v_mfma_f32_32x32x16_bf16 v[96:111], v[72:75], v[64:67], v[96:111]
    v_mfma_f32_32x32x16_bf16 v[112:127], v[72:75], v[68:71], v[112:127]
    ds_read_b128 v[64:67], v26 offset:0
    ds_read_b128 v[68:71], v26 offset:4096
    ds_read_b64_tr_b16 v[72:73], v16 offset:4096
    ds_read_b64_tr_b16 v[74:75], v16 offset:4608
    s_waitcnt lgkmcnt(4)
    v_mfma_f32_32x32x16_bf16 v[96:111], v[88:91], v[80:83], v[96:111]
    v_mfma_f32_32x32x16_bf16 v[112:127], v[88:91], v[84:87], v[112:127]
    ds_read_b128 v[80:83], v27 offset:0
    ds_read_b128 v[84:87], v27 offset:4096
    ds_read_b64_tr_b16 v[88:89], v16 offset:6144
    ds_read_b64_tr_b16 v[90:91], v16 offset:6656
    s_waitcnt lgkmcnt(4)
    v_mfma_f32_32x32x16_bf16 v[96:111], v[72:75], v[64:67], v[96:111]
    v_mfma_f32_32x32x16_bf16 v[112:127], v[72:75], v[68:71], v[112:127]
    s_waitcnt lgkmcnt(0)
    v_mfma_f32_32x32x16_bf16 v[96:111], v[88:91], v[80:83], v[96:111]
    v_mfma_f32_32x32x16_bf16 v[112:127], v[88:91], v[84:87], v[112:127]
    s_waitcnt vmcnt(6)
    s_barrier
    ds_read_b128 v[64:67], v24 offset:24576
    ds_read_b128 v[68:71], v24 offset:28672
    ds_read_b64_tr_b16 v[72:73], v16 offset:24576
    ds_read_b64_tr_b16 v[74:75], v16 offset:25088
    ds_read_b128 v[80:83], v25 offset:24576
    ds_read_b128 v[84:87], v25 offset:28672
    ds_read_b64_tr_b16 v[88:89], v16 offset:26624
    ds_read_b64_tr_b16 v[90:91], v16 offset:27136
    s_waitcnt lgkmcnt(4)
    v_mfma_f32_32x32x16_bf16 v[96:111], v[72:75], v[64:67], v[96:111]
    v_mfma_f32_32x32x16_bf16 v[112:127], v[72:75], v[68:71], v[112:127]
    ds_read_b128 v[64:67], v26 offset:24576
    ds_read_b128 v[68:71], v26 offset:28672
    ds_read_b64_tr_b16 v[72:73], v16 offset:28672
    ds_read_b64_tr_b16 v[74:75], v16 offset:29184
    s_waitcnt lgkmcnt(4)
    v_mfma_f32_32x32x16_bf16 v[96:111], v[88:91], v[80:83], v[96:111]
    v_mfma_f32_32x32x16_bf16 v[112:127], v[88:91], v[84:87], v[112:127]
    ds_read_b128 v[80:83], v27 offset:24576
    ds_read_b128 v[84:87], v27 offset:28672
    ds_read_b64_tr_b16 v[88:89], v16 offset:30720
    ds_read_b64_tr_b16 v[90:91], v16 offset:31232
    s_waitcnt lgkmcnt(4)
    v_mfma_f32_32x32x16_bf16 v[96:111], v[72:75], v[64:67], v[96:111]
    v_mfma_f32_32x32x16_bf16 v[112:127], v[72:75], v[68:71], v[112:127]
    s_waitcnt lgkmcnt(0)
    v_mfma_f32_32x32x16_bf16 v[96:111], v[88:91], v[80:83], v[96:111]
    v_mfma_f32_32x32x16_bf16 v[112:127], v[88:91], v[84:87], v[112:127]
    s_waitcnt vmcnt(0)
    s_barrier
    ds_read_b128 v[64:67], v24 offset:49152
    ds_read_b128 v[68:71], v24 offset:53248
    ds_read_b64_tr_b16 v[72:73], v16 offset:49152
    ds_read_b64_tr_b16 v[74:75], v16 offset:49664
    ds_read_b128 v[80:83], v25 offset:49152
    ds_read_b128 v[84:87], v25 offset:53248
    ds_read_b64_tr_b16 v[88:89], v16 offset:51200
    ds_read_b64_tr_b16 v[90:91], v16 offset:51712
    s_waitcnt lgkmcnt(4)
    v_mfma_f32_32x32x16_bf16 v[96:111], v[72:75], v[64:67], v[96:111]
    v_mfma_f32_32x32x16_bf16 v[112:127], v[72:75], v[68:71], v[112:127]
    ds_read_b128 v[64:67], v26 offset:49152
    ds_read_b128 v[68:71], v26 offset:53248
    ds_read_b64_tr_b16 v[72:73], v16 offset:53248
    ds_read_b64_tr_b16 v[74:75], v16 offset:53760
    s_waitcnt lgkmcnt(4)
    v_mfma_f32_32x32x16_bf16 v[96:111], v[88:91], v[80:83], v[96:111]
    v_mfma_f32_32x32x16_bf16 v[112:127], v[88:91], v[84:87], v[112:127]
    ds_read_b128 v[80:83], v27 offset:49152
    ds_read_b128 v[84:87], v27 offset:53248
    ds_read_b64_tr_b16 v[88:89], v16 offset:55296
    ds_read_b64_tr_b16 v[90:91], v16 offset:55808
    s_waitcnt lgkmcnt(4)
    v_mfma_f32_32x32x16_bf16 v[96:111], v[72:75], v[64:67], v[96:111]
    v_mfma_f32_32x32x16_bf16 v[112:127], v[72:75], v[68:71], v[112:127]
    s_waitcnt lgkmcnt(0)
    v_mfma_f32_32x32x16_bf16 v[96:111], v[88:91], v[80:83], v[96:111]
    v_mfma_f32_32x32x16_bf16 v[112:127], v[88:91], v[84:87], v[112:127]
    s_nop 15
    s_nop 3
    s_lshl_b32 s32, s14, 7
    v_lshl_add_u32 v1, v11, 6, v13
    v_add_u32 v1, s32, v1
    s_movk_i32 s33, 1280
    v_mul_lo_u32 v1, v1, s33
    s_lshl_b32 s32, s15, 7
    v_add_u32 v1, s32, v1
    v_lshl_add_u32 v1, v12, 6, v1
    v_lshl_add_u32 v1, v14, 3, v1
    s_mov_b32 s35, 0
    buffer_load_dwordx2 v[32:33], v1, s[24:27], s35 offen offset:0
    buffer_load_dwordx2 v[34:35], v1, s[24:27], s35 offen offset:16
    buffer_load_dwordx2 v[36:37], v1, s[24:27], s35 offen offset:32
    buffer_load_dwordx2 v[38:39], v1, s[24:27], s35 offen offset:48
    s_waitcnt vmcnt(0)
    v_cvt_pk_bf16_f32 v20, v96, v97
    v_lshlrev_b32 v96, 16, v20
    v_and_b32 v97, 0xffff0000, v20
    v_lshlrev_b32 v21, 16, v32
    v_and_b32 v22, 0xffff0000, v32
    v_add_f32 v96, v96, v21
    v_add_f32 v97, v97, v22
    v_cvt_pk_bf16_f32 v24, v96, v97
    v_cvt_pk_bf16_f32 v20, v98, v99
    v_lshlrev_b32 v98, 16, v20
    v_and_b32 v99, 0xffff0000, v20
    v_lshlrev_b32 v21, 16, v33
    v_and_b32 v22, 0xffff0000, v33
    v_add_f32 v98, v98, v21
    v_add_f32 v99, v99, v22
    v_cvt_pk_bf16_f32 v25, v98, v99
    buffer_store_dwordx2 v[24:25], v1, s[28:31], s35 offen offset:0
    s_nop 1
    v_cvt_pk_bf16_f32 v20, v100, v101
    v_lshlrev_b32 v100, 16, v20
    v_and_b32 v101, 0xffff0000, v20
    v_lshlrev_b32 v21, 16, v34
    v_and_b32 v22, 0xffff0000, v34
    v_add_f32 v100, v100, v21
    v_add_f32 v101, v101, v22
    v_cvt_pk_bf16_f32 v24, v100, v101
    v_cvt_pk_bf16_f32 v20, v102, v103
    v_lshlrev_b32 v102, 16, v20
    v_and_b32 v103, 0xffff0000, v20
    v_lshlrev_b32 v21, 16, v35
    v_and_b32 v22, 0xffff0000, v35
    v_add_f32 v102, v102, v21
    v_add_f32 v103, v103, v22
    v_cvt_pk_bf16_f32 v25, v102, v103
    buffer_store_dwordx2 v[24:25], v1, s[28:31], s35 offen offset:16
    s_nop 1
    v_cvt_pk_bf16_f32 v20, v104, v105
    v_lshlrev_b32 v104, 16, v20
    v_and_b32 v105, 0xffff0000, v20
    v_lshlrev_b32 v21, 16, v36
    v_and_b32 v22, 0xffff0000, v36
    v_add_f32 v104, v104, v21
    v_add_f32 v105, v105, v22
    v_cvt_pk_bf16_f32 v24, v104, v105
    v_cvt_pk_bf16_f32 v20, v106, v107
    v_lshlrev_b32 v106, 16, v20
    v_and_b32 v107, 0xffff0000, v20
    v_lshlrev_b32 v21, 16, v37
    v_and_b32 v22, 0xffff0000, v37
    v_add_f32 v106, v106, v21
    v_add_f32 v107, v107, v22
    v_cvt_pk_bf16_f32 v25, v106, v107
    buffer_store_dwordx2 v[24:25], v1, s[28:31], s35 offen offset:32
    s_nop 1
    v_cvt_pk_bf16_f32 v20, v108, v109
    v_lshlrev_b32 v108, 16, v20
    v_and_b32 v109, 0xffff0000, v20
    v_lshlrev_b32 v21, 16, v38
    v_and_b32 v22, 0xffff0000, v38
    v_add_f32 v108, v108, v21
    v_add_f32 v109, v109, v22
    v_cvt_pk_bf16_f32 v24, v108, v109
    v_cvt_pk_bf16_f32 v20, v110, v111
    v_lshlrev_b32 v110, 16, v20
    v_and_b32 v111, 0xffff0000, v20
    v_lshlrev_b32 v21, 16, v39
    v_and_b32 v22, 0xffff0000, v39
    v_add_f32 v110, v110, v21
    v_add_f32 v111, v111, v22
    v_cvt_pk_bf16_f32 v25, v110, v111
    buffer_store_dwordx2 v[24:25], v1, s[28:31], s35 offen offset:48
    s_nop 1
    s_mov_b32 s35, 40960
    buffer_load_dwordx2 v[32:33], v1, s[24:27], s35 offen offset:0
    buffer_load_dwordx2 v[34:35], v1, s[24:27], s35 offen offset:16
    buffer_load_dwordx2 v[36:37], v1, s[24:27], s35 offen offset:32
    buffer_load_dwordx2 v[38:39], v1, s[24:27], s35 offen offset:48
    s_waitcnt vmcnt(0)
    v_cvt_pk_bf16_f32 v20, v112, v113
    v_lshlrev_b32 v112, 16, v20
    v_and_b32 v113, 0xffff0000, v20
    v_lshlrev_b32 v21, 16, v32
    v_and_b32 v22, 0xffff0000, v32
    v_add_f32 v112, v112, v21
    v_add_f32 v113, v113, v22
    v_cvt_pk_bf16_f32 v24, v112, v113
    v_cvt_pk_bf16_f32 v20, v114, v115
    v_lshlrev_b32 v114, 16, v20
    v_and_b32 v115, 0xffff0000, v20
    v_lshlrev_b32 v21, 16, v33
    v_and_b32 v22, 0xffff0000, v33
    v_add_f32 v114, v114, v21
    v_add_f32 v115, v115, v22
    v_cvt_pk_bf16_f32 v25, v114, v115
    buffer_store_dwordx2 v[24:25], v1, s[28:31], s35 offen offset:0
    s_nop 1
    v_cvt_pk_bf16_f32 v20, v116, v117
    v_lshlrev_b32 v116, 16, v20
    v_and_b32 v117, 0xffff0000, v20
    v_lshlrev_b32 v21, 16, v34
    v_and_b32 v22, 0xffff0000, v34
    v_add_f32 v116, v116, v21
    v_add_f32 v117, v117, v22
    v_cvt_pk_bf16_f32 v24, v116, v117
    v_cvt_pk_bf16_f32 v20, v118, v119
    v_lshlrev_b32 v118, 16, v20
    v_and_b32 v119, 0xffff0000, v20
    v_lshlrev_b32 v21, 16, v35
    v_and_b32 v22, 0xffff0000, v35
    v_add_f32 v118, v118, v21
    v_add_f32 v119, v119, v22
    v_cvt_pk_bf16_f32 v25, v118, v119
    buffer_store_dwordx2 v[24:25], v1, s[28:31], s35 offen offset:16
    s_nop 1
    v_cvt_pk_bf16_f32 v20, v120, v121
    v_lshlrev_b32 v120, 16, v20
    v_and_b32 v121, 0xffff0000, v20
    v_lshlrev_b32 v21, 16, v36
    v_and_b32 v22, 0xffff0000, v36
    v_add_f32 v120, v120, v21
    v_add_f32 v121, v121, v22
    v_cvt_pk_bf16_f32 v24, v120, v121
    v_cvt_pk_bf16_f32 v20, v122, v123
    v_lshlrev_b32 v122, 16, v20
    v_and_b32 v123, 0xffff0000, v20
    v_lshlrev_b32 v21, 16, v37
    v_and_b32 v22, 0xffff0000, v37
    v_add_f32 v122, v122, v21
    v_add_f32 v123, v123, v22
    v_cvt_pk_bf16_f32 v25, v122, v123
    buffer_store_dwordx2 v[24:25], v1, s[28:31], s35 offen offset:32
    s_nop 1
    v_cvt_pk_bf16_f32 v20, v124, v125
    v_lshlrev_b32 v124, 16, v20
    v_and_b32 v125, 0xffff0000, v20
    v_lshlrev_b32 v21, 16, v38
    v_and_b32 v22, 0xffff0000, v38
    v_add_f32 v124, v124, v21
    v_add_f32 v125, v125, v22
    v_cvt_pk_bf16_f32 v24, v124, v125
    v_cvt_pk_bf16_f32 v20, v126, v127
    v_lshlrev_b32 v126, 16, v20
    v_and_b32 v127, 0xffff0000, v20
    v_lshlrev_b32 v21, 16, v39
    v_and_b32 v22, 0xffff0000, v39
    v_add_f32 v126, v126, v21
    v_add_f32 v127, v127, v22
    v_cvt_pk_bf16_f32 v25, v126, v127
    buffer_store_dwordx2 v[24:25], v1, s[28:31], s35 offen offset:48
    s_nop 1
GEMM_END_g2b_kernel:
    s_endpgm
.section .rodata,"a"
.p2align 6
.p2align 6
.amdhsa_kernel kvt_kernel
  .amdhsa_next_free_vgpr 72
  .amdhsa_next_free_sgpr 96
  .amdhsa_accum_offset 72
  .amdhsa_group_segment_fixed_size 0
  .amdhsa_kernarg_size 104
  .amdhsa_user_sgpr_count 2
  .amdhsa_user_sgpr_kernarg_segment_ptr 1
  .amdhsa_system_sgpr_workgroup_id_x 1
.end_amdhsa_kernel
.p2align 6
.amdhsa_kernel conv_kernel
  .amdhsa_next_free_vgpr 136
  .amdhsa_next_free_sgpr 96
  .amdhsa_accum_offset 136
  .amdhsa_group_segment_fixed_size 0
  .amdhsa_kernarg_size 104
  .amdhsa_user_sgpr_count 2
  .amdhsa_user_sgpr_kernarg_segment_ptr 1
  .amdhsa_system_sgpr_workgroup_id_x 1
.end_amdhsa_kernel
.p2align 6
.amdhsa_kernel lna_kernel
  .amdhsa_next_free_vgpr 72
  .amdhsa_next_free_sgpr 96
  .amdhsa_accum_offset 72
  .amdhsa_group_segment_fixed_size 0
  .amdhsa_kernarg_size 104
  .amdhsa_user_sgpr_count 2
  .amdhsa_user_sgpr_kernarg_segment_ptr 1
  .amdhsa_system_sgpr_workgroup_id_x 1
.end_amdhsa_kernel
.p2align 6
.amdhsa_kernel lnb_kernel
  .amdhsa_next_free_vgpr 72
  .amdhsa_next_free_sgpr 96
  .amdhsa_accum_offset 72
  .amdhsa_group_segment_fixed_size 0
  .amdhsa_kernarg_size 104
  .amdhsa_user_sgpr_count 2
  .amdhsa_user_sgpr_kernarg_segment_ptr 1
  .amdhsa_system_sgpr_workgroup_id_x 1
.end_amdhsa_kernel
.p2align 6
.amdhsa_kernel g1_kernel
  .amdhsa_next_free_vgpr 160
  .amdhsa_next_free_sgpr 96
  .amdhsa_accum_offset 160
  .amdhsa_group_segment_fixed_size 0
  .amdhsa_kernarg_size 104
  .amdhsa_user_sgpr_count 2
  .amdhsa_user_sgpr_kernarg_segment_ptr 1
  .amdhsa_system_sgpr_workgroup_id_x 1
.end_amdhsa_kernel
.p2align 6
.amdhsa_kernel g2a_kernel
  .amdhsa_next_free_vgpr 128
  .amdhsa_next_free_sgpr 96
  .amdhsa_accum_offset 128
  .amdhsa_group_segment_fixed_size 0
  .amdhsa_kernarg_size 104
  .amdhsa_user_sgpr_count 2
  .amdhsa_user_sgpr_kernarg_segment_ptr 1
  .amdhsa_system_sgpr_workgroup_id_x 1
.end_amdhsa_kernel
.p2align 6
.amdhsa_kernel g2b_kernel
  .amdhsa_next_free_vgpr 128
  .amdhsa_next_free_sgpr 96
  .amdhsa_accum_offset 128
  .amdhsa_group_segment_fixed_size 0
  .amdhsa_kernarg_size 104
  .amdhsa_user_sgpr_count 2
  .amdhsa_user_sgpr_kernarg_segment_ptr 1
  .amdhsa_system_sgpr_workgroup_id_x 1
.end_amdhsa_kernel
```
